```python
import torch

def _softmax(x, axis=-1):
    return torch.softmax(x, dim=axis)
def _gelu(x):
    return torch.nn.functional.gelu(x, approximate="tanh")
def _silu(x):
    return torch.nn.functional.silu(x)
def _sigmoid(x):
    return torch.sigmoid(x)
def _layernorm(x, axis=-1, eps=1e-5):
    m = x.mean(dim=axis, keepdim=True)
    v = x.var(dim=axis, keepdim=True, unbiased=False)
    return (x - m) / torch.sqrt(v + eps)
def _scatter_add(tgt, idx, src, axis=0):
    return tgt.clone().index_add_(axis, idx, src)
def _segment_sum(src, seg, n):
    out = torch.zeros((n,) + src.shape[1:], dtype=src.dtype)
    return out.index_add_(0, seg, src)
def _pad(x, pw):
    flat = tuple(v for pair in reversed(pw) for v in pair)
    return torch.nn.functional.pad(x, flat)

kernel_name = 'gated_mix__sliding_block__softmax_full_mha__prompt'

def setup_inputs():

    _w = (lambda a: (lambda t: t.to(torch.bfloat16) if t.is_floating_point() else t)(torch.as_tensor(a)))
    def _A_setup():
        B, S, D = 1, 2048, 576
        return {
            "x": _w((lambda *s: torch.randn(*s, dtype=torch.bfloat16) * 0.05)(B, S, D)),
            "wqkv": _w((lambda *s: torch.randn(*s, dtype=torch.bfloat16) * 3.2)(D, 3 * D)),
            "wo": _w((lambda *s: torch.randn(*s, dtype=torch.bfloat16) * 0.1)(D, D)),
        }
    _A_in = _A_setup()

    def _B_setup():
        B, S, D = 1, 2048, 576
        return {
            "x": _w((lambda *s: torch.randn(*s, dtype=torch.bfloat16) * 0.05)(B, S, D)),
            "wqkv": _w((lambda *s: torch.randn(*s, dtype=torch.bfloat16) * 1.6)(D, 3 * D)),
            "wo": _w((lambda *s: torch.randn(*s, dtype=torch.bfloat16) * 0.2)(D, D)),
        }
    _B_in = _B_setup()

    return {
        "A_x": _A_in["x"],
        "A_wqkv": _A_in["wqkv"],
        "A_wo": _A_in["wo"],
        "B_x": _B_in["x"],
        "B_wqkv": _B_in["wqkv"],
        "B_wo": _B_in["wo"],
        "gate_w": _w((lambda *s: torch.randn(*s, dtype=torch.bfloat16) * 0.05)(576) * 16.0),
    }

def reference(A_x, A_wqkv, A_wo, B_x, B_wqkv, B_wo, gate_w):
    def _A_ref(x, wqkv, wo):
        B, S, D = x.shape
        H = 32; Dh = D // H; W = 256
        qkv = (lambda x, *d: x.permute(*d))((x @ wqkv).reshape(B, S, 3, H, Dh), 2, 0, 3, 1, 4)
        q, k, v = qkv[0], qkv[1], qkv[2]
        scores = torch.einsum("bhqd,bhkd->bhqk", q, k) * (Dh ** -0.5)
        idx = torch.arange(S)
        mask = (idx[:, None] - idx[None, :] >= 0) & (idx[:, None] - idx[None, :] < W)
        scores = torch.where(mask[None, None], scores, -1e9)
        p = _softmax(scores, axis=-1)
        o = torch.einsum("bhqk,bhkd->bhqd", p, v)
        return (lambda x, *d: x.permute(*d))(o, 0, 2, 1, 3).reshape(B, S, D) @ wo

    def _B_ref(x, wqkv, wo):
        B, S, D = x.shape
        H = 32; Dh = D // H
        qkv = (lambda x, *d: x.permute(*d))((x @ wqkv).reshape(B, S, 3, H, Dh), 2, 0, 3, 1, 4)
        q, k, v = qkv[0], qkv[1], qkv[2]
        scale = Dh ** -0.5
        scores = torch.einsum("bhqd,bhkd->bhqk", q, k) * scale
        p = _softmax(scores, axis=-1)
        o = torch.einsum("bhqk,bhkd->bhqd", p, v)
        return (lambda x, *d: x.permute(*d))(o, 0, 2, 1, 3).reshape(B, S, D) @ wo

    x = A_x
    g = _sigmoid((x * gate_w).sum(-1, keepdims=True))
    a = _A_ref(x, A_wqkv, A_wo)
    b = _B_ref(x, B_wqkv, B_wo)
    return g * a + (1 - g) * b
```

```asm
; @launch kernel=qkv_kernel grid=(256,1,1) block=(768,1,1) lds=150592
; @launch kernel=attn_kernel grid=(256,1,1) block=(576,1,1) lds=163840
; @launch kernel=oproj_kernel grid=(256,1,1) block=(768,1,1) lds=147456
.amdgcn_target "amdgcn-amd-amdhsa--gfx950"
.text
code_start:
.globl qkv_kernel
.p2align 8
.type qkv_kernel,@function
qkv_kernel:
    s_load_dwordx4 s[40:43], s[0:1], 0
    s_load_dwordx2 s[56:57], s[0:1], 32
    s_load_dwordx2 s[4:5], s[0:1], 72
    s_cmp_ge_u32 s2, 256
    s_cbranch_scc1 L_qkv_end
    s_getpc_b64 s[94:95]
L_pc_1:
    s_sub_u32 s94, s94, L_pc_1-code_start
    s_subb_u32 s95, s95, 0
    v_lshlrev_b32 v164, 7, v0
    v_min_u32 v164, code_end-code_start-4, v164
    v_mov_b32 v165, s95
    v_add_co_u32 v164, vcc, s94, v164
    s_nop 1
    v_addc_co_u32 v165, vcc, 0, v165, vcc
    global_load_dword v166, v[164:165], off
    s_and_b32 s29, s2, 7
    s_lshr_b32 s25, s29, 2
    v_and_b32 v1, 63, v0
    v_lshrrev_b32 v2, 6, v0
    v_and_b32 v11, 15, v1
    v_readfirstlane_b32 s24, v2
    v_lshrrev_b32 v12, 4, v1
    s_lshr_b32 s31, s2, 3
    s_and_b32 s26, s31, 7
    s_and_b32 s32, s2, 1
    s_lshl_b32 s32, s32, 3
    s_add_u32 s26, s26, s32
    s_lshr_b32 s27, s31, 3
    s_bfe_u32 s32, s2, 0x10001
    s_lshl_b32 s32, s32, 2
    s_add_u32 s27, s27, s32
    s_and_b32 s36, s27, 5
    s_cmp_eq_u32 s36, 5
    s_cselect_b32 s36, -8, 0
    s_mul_i32 s35, s27, 216
    s_add_i32 s35, s35, s36
    s_waitcnt lgkmcnt(0)
    s_cmp_eq_u32 s25, 0
    s_cselect_b32 s42, s56, s42
    s_cselect_b32 s43, s57, s43
    s_mov_b32 s12, s40
    s_and_b32 s13, s41, 0xffff
    s_mov_b32 s14, 2359296
    s_mov_b32 s15, 0x20000
    s_mov_b32 s16, s42
    s_and_b32 s17, s43, 0xffff
    s_mov_b32 s18, 1990656
    s_mov_b32 s19, 0x20000
    s_mov_b32 s20, s4
    s_and_b32 s21, s5, 0xffff
    s_mov_b32 s22, 268435456
    s_mov_b32 s23, 0x20000
    s_cmp_ge_u32 s24, 8
    s_cbranch_scc1 L_qkv_loader
    s_cmp_gt_u32 s24, 1
    s_cbranch_scc1 L_nopf_2
    v_mov_b32 v5, 0x80000000
    s_cmp_ge_u32 s24, 1
    s_cbranch_scc1 L_p0_3
    v_mul_u32_u24 v2, 21846, v1
    v_lshrrev_b32 v2, 16, v2
    v_mul_u32_u24 v3, 3, v2
    v_sub_u32 v3, v1, v3
    v_cmp_gt_u32 vcc, 24, v1
    s_lshl_b32 s31, s2, 3
    v_add_u32 v2, s31, v2
    v_mul_u32_u24 v2, 1152, v2
    v_add_u32 v3, 1, v3
    v_lshlrev_b32 v3, 7, v3
    v_add_u32 v2, v2, v3
    v_cndmask_b32 v2, v5, v2, vcc
    buffer_load_dword v164, v2, s[12:15], 0 offen
    s_branch L_nopf_2
L_p0_3:
    s_lshr_b32 s31, s2, 3
    s_lshl_b32 s31, s31, 2
    s_and_b32 s32, s2, 3
    s_add_u32 s31, s31, s32
    s_mul_i32 s31, s31, 41
    s_add_u32 s31, s31, 1728
    s_sub_u32 s32, s24, 1
    s_lshl_b32 s32, s32, 6
    v_add_u32 v2, s32, v1
    v_cmp_gt_u32 vcc, 41, v2
    v_add_u32 v2, s31, v2
    v_lshlrev_b32 v2, 7, v2
    v_cndmask_b32 v2, v5, v2, vcc
    buffer_load_dword v164, v2, s[16:19], 0 offen
L_nopf_2:
    s_and_b32 s54, s24, 1
    s_bfe_u32 s31, s24, 0x10001
    s_cmp_ge_u32 s24, 4
    s_cselect_b32 s55, 3, 4
    s_cselect_b32 s32, 8, 0
    s_mul_i32 s28, s31, s55
    s_add_u32 s28, s28, s32
    v_and_b32 v3, 1, v12
    v_lshlrev_b32 v3, 2, v3
    v_lshrrev_b32 v2, 2, v11
    v_add_u32 v2, v2, v3
    v_mul_u32_u24 v10, 1056, v2
    v_lshrrev_b32 v2, 1, v12
    v_lshlrev_b32 v2, 9, v2
    v_add_u32 v10, v10, v2
    v_and_b32 v3, 3, v11
    v_lshlrev_b32 v3, 3, v3
    v_add_u32 v10, v10, v3
    s_lshl_b32 s31, s35, 1
    s_and_b32 s31, s31, 63
    s_lshl_b32 s32, s28, 5
    s_add_u32 s31, s31, s32
    v_add_u32 v10, s31, v10
    v_lshrrev_b32 v2, 1, v11
    v_xor_b32 v2, v2, v12
    v_lshlrev_b32 v2, 4, v2
    v_lshlrev_b32 v3, 7, v11
    v_add_u32 v14, v2, v3
    s_lshl_b32 s31, s54, 13
    s_add_u32 s31, s31, 101376
    v_add_u32 v14, s31, v14
    v_xor_b32 v15, 64, v14
    s_cmp_le_u32 s27, 4
    s_cselect_b32 s37, 14, 0
    s_cmp_eq_u32 s27, 5
    s_cselect_b32 s37, 5, s37
    s_cmp_le_u32 s27, 1
    s_cselect_b32 s45, 14, 0
    s_cmp_eq_u32 s27, 2
    s_cselect_b32 s45, 9, s45
    v_mov_b32 v13, 58432
    s_mov_b32 s44, 0
    s_add_u32 s33, s28, 0
    s_cmp_ge_u32 s33, s37
    s_cbranch_scc1 L_pv_4
    s_ashr_i32 s31, s36, 2
    s_lshl_b32 s32, s33, 2
    s_add_i32 s31, s31, s32
    v_add_u32 v28, s31, v12
    v_cmp_gt_u32 s[38:39], 54, v28
    v_mul_u32_u24 v29, 7282, v28
    v_lshrrev_b32 v29, 16, v29
    v_mul_u32_u24 v32, 9, v29
    v_sub_u32 v30, v28, v32
    v_cmp_lt_u32 vcc, 4, v30
    v_lshlrev_b32 v31, 1, v29
    v_subrev_u32 v32, 5, v30
    v_cndmask_b32 v32, v30, v32, vcc
    v_cndmask_b32_e64 v33, 0, 1, vcc
    v_add_u32 v31, v31, v33
    v_mul_u32_u24 v31, 4864, v31
    v_lshrrev_b32 v33, 1, v32
    v_lshlrev_b32 v33, 9, v33
    v_add_u32 v31, v31, v33
    v_and_b32 v32, 1, v32
    v_lshlrev_b32 v32, 3, v32
    v_add_u32 v31, v31, v32
    v_lshlrev_b32 v32, 4, v11
    v_add_u32 v31, v31, v32
    s_lshl_b32 s31, s54, 11
    v_add_u32 v31, s31, v31
    v_cmp_eq_u32 vcc, 4, v30
    s_and_b64 vcc, vcc, s[38:39]
    s_andn2_b64 s[38:39], s[38:39], vcc
    s_cmp_lg_u64 vcc, 0
    s_cselect_b32 s31, 1, 0
    s_or_b32 s44, s44, s31
    v_cndmask_b32_e64 v20, v13, v31, s[38:39]
    v_mul_u32_u24 v29, 9728, v29
    v_lshlrev_b32 v32, 2, v11
    v_add_u32 v29, v29, v32
    s_lshl_b32 s31, s54, 8
    s_add_u32 s31, s31, 4096
    v_add_u32 v29, s31, v29
    v_cndmask_b32 v24, v13, v29, vcc
    s_branch L_pd_5
L_pv_4:
    s_lshl_b32 s31, s33, 4
    s_add_i32 s31, s31, s36
    v_add_u32 v28, s31, v11
    v_cmp_gt_u32 vcc, 216, v28
    v_mul_u32_u24 v31, 3641, v28
    v_lshrrev_b32 v31, 16, v31
    v_mul_u32_u24 v32, 18, v31
    v_sub_u32 v30, v28, v32
    v_mul_u32_u24 v31, 4864, v31
    v_lshlrev_b32 v32, 4, v30
    v_add_u32 v31, v31, v32
    v_and_b32 v32, 1, v12
    v_mul_u32_u24 v32, 304, v32
    v_add_u32 v31, v31, v32
    v_lshrrev_b32 v32, 1, v12
    v_lshlrev_b32 v32, 3, v32
    v_add_u32 v31, v31, v32
    s_mul_i32 s31, s54, 2432
    v_add_u32 v31, s31, v31
    v_cndmask_b32 v20, v13, v31, vcc
L_pd_5:
    s_add_u32 s33, s28, 1
    s_cmp_ge_u32 s33, s37
    s_cbranch_scc1 L_pv_6
    s_ashr_i32 s31, s36, 2
    s_lshl_b32 s32, s33, 2
    s_add_i32 s31, s31, s32
    v_add_u32 v28, s31, v12
    v_cmp_gt_u32 s[38:39], 54, v28
    v_mul_u32_u24 v29, 7282, v28
    v_lshrrev_b32 v29, 16, v29
    v_mul_u32_u24 v32, 9, v29
    v_sub_u32 v30, v28, v32
    v_cmp_lt_u32 vcc, 4, v30
    v_lshlrev_b32 v31, 1, v29
    v_subrev_u32 v32, 5, v30
    v_cndmask_b32 v32, v30, v32, vcc
    v_cndmask_b32_e64 v33, 0, 1, vcc
    v_add_u32 v31, v31, v33
    v_mul_u32_u24 v31, 4864, v31
    v_lshrrev_b32 v33, 1, v32
    v_lshlrev_b32 v33, 9, v33
    v_add_u32 v31, v31, v33
    v_and_b32 v32, 1, v32
    v_lshlrev_b32 v32, 3, v32
    v_add_u32 v31, v31, v32
    v_lshlrev_b32 v32, 4, v11
    v_add_u32 v31, v31, v32
    s_lshl_b32 s31, s54, 11
    v_add_u32 v31, s31, v31
    v_cmp_eq_u32 vcc, 4, v30
    s_and_b64 vcc, vcc, s[38:39]
    s_andn2_b64 s[38:39], s[38:39], vcc
    s_cmp_lg_u64 vcc, 0
    s_cselect_b32 s31, 2, 0
    s_or_b32 s44, s44, s31
    v_cndmask_b32_e64 v21, v13, v31, s[38:39]
    v_mul_u32_u24 v29, 9728, v29
    v_lshlrev_b32 v32, 2, v11
    v_add_u32 v29, v29, v32
    s_lshl_b32 s31, s54, 8
    s_add_u32 s31, s31, 4096
    v_add_u32 v29, s31, v29
    v_cndmask_b32 v25, v13, v29, vcc
    s_branch L_pd_7
L_pv_6:
    s_lshl_b32 s31, s33, 4
    s_add_i32 s31, s31, s36
    v_add_u32 v28, s31, v11
    v_cmp_gt_u32 vcc, 216, v28
    v_mul_u32_u24 v31, 3641, v28
    v_lshrrev_b32 v31, 16, v31
    v_mul_u32_u24 v32, 18, v31
    v_sub_u32 v30, v28, v32
    v_mul_u32_u24 v31, 4864, v31
    v_lshlrev_b32 v32, 4, v30
    v_add_u32 v31, v31, v32
    v_and_b32 v32, 1, v12
    v_mul_u32_u24 v32, 304, v32
    v_add_u32 v31, v31, v32
    v_lshrrev_b32 v32, 1, v12
    v_lshlrev_b32 v32, 3, v32
    v_add_u32 v31, v31, v32
    s_mul_i32 s31, s54, 2432
    v_add_u32 v31, s31, v31
    v_cndmask_b32 v21, v13, v31, vcc
L_pd_7:
    s_add_u32 s33, s28, 2
    s_cmp_ge_u32 s33, s37
    s_cbranch_scc1 L_pv_8
    s_ashr_i32 s31, s36, 2
    s_lshl_b32 s32, s33, 2
    s_add_i32 s31, s31, s32
    v_add_u32 v28, s31, v12
    v_cmp_gt_u32 s[38:39], 54, v28
    v_mul_u32_u24 v29, 7282, v28
    v_lshrrev_b32 v29, 16, v29
    v_mul_u32_u24 v32, 9, v29
    v_sub_u32 v30, v28, v32
    v_cmp_lt_u32 vcc, 4, v30
    v_lshlrev_b32 v31, 1, v29
    v_subrev_u32 v32, 5, v30
    v_cndmask_b32 v32, v30, v32, vcc
    v_cndmask_b32_e64 v33, 0, 1, vcc
    v_add_u32 v31, v31, v33
    v_mul_u32_u24 v31, 4864, v31
    v_lshrrev_b32 v33, 1, v32
    v_lshlrev_b32 v33, 9, v33
    v_add_u32 v31, v31, v33
    v_and_b32 v32, 1, v32
    v_lshlrev_b32 v32, 3, v32
    v_add_u32 v31, v31, v32
    v_lshlrev_b32 v32, 4, v11
    v_add_u32 v31, v31, v32
    s_lshl_b32 s31, s54, 11
    v_add_u32 v31, s31, v31
    v_cmp_eq_u32 vcc, 4, v30
    s_and_b64 vcc, vcc, s[38:39]
    s_andn2_b64 s[38:39], s[38:39], vcc
    s_cmp_lg_u64 vcc, 0
    s_cselect_b32 s31, 4, 0
    s_or_b32 s44, s44, s31
    v_cndmask_b32_e64 v22, v13, v31, s[38:39]
    v_mul_u32_u24 v29, 9728, v29
    v_lshlrev_b32 v32, 2, v11
    v_add_u32 v29, v29, v32
    s_lshl_b32 s31, s54, 8
    s_add_u32 s31, s31, 4096
    v_add_u32 v29, s31, v29
    v_cndmask_b32 v26, v13, v29, vcc
    s_branch L_pd_9
L_pv_8:
    s_lshl_b32 s31, s33, 4
    s_add_i32 s31, s31, s36
    v_add_u32 v28, s31, v11
    v_cmp_gt_u32 vcc, 216, v28
    v_mul_u32_u24 v31, 3641, v28
    v_lshrrev_b32 v31, 16, v31
    v_mul_u32_u24 v32, 18, v31
    v_sub_u32 v30, v28, v32
    v_mul_u32_u24 v31, 4864, v31
    v_lshlrev_b32 v32, 4, v30
    v_add_u32 v31, v31, v32
    v_and_b32 v32, 1, v12
    v_mul_u32_u24 v32, 304, v32
    v_add_u32 v31, v31, v32
    v_lshrrev_b32 v32, 1, v12
    v_lshlrev_b32 v32, 3, v32
    v_add_u32 v31, v31, v32
    s_mul_i32 s31, s54, 2432
    v_add_u32 v31, s31, v31
    v_cndmask_b32 v22, v13, v31, vcc
L_pd_9:
    s_add_u32 s33, s28, 3
    s_cmp_ge_u32 s33, s37
    s_cbranch_scc1 L_pv_10
    s_ashr_i32 s31, s36, 2
    s_lshl_b32 s32, s33, 2
    s_add_i32 s31, s31, s32
    v_add_u32 v28, s31, v12
    v_cmp_gt_u32 s[38:39], 54, v28
    v_mul_u32_u24 v29, 7282, v28
    v_lshrrev_b32 v29, 16, v29
    v_mul_u32_u24 v32, 9, v29
    v_sub_u32 v30, v28, v32
    v_cmp_lt_u32 vcc, 4, v30
    v_lshlrev_b32 v31, 1, v29
    v_subrev_u32 v32, 5, v30
    v_cndmask_b32 v32, v30, v32, vcc
    v_cndmask_b32_e64 v33, 0, 1, vcc
    v_add_u32 v31, v31, v33
    v_mul_u32_u24 v31, 4864, v31
    v_lshrrev_b32 v33, 1, v32
    v_lshlrev_b32 v33, 9, v33
    v_add_u32 v31, v31, v33
    v_and_b32 v32, 1, v32
    v_lshlrev_b32 v32, 3, v32
    v_add_u32 v31, v31, v32
    v_lshlrev_b32 v32, 4, v11
    v_add_u32 v31, v31, v32
    s_lshl_b32 s31, s54, 11
    v_add_u32 v31, s31, v31
    v_cmp_eq_u32 vcc, 4, v30
    s_and_b64 vcc, vcc, s[38:39]
    s_andn2_b64 s[38:39], s[38:39], vcc
    s_cmp_lg_u64 vcc, 0
    s_cselect_b32 s31, 8, 0
    s_or_b32 s44, s44, s31
    v_cndmask_b32_e64 v23, v13, v31, s[38:39]
    v_mul_u32_u24 v29, 9728, v29
    v_lshlrev_b32 v32, 2, v11
    v_add_u32 v29, v29, v32
    s_lshl_b32 s31, s54, 8
    s_add_u32 s31, s31, 4096
    v_add_u32 v29, s31, v29
    v_cndmask_b32 v27, v13, v29, vcc
    s_branch L_pd_11
L_pv_10:
    s_lshl_b32 s31, s33, 4
    s_add_i32 s31, s31, s36
    v_add_u32 v28, s31, v11
    v_cmp_gt_u32 vcc, 216, v28
    v_mul_u32_u24 v31, 3641, v28
    v_lshrrev_b32 v31, 16, v31
    v_mul_u32_u24 v32, 18, v31
    v_sub_u32 v30, v28, v32
    v_mul_u32_u24 v31, 4864, v31
    v_lshlrev_b32 v32, 4, v30
    v_add_u32 v31, v31, v32
    v_and_b32 v32, 1, v12
    v_mul_u32_u24 v32, 304, v32
    v_add_u32 v31, v31, v32
    v_lshrrev_b32 v32, 1, v12
    v_lshlrev_b32 v32, 3, v32
    v_add_u32 v31, v31, v32
    s_mul_i32 s31, s54, 2432
    v_add_u32 v31, s31, v31
    v_cndmask_b32 v23, v13, v31, vcc
L_pd_11:
    v_mov_b64 v[100:101], 0
    v_mov_b64 v[102:103], 0
    v_mov_b64 v[104:105], 0
    v_mov_b64 v[106:107], 0
    v_mov_b64 v[108:109], 0
    v_mov_b64 v[110:111], 0
    v_mov_b64 v[112:113], 0
    v_mov_b64 v[114:115], 0
    v_mov_b64 v[116:117], 0
    v_mov_b64 v[118:119], 0
    v_mov_b64 v[120:121], 0
    v_mov_b64 v[122:123], 0
    v_mov_b64 v[124:125], 0
    v_mov_b64 v[126:127], 0
    v_mov_b64 v[128:129], 0
    v_mov_b64 v[130:131], 0
    v_mov_b64 v[132:133], 0
    v_mov_b64 v[134:135], 0
    v_mov_b64 v[136:137], 0
    v_mov_b64 v[138:139], 0
    v_mov_b64 v[140:141], 0
    v_mov_b64 v[142:143], 0
    v_mov_b64 v[144:145], 0
    v_mov_b64 v[146:147], 0
    v_mov_b64 v[148:149], 0
    v_mov_b64 v[150:151], 0
    v_mov_b64 v[152:153], 0
    v_mov_b64 v[154:155], 0
    v_mov_b64 v[156:157], 0
    v_mov_b64 v[158:159], 0
    v_mov_b64 v[160:161], 0
    v_mov_b64 v[162:163], 0
    s_sub_i32 s31, s37, s28
    s_max_i32 s31, s31, 0
    s_min_i32 s31, s31, s55
    s_lshl_b32 s32, s55, 4
    s_add_u32 s31, s31, s32
    s_mov_b32 s48, 16896
    s_mov_b32 s49, 0
    s_mov_b32 s50, 0
    s_cmp_eq_u32 s31, 65
    s_cbranch_scc1 L_qkv_v41
    s_cmp_eq_u32 s31, 64
    s_cbranch_scc1 L_qkv_v40
    s_cmp_eq_u32 s31, 51
    s_cbranch_scc1 L_qkv_v33
    s_cmp_eq_u32 s31, 48
    s_cbranch_scc1 L_qkv_v30
L_qkv_v44:
    s_barrier
    s_cmp_gt_u32 s24, 2
    s_cbranch_scc1 L_nopf_12
    v_mov_b32 v5, 0x80000000
    s_cmp_ge_u32 s24, 1
    s_cbranch_scc1 L_p0_13
    v_mul_u32_u24 v2, 13108, v1
    v_lshrrev_b32 v2, 16, v2
    v_mul_u32_u24 v3, 5, v2
    v_sub_u32 v3, v1, v3
    v_cmp_gt_u32 vcc, 40, v1
    s_lshl_b32 s31, s2, 3
    v_add_u32 v2, s31, v2
    v_mul_u32_u24 v2, 1152, v2
    v_add_u32 v3, 4, v3
    v_lshlrev_b32 v3, 7, v3
    v_add_u32 v2, v2, v3
    v_cndmask_b32 v2, v5, v2, vcc
    buffer_load_dword v164, v2, s[12:15], 0 offen
    s_branch L_nopf_12
L_p0_13:
    s_lshr_b32 s31, s2, 3
    s_lshl_b32 s31, s31, 2
    s_and_b32 s32, s2, 3
    s_add_u32 s31, s31, s32
    s_mul_i32 s31, s31, 68
    s_add_u32 s31, s31, 6912
    s_sub_u32 s32, s24, 1
    s_lshl_b32 s32, s32, 6
    v_add_u32 v2, s32, v1
    v_cmp_gt_u32 vcc, 68, v2
    v_add_u32 v2, s31, v2
    v_lshlrev_b32 v2, 7, v2
    v_cndmask_b32 v2, v5, v2, vcc
    buffer_load_dword v164, v2, s[16:19], 0 offen
L_nopf_12:
    ds_read_b128 v[68:71], v14 offset:0
    ds_read_b128 v[72:75], v14 offset:2048
    ds_read_b128 v[76:79], v14 offset:4096
    ds_read_b128 v[80:83], v14 offset:6144
    ds_read_b64_tr_b16 v[36:37], v10 offset:0
    ds_read_b64_tr_b16 v[38:39], v10 offset:8448
    ds_read_b64_tr_b16 v[40:41], v10 offset:32
    ds_read_b64_tr_b16 v[42:43], v10 offset:8480
    ds_read_b64_tr_b16 v[44:45], v10 offset:64
    ds_read_b64_tr_b16 v[46:47], v10 offset:8512
    ds_read_b64_tr_b16 v[48:49], v10 offset:96
    ds_read_b64_tr_b16 v[50:51], v10 offset:8544
L_qkv_loop44:
    s_waitcnt lgkmcnt(0)
    v_mfma_f32_16x16x32_bf16 v[100:103], v[36:39], v[68:71], v[100:103]
    v_add_u32 v9, s48, v10
    v_add_u32 v17, s49, v15
    v_mfma_f32_16x16x32_bf16 v[104:107], v[36:39], v[72:75], v[104:107]
    s_add_u32 s48, s48, 16896
    s_cmp_eq_u32 s48, 101376
    s_cselect_b32 s48, 0, s48
    v_mfma_f32_16x16x32_bf16 v[108:111], v[36:39], v[76:79], v[108:111]
    ds_read_b128 v[84:87], v17 offset:0
    ds_read_b128 v[88:91], v17 offset:2048
    v_mfma_f32_16x16x32_bf16 v[112:115], v[36:39], v[80:83], v[112:115]
    ds_read_b128 v[92:95], v17 offset:4096
    ds_read_b128 v[96:99], v17 offset:6144
    v_mfma_f32_16x16x32_bf16 v[116:119], v[40:43], v[68:71], v[116:119]
    ds_read_b64_tr_b16 v[52:53], v9 offset:0
    ds_read_b64_tr_b16 v[54:55], v9 offset:8448
    v_mfma_f32_16x16x32_bf16 v[120:123], v[40:43], v[72:75], v[120:123]
    ds_read_b64_tr_b16 v[56:57], v9 offset:32
    ds_read_b64_tr_b16 v[58:59], v9 offset:8480
    v_mfma_f32_16x16x32_bf16 v[124:127], v[40:43], v[76:79], v[124:127]
    ds_read_b64_tr_b16 v[60:61], v9 offset:64
    ds_read_b64_tr_b16 v[62:63], v9 offset:8512
    v_mfma_f32_16x16x32_bf16 v[128:131], v[40:43], v[80:83], v[128:131]
    ds_read_b64_tr_b16 v[64:65], v9 offset:96
    ds_read_b64_tr_b16 v[66:67], v9 offset:8544
    v_mfma_f32_16x16x32_bf16 v[132:135], v[44:47], v[68:71], v[132:135]
    v_mfma_f32_16x16x32_bf16 v[136:139], v[44:47], v[72:75], v[136:139]
    v_mfma_f32_16x16x32_bf16 v[140:143], v[44:47], v[76:79], v[140:143]
    v_mfma_f32_16x16x32_bf16 v[144:147], v[44:47], v[80:83], v[144:147]
    v_mfma_f32_16x16x32_bf16 v[148:151], v[48:51], v[68:71], v[148:151]
    v_mfma_f32_16x16x32_bf16 v[152:155], v[48:51], v[72:75], v[152:155]
    v_mfma_f32_16x16x32_bf16 v[156:159], v[48:51], v[76:79], v[156:159]
    v_mfma_f32_16x16x32_bf16 v[160:163], v[48:51], v[80:83], v[160:163]
    s_barrier
    s_waitcnt lgkmcnt(0)
    v_mfma_f32_16x16x32_bf16 v[100:103], v[52:55], v[84:87], v[100:103]
    v_add_u32 v8, s48, v10
    s_add_u32 s49, s49, 16384
    s_cmp_eq_u32 s49, 49152
    s_cselect_b32 s49, 0, s49
    v_add_u32 v16, s49, v14
    v_mfma_f32_16x16x32_bf16 v[104:107], v[52:55], v[88:91], v[104:107]
    s_add_u32 s48, s48, 16896
    s_cmp_eq_u32 s48, 101376
    s_cselect_b32 s48, 0, s48
    v_mfma_f32_16x16x32_bf16 v[108:111], v[52:55], v[92:95], v[108:111]
    ds_read_b128 v[68:71], v16 offset:0
    ds_read_b128 v[72:75], v16 offset:2048
    v_mfma_f32_16x16x32_bf16 v[112:115], v[52:55], v[96:99], v[112:115]
    ds_read_b128 v[76:79], v16 offset:4096
    ds_read_b128 v[80:83], v16 offset:6144
    v_mfma_f32_16x16x32_bf16 v[116:119], v[56:59], v[84:87], v[116:119]
    ds_read_b64_tr_b16 v[36:37], v8 offset:0
    ds_read_b64_tr_b16 v[38:39], v8 offset:8448
    v_mfma_f32_16x16x32_bf16 v[120:123], v[56:59], v[88:91], v[120:123]
    ds_read_b64_tr_b16 v[40:41], v8 offset:32
    ds_read_b64_tr_b16 v[42:43], v8 offset:8480
    v_mfma_f32_16x16x32_bf16 v[124:127], v[56:59], v[92:95], v[124:127]
    ds_read_b64_tr_b16 v[44:45], v8 offset:64
    ds_read_b64_tr_b16 v[46:47], v8 offset:8512
    v_mfma_f32_16x16x32_bf16 v[128:131], v[56:59], v[96:99], v[128:131]
    ds_read_b64_tr_b16 v[48:49], v8 offset:96
    ds_read_b64_tr_b16 v[50:51], v8 offset:8544
    v_mfma_f32_16x16x32_bf16 v[132:135], v[60:63], v[84:87], v[132:135]
    v_mfma_f32_16x16x32_bf16 v[136:139], v[60:63], v[88:91], v[136:139]
    v_mfma_f32_16x16x32_bf16 v[140:143], v[60:63], v[92:95], v[140:143]
    v_mfma_f32_16x16x32_bf16 v[144:147], v[60:63], v[96:99], v[144:147]
    v_mfma_f32_16x16x32_bf16 v[148:151], v[64:67], v[84:87], v[148:151]
    v_mfma_f32_16x16x32_bf16 v[152:155], v[64:67], v[88:91], v[152:155]
    v_mfma_f32_16x16x32_bf16 v[156:159], v[64:67], v[92:95], v[156:159]
    v_mfma_f32_16x16x32_bf16 v[160:163], v[64:67], v[96:99], v[160:163]
    s_barrier
    s_add_u32 s50, s50, 1
    s_cmp_lt_u32 s50, 9
    s_cbranch_scc1 L_qkv_loop44
    s_waitcnt lgkmcnt(0)
    v_cvt_pk_bf16_f32 v36, v100, v101
    v_cvt_pk_bf16_f32 v37, v102, v103
    ds_write_b64 v20, v[36:37] offset:0
    v_cvt_pk_bf16_f32 v38, v104, v105
    v_cvt_pk_bf16_f32 v39, v106, v107
    ds_write_b64 v20, v[38:39] offset:256
    v_cvt_pk_bf16_f32 v40, v108, v109
    v_cvt_pk_bf16_f32 v41, v110, v111
    ds_write_b64 v20, v[40:41] offset:1024
    v_cvt_pk_bf16_f32 v42, v112, v113
    v_cvt_pk_bf16_f32 v43, v114, v115
    ds_write_b64 v20, v[42:43] offset:1280
    s_bitcmp1_b32 s44, 0
    s_cbranch_scc0 L_ed_14
    ds_write_b32 v24, v36 offset:0
    ds_write_b32 v24, v37 offset:4864
    ds_write_b32 v24, v38 offset:64
    ds_write_b32 v24, v39 offset:4928
    ds_write_b32 v24, v40 offset:128
    ds_write_b32 v24, v41 offset:4992
    ds_write_b32 v24, v42 offset:192
    ds_write_b32 v24, v43 offset:5056
L_ed_14:
    v_cvt_pk_bf16_f32 v44, v116, v117
    v_cvt_pk_bf16_f32 v45, v118, v119
    ds_write_b64 v21, v[44:45] offset:0
    v_cvt_pk_bf16_f32 v46, v120, v121
    v_cvt_pk_bf16_f32 v47, v122, v123
    ds_write_b64 v21, v[46:47] offset:256
    v_cvt_pk_bf16_f32 v48, v124, v125
    v_cvt_pk_bf16_f32 v49, v126, v127
    ds_write_b64 v21, v[48:49] offset:1024
    v_cvt_pk_bf16_f32 v50, v128, v129
    v_cvt_pk_bf16_f32 v51, v130, v131
    ds_write_b64 v21, v[50:51] offset:1280
    s_bitcmp1_b32 s44, 1
    s_cbranch_scc0 L_ed_15
    ds_write_b32 v25, v44 offset:0
    ds_write_b32 v25, v45 offset:4864
    ds_write_b32 v25, v46 offset:64
    ds_write_b32 v25, v47 offset:4928
    ds_write_b32 v25, v48 offset:128
    ds_write_b32 v25, v49 offset:4992
    ds_write_b32 v25, v50 offset:192
    ds_write_b32 v25, v51 offset:5056
L_ed_15:
    v_cvt_pk_bf16_f32 v52, v132, v133
    v_cvt_pk_bf16_f32 v53, v134, v135
    ds_write_b64 v22, v[52:53] offset:0
    v_cvt_pk_bf16_f32 v54, v136, v137
    v_cvt_pk_bf16_f32 v55, v138, v139
    ds_write_b64 v22, v[54:55] offset:256
    v_cvt_pk_bf16_f32 v56, v140, v141
    v_cvt_pk_bf16_f32 v57, v142, v143
    ds_write_b64 v22, v[56:57] offset:1024
    v_cvt_pk_bf16_f32 v58, v144, v145
    v_cvt_pk_bf16_f32 v59, v146, v147
    ds_write_b64 v22, v[58:59] offset:1280
    s_bitcmp1_b32 s44, 2
    s_cbranch_scc0 L_ed_16
    ds_write_b32 v26, v52 offset:0
    ds_write_b32 v26, v53 offset:4864
    ds_write_b32 v26, v54 offset:64
    ds_write_b32 v26, v55 offset:4928
    ds_write_b32 v26, v56 offset:128
    ds_write_b32 v26, v57 offset:4992
    ds_write_b32 v26, v58 offset:192
    ds_write_b32 v26, v59 offset:5056
L_ed_16:
    v_cvt_pk_bf16_f32 v60, v148, v149
    v_cvt_pk_bf16_f32 v61, v150, v151
    ds_write_b64 v23, v[60:61] offset:0
    v_cvt_pk_bf16_f32 v62, v152, v153
    v_cvt_pk_bf16_f32 v63, v154, v155
    ds_write_b64 v23, v[62:63] offset:256
    v_cvt_pk_bf16_f32 v64, v156, v157
    v_cvt_pk_bf16_f32 v65, v158, v159
    ds_write_b64 v23, v[64:65] offset:1024
    v_cvt_pk_bf16_f32 v66, v160, v161
    v_cvt_pk_bf16_f32 v67, v162, v163
    ds_write_b64 v23, v[66:67] offset:1280
    s_bitcmp1_b32 s44, 3
    s_cbranch_scc0 L_ed_17
    ds_write_b32 v27, v60 offset:0
    ds_write_b32 v27, v61 offset:4864
    ds_write_b32 v27, v62 offset:64
    ds_write_b32 v27, v63 offset:4928
    ds_write_b32 v27, v64 offset:128
    ds_write_b32 v27, v65 offset:4992
    ds_write_b32 v27, v66 offset:192
    ds_write_b32 v27, v67 offset:5056
L_ed_17:
    s_branch L_qkv_epi2
L_qkv_v41:
    s_barrier
    s_cmp_gt_u32 s24, 2
    s_cbranch_scc1 L_nopf_18
    v_mov_b32 v5, 0x80000000
    s_cmp_ge_u32 s24, 1
    s_cbranch_scc1 L_p0_19
    v_mul_u32_u24 v2, 13108, v1
    v_lshrrev_b32 v2, 16, v2
    v_mul_u32_u24 v3, 5, v2
    v_sub_u32 v3, v1, v3
    v_cmp_gt_u32 vcc, 40, v1
    s_lshl_b32 s31, s2, 3
    v_add_u32 v2, s31, v2
    v_mul_u32_u24 v2, 1152, v2
    v_add_u32 v3, 4, v3
    v_lshlrev_b32 v3, 7, v3
    v_add_u32 v2, v2, v3
    v_cndmask_b32 v2, v5, v2, vcc
    buffer_load_dword v164, v2, s[12:15], 0 offen
    s_branch L_nopf_18
L_p0_19:
    s_lshr_b32 s31, s2, 3
    s_lshl_b32 s31, s31, 2
    s_and_b32 s32, s2, 3
    s_add_u32 s31, s31, s32
    s_mul_i32 s31, s31, 68
    s_add_u32 s31, s31, 6912
    s_sub_u32 s32, s24, 1
    s_lshl_b32 s32, s32, 6
    v_add_u32 v2, s32, v1
    v_cmp_gt_u32 vcc, 68, v2
    v_add_u32 v2, s31, v2
    v_lshlrev_b32 v2, 7, v2
    v_cndmask_b32 v2, v5, v2, vcc
    buffer_load_dword v164, v2, s[16:19], 0 offen
L_nopf_18:
    ds_read_b128 v[68:71], v14 offset:0
    ds_read_b128 v[72:75], v14 offset:2048
    ds_read_b128 v[76:79], v14 offset:4096
    ds_read_b128 v[80:83], v14 offset:6144
    ds_read_b64_tr_b16 v[36:37], v10 offset:0
    ds_read_b64_tr_b16 v[38:39], v10 offset:8448
    ds_read_b64_tr_b16 v[40:41], v10 offset:32
    ds_read_b64_tr_b16 v[42:43], v10 offset:8480
    ds_read_b64_tr_b16 v[44:45], v10 offset:64
    ds_read_b64_tr_b16 v[46:47], v10 offset:8512
    ds_read_b64_tr_b16 v[48:49], v10 offset:96
    ds_read_b64_tr_b16 v[50:51], v10 offset:8544
L_qkv_loop41:
    s_waitcnt lgkmcnt(0)
    v_mfma_f32_16x16x32_bf16 v[100:103], v[36:39], v[68:71], v[100:103]
    v_add_u32 v9, s48, v10
    v_add_u32 v17, s49, v15
    v_mfma_f32_16x16x32_bf16 v[104:107], v[36:39], v[72:75], v[104:107]
    s_add_u32 s48, s48, 16896
    s_cmp_eq_u32 s48, 101376
    s_cselect_b32 s48, 0, s48
    v_mfma_f32_16x16x32_bf16 v[108:111], v[36:39], v[76:79], v[108:111]
    ds_read_b128 v[84:87], v17 offset:0
    ds_read_b128 v[88:91], v17 offset:2048
    v_mfma_f32_16x16x32_bf16 v[112:115], v[36:39], v[80:83], v[112:115]
    ds_read_b128 v[92:95], v17 offset:4096
    ds_read_b128 v[96:99], v17 offset:6144
    v_mfma_f32_16x16x32_bf16 v[116:119], v[68:71], v[40:43], v[116:119]
    ds_read_b64_tr_b16 v[52:53], v9 offset:0
    ds_read_b64_tr_b16 v[54:55], v9 offset:8448
    v_mfma_f32_16x16x32_bf16 v[120:123], v[72:75], v[40:43], v[120:123]
    ds_read_b64_tr_b16 v[56:57], v9 offset:32
    ds_read_b64_tr_b16 v[58:59], v9 offset:8480
    v_mfma_f32_16x16x32_bf16 v[124:127], v[76:79], v[40:43], v[124:127]
    ds_read_b64_tr_b16 v[60:61], v9 offset:64
    ds_read_b64_tr_b16 v[62:63], v9 offset:8512
    v_mfma_f32_16x16x32_bf16 v[128:131], v[80:83], v[40:43], v[128:131]
    ds_read_b64_tr_b16 v[64:65], v9 offset:96
    ds_read_b64_tr_b16 v[66:67], v9 offset:8544
    v_mfma_f32_16x16x32_bf16 v[132:135], v[68:71], v[44:47], v[132:135]
    v_mfma_f32_16x16x32_bf16 v[136:139], v[72:75], v[44:47], v[136:139]
    v_mfma_f32_16x16x32_bf16 v[140:143], v[76:79], v[44:47], v[140:143]
    v_mfma_f32_16x16x32_bf16 v[144:147], v[80:83], v[44:47], v[144:147]
    v_mfma_f32_16x16x32_bf16 v[148:151], v[68:71], v[48:51], v[148:151]
    v_mfma_f32_16x16x32_bf16 v[152:155], v[72:75], v[48:51], v[152:155]
    v_mfma_f32_16x16x32_bf16 v[156:159], v[76:79], v[48:51], v[156:159]
    v_mfma_f32_16x16x32_bf16 v[160:163], v[80:83], v[48:51], v[160:163]
    s_barrier
    s_waitcnt lgkmcnt(0)
    v_mfma_f32_16x16x32_bf16 v[100:103], v[52:55], v[84:87], v[100:103]
    v_add_u32 v8, s48, v10
    s_add_u32 s49, s49, 16384
    s_cmp_eq_u32 s49, 49152
    s_cselect_b32 s49, 0, s49
    v_add_u32 v16, s49, v14
    v_mfma_f32_16x16x32_bf16 v[104:107], v[52:55], v[88:91], v[104:107]
    s_add_u32 s48, s48, 16896
    s_cmp_eq_u32 s48, 101376
    s_cselect_b32 s48, 0, s48
    v_mfma_f32_16x16x32_bf16 v[108:111], v[52:55], v[92:95], v[108:111]
    ds_read_b128 v[68:71], v16 offset:0
    ds_read_b128 v[72:75], v16 offset:2048
    v_mfma_f32_16x16x32_bf16 v[112:115], v[52:55], v[96:99], v[112:115]
    ds_read_b128 v[76:79], v16 offset:4096
    ds_read_b128 v[80:83], v16 offset:6144
    v_mfma_f32_16x16x32_bf16 v[116:119], v[84:87], v[56:59], v[116:119]
    ds_read_b64_tr_b16 v[36:37], v8 offset:0
    ds_read_b64_tr_b16 v[38:39], v8 offset:8448
    v_mfma_f32_16x16x32_bf16 v[120:123], v[88:91], v[56:59], v[120:123]
    ds_read_b64_tr_b16 v[40:41], v8 offset:32
    ds_read_b64_tr_b16 v[42:43], v8 offset:8480
    v_mfma_f32_16x16x32_bf16 v[124:127], v[92:95], v[56:59], v[124:127]
    ds_read_b64_tr_b16 v[44:45], v8 offset:64
    ds_read_b64_tr_b16 v[46:47], v8 offset:8512
    v_mfma_f32_16x16x32_bf16 v[128:131], v[96:99], v[56:59], v[128:131]
    ds_read_b64_tr_b16 v[48:49], v8 offset:96
    ds_read_b64_tr_b16 v[50:51], v8 offset:8544
    v_mfma_f32_16x16x32_bf16 v[132:135], v[84:87], v[60:63], v[132:135]
    v_mfma_f32_16x16x32_bf16 v[136:139], v[88:91], v[60:63], v[136:139]
    v_mfma_f32_16x16x32_bf16 v[140:143], v[92:95], v[60:63], v[140:143]
    v_mfma_f32_16x16x32_bf16 v[144:147], v[96:99], v[60:63], v[144:147]
    v_mfma_f32_16x16x32_bf16 v[148:151], v[84:87], v[64:67], v[148:151]
    v_mfma_f32_16x16x32_bf16 v[152:155], v[88:91], v[64:67], v[152:155]
    v_mfma_f32_16x16x32_bf16 v[156:159], v[92:95], v[64:67], v[156:159]
    v_mfma_f32_16x16x32_bf16 v[160:163], v[96:99], v[64:67], v[160:163]
    s_barrier
    s_add_u32 s50, s50, 1
    s_cmp_lt_u32 s50, 9
    s_cbranch_scc1 L_qkv_loop41
    s_waitcnt lgkmcnt(0)
    v_cvt_pk_bf16_f32 v36, v100, v101
    v_cvt_pk_bf16_f32 v37, v102, v103
    ds_write_b64 v20, v[36:37] offset:0
    v_cvt_pk_bf16_f32 v38, v104, v105
    v_cvt_pk_bf16_f32 v39, v106, v107
    ds_write_b64 v20, v[38:39] offset:256
    v_cvt_pk_bf16_f32 v40, v108, v109
    v_cvt_pk_bf16_f32 v41, v110, v111
    ds_write_b64 v20, v[40:41] offset:1024
    v_cvt_pk_bf16_f32 v42, v112, v113
    v_cvt_pk_bf16_f32 v43, v114, v115
    ds_write_b64 v20, v[42:43] offset:1280
    s_bitcmp1_b32 s44, 0
    s_cbranch_scc0 L_ed_20
    ds_write_b32 v24, v36 offset:0
    ds_write_b32 v24, v37 offset:4864
    ds_write_b32 v24, v38 offset:64
    ds_write_b32 v24, v39 offset:4928
    ds_write_b32 v24, v40 offset:128
    ds_write_b32 v24, v41 offset:4992
    ds_write_b32 v24, v42 offset:192
    ds_write_b32 v24, v43 offset:5056
L_ed_20:
    v_cvt_pk_bf16_f32 v44, v116, v117
    v_cvt_pk_bf16_f32 v45, v118, v119
    ds_write_b64 v21, v[44:45] offset:0
    v_cvt_pk_bf16_f32 v46, v120, v121
    v_cvt_pk_bf16_f32 v47, v122, v123
    ds_write_b64 v21, v[46:47] offset:608
    v_cvt_pk_bf16_f32 v48, v124, v125
    v_cvt_pk_bf16_f32 v49, v126, v127
    ds_write_b64 v21, v[48:49] offset:1216
    v_cvt_pk_bf16_f32 v50, v128, v129
    v_cvt_pk_bf16_f32 v51, v130, v131
    ds_write_b64 v21, v[50:51] offset:1824
    v_cvt_pk_bf16_f32 v52, v132, v133
    v_cvt_pk_bf16_f32 v53, v134, v135
    ds_write_b64 v22, v[52:53] offset:0
    v_cvt_pk_bf16_f32 v54, v136, v137
    v_cvt_pk_bf16_f32 v55, v138, v139
    ds_write_b64 v22, v[54:55] offset:608
    v_cvt_pk_bf16_f32 v56, v140, v141
    v_cvt_pk_bf16_f32 v57, v142, v143
    ds_write_b64 v22, v[56:57] offset:1216
    v_cvt_pk_bf16_f32 v58, v144, v145
    v_cvt_pk_bf16_f32 v59, v146, v147
    ds_write_b64 v22, v[58:59] offset:1824
    v_cvt_pk_bf16_f32 v60, v148, v149
    v_cvt_pk_bf16_f32 v61, v150, v151
    ds_write_b64 v23, v[60:61] offset:0
    v_cvt_pk_bf16_f32 v62, v152, v153
    v_cvt_pk_bf16_f32 v63, v154, v155
    ds_write_b64 v23, v[62:63] offset:608
    v_cvt_pk_bf16_f32 v64, v156, v157
    v_cvt_pk_bf16_f32 v65, v158, v159
    ds_write_b64 v23, v[64:65] offset:1216
    v_cvt_pk_bf16_f32 v66, v160, v161
    v_cvt_pk_bf16_f32 v67, v162, v163
    ds_write_b64 v23, v[66:67] offset:1824
    s_branch L_qkv_epi2
L_qkv_v40:
    s_barrier
    s_cmp_gt_u32 s24, 2
    s_cbranch_scc1 L_nopf_21
    v_mov_b32 v5, 0x80000000
    s_cmp_ge_u32 s24, 1
    s_cbranch_scc1 L_p0_22
    v_mul_u32_u24 v2, 13108, v1
    v_lshrrev_b32 v2, 16, v2
    v_mul_u32_u24 v3, 5, v2
    v_sub_u32 v3, v1, v3
    v_cmp_gt_u32 vcc, 40, v1
    s_lshl_b32 s31, s2, 3
    v_add_u32 v2, s31, v2
    v_mul_u32_u24 v2, 1152, v2
    v_add_u32 v3, 4, v3
    v_lshlrev_b32 v3, 7, v3
    v_add_u32 v2, v2, v3
    v_cndmask_b32 v2, v5, v2, vcc
    buffer_load_dword v164, v2, s[12:15], 0 offen
    s_branch L_nopf_21
L_p0_22:
    s_lshr_b32 s31, s2, 3
    s_lshl_b32 s31, s31, 2
    s_and_b32 s32, s2, 3
    s_add_u32 s31, s31, s32
    s_mul_i32 s31, s31, 68
    s_add_u32 s31, s31, 6912
    s_sub_u32 s32, s24, 1
    s_lshl_b32 s32, s32, 6
    v_add_u32 v2, s32, v1
    v_cmp_gt_u32 vcc, 68, v2
    v_add_u32 v2, s31, v2
    v_lshlrev_b32 v2, 7, v2
    v_cndmask_b32 v2, v5, v2, vcc
    buffer_load_dword v164, v2, s[16:19], 0 offen
L_nopf_21:
    ds_read_b128 v[68:71], v14 offset:0
    ds_read_b128 v[72:75], v14 offset:2048
    ds_read_b128 v[76:79], v14 offset:4096
    ds_read_b128 v[80:83], v14 offset:6144
    ds_read_b64_tr_b16 v[36:37], v10 offset:0
    ds_read_b64_tr_b16 v[38:39], v10 offset:8448
    ds_read_b64_tr_b16 v[40:41], v10 offset:32
    ds_read_b64_tr_b16 v[42:43], v10 offset:8480
    ds_read_b64_tr_b16 v[44:45], v10 offset:64
    ds_read_b64_tr_b16 v[46:47], v10 offset:8512
    ds_read_b64_tr_b16 v[48:49], v10 offset:96
    ds_read_b64_tr_b16 v[50:51], v10 offset:8544
L_qkv_loop40:
    s_waitcnt lgkmcnt(0)
    v_mfma_f32_16x16x32_bf16 v[100:103], v[68:71], v[36:39], v[100:103]
    v_add_u32 v9, s48, v10
    v_add_u32 v17, s49, v15
    v_mfma_f32_16x16x32_bf16 v[104:107], v[72:75], v[36:39], v[104:107]
    s_add_u32 s48, s48, 16896
    s_cmp_eq_u32 s48, 101376
    s_cselect_b32 s48, 0, s48
    v_mfma_f32_16x16x32_bf16 v[108:111], v[76:79], v[36:39], v[108:111]
    ds_read_b128 v[84:87], v17 offset:0
    ds_read_b128 v[88:91], v17 offset:2048
    v_mfma_f32_16x16x32_bf16 v[112:115], v[80:83], v[36:39], v[112:115]
    ds_read_b128 v[92:95], v17 offset:4096
    ds_read_b128 v[96:99], v17 offset:6144
    v_mfma_f32_16x16x32_bf16 v[116:119], v[68:71], v[40:43], v[116:119]
    ds_read_b64_tr_b16 v[52:53], v9 offset:0
    ds_read_b64_tr_b16 v[54:55], v9 offset:8448
    v_mfma_f32_16x16x32_bf16 v[120:123], v[72:75], v[40:43], v[120:123]
    ds_read_b64_tr_b16 v[56:57], v9 offset:32
    ds_read_b64_tr_b16 v[58:59], v9 offset:8480
    v_mfma_f32_16x16x32_bf16 v[124:127], v[76:79], v[40:43], v[124:127]
    ds_read_b64_tr_b16 v[60:61], v9 offset:64
    ds_read_b64_tr_b16 v[62:63], v9 offset:8512
    v_mfma_f32_16x16x32_bf16 v[128:131], v[80:83], v[40:43], v[128:131]
    ds_read_b64_tr_b16 v[64:65], v9 offset:96
    ds_read_b64_tr_b16 v[66:67], v9 offset:8544
    v_mfma_f32_16x16x32_bf16 v[132:135], v[68:71], v[44:47], v[132:135]
    v_mfma_f32_16x16x32_bf16 v[136:139], v[72:75], v[44:47], v[136:139]
    v_mfma_f32_16x16x32_bf16 v[140:143], v[76:79], v[44:47], v[140:143]
    v_mfma_f32_16x16x32_bf16 v[144:147], v[80:83], v[44:47], v[144:147]
    v_mfma_f32_16x16x32_bf16 v[148:151], v[68:71], v[48:51], v[148:151]
    v_mfma_f32_16x16x32_bf16 v[152:155], v[72:75], v[48:51], v[152:155]
    v_mfma_f32_16x16x32_bf16 v[156:159], v[76:79], v[48:51], v[156:159]
    v_mfma_f32_16x16x32_bf16 v[160:163], v[80:83], v[48:51], v[160:163]
    s_barrier
    s_waitcnt lgkmcnt(0)
    v_mfma_f32_16x16x32_bf16 v[100:103], v[84:87], v[52:55], v[100:103]
    v_add_u32 v8, s48, v10
    s_add_u32 s49, s49, 16384
    s_cmp_eq_u32 s49, 49152
    s_cselect_b32 s49, 0, s49
    v_add_u32 v16, s49, v14
    v_mfma_f32_16x16x32_bf16 v[104:107], v[88:91], v[52:55], v[104:107]
    s_add_u32 s48, s48, 16896
    s_cmp_eq_u32 s48, 101376
    s_cselect_b32 s48, 0, s48
    v_mfma_f32_16x16x32_bf16 v[108:111], v[92:95], v[52:55], v[108:111]
    ds_read_b128 v[68:71], v16 offset:0
    ds_read_b128 v[72:75], v16 offset:2048
    v_mfma_f32_16x16x32_bf16 v[112:115], v[96:99], v[52:55], v[112:115]
    ds_read_b128 v[76:79], v16 offset:4096
    ds_read_b128 v[80:83], v16 offset:6144
    v_mfma_f32_16x16x32_bf16 v[116:119], v[84:87], v[56:59], v[116:119]
    ds_read_b64_tr_b16 v[36:37], v8 offset:0
    ds_read_b64_tr_b16 v[38:39], v8 offset:8448
    v_mfma_f32_16x16x32_bf16 v[120:123], v[88:91], v[56:59], v[120:123]
    ds_read_b64_tr_b16 v[40:41], v8 offset:32
    ds_read_b64_tr_b16 v[42:43], v8 offset:8480
    v_mfma_f32_16x16x32_bf16 v[124:127], v[92:95], v[56:59], v[124:127]
    ds_read_b64_tr_b16 v[44:45], v8 offset:64
    ds_read_b64_tr_b16 v[46:47], v8 offset:8512
    v_mfma_f32_16x16x32_bf16 v[128:131], v[96:99], v[56:59], v[128:131]
    ds_read_b64_tr_b16 v[48:49], v8 offset:96
    ds_read_b64_tr_b16 v[50:51], v8 offset:8544
    v_mfma_f32_16x16x32_bf16 v[132:135], v[84:87], v[60:63], v[132:135]
    v_mfma_f32_16x16x32_bf16 v[136:139], v[88:91], v[60:63], v[136:139]
    v_mfma_f32_16x16x32_bf16 v[140:143], v[92:95], v[60:63], v[140:143]
    v_mfma_f32_16x16x32_bf16 v[144:147], v[96:99], v[60:63], v[144:147]
    v_mfma_f32_16x16x32_bf16 v[148:151], v[84:87], v[64:67], v[148:151]
    v_mfma_f32_16x16x32_bf16 v[152:155], v[88:91], v[64:67], v[152:155]
    v_mfma_f32_16x16x32_bf16 v[156:159], v[92:95], v[64:67], v[156:159]
    v_mfma_f32_16x16x32_bf16 v[160:163], v[96:99], v[64:67], v[160:163]
    s_barrier
    s_add_u32 s50, s50, 1
    s_cmp_lt_u32 s50, 9
    s_cbranch_scc1 L_qkv_loop40
    s_waitcnt lgkmcnt(0)
    v_cvt_pk_bf16_f32 v36, v100, v101
    v_cvt_pk_bf16_f32 v37, v102, v103
    ds_write_b64 v20, v[36:37] offset:0
    v_cvt_pk_bf16_f32 v38, v104, v105
    v_cvt_pk_bf16_f32 v39, v106, v107
    ds_write_b64 v20, v[38:39] offset:608
    v_cvt_pk_bf16_f32 v40, v108, v109
    v_cvt_pk_bf16_f32 v41, v110, v111
    ds_write_b64 v20, v[40:41] offset:1216
    v_cvt_pk_bf16_f32 v42, v112, v113
    v_cvt_pk_bf16_f32 v43, v114, v115
    ds_write_b64 v20, v[42:43] offset:1824
    v_cvt_pk_bf16_f32 v44, v116, v117
    v_cvt_pk_bf16_f32 v45, v118, v119
    ds_write_b64 v21, v[44:45] offset:0
    v_cvt_pk_bf16_f32 v46, v120, v121
    v_cvt_pk_bf16_f32 v47, v122, v123
    ds_write_b64 v21, v[46:47] offset:608
    v_cvt_pk_bf16_f32 v48, v124, v125
    v_cvt_pk_bf16_f32 v49, v126, v127
    ds_write_b64 v21, v[48:49] offset:1216
    v_cvt_pk_bf16_f32 v50, v128, v129
    v_cvt_pk_bf16_f32 v51, v130, v131
    ds_write_b64 v21, v[50:51] offset:1824
    v_cvt_pk_bf16_f32 v52, v132, v133
    v_cvt_pk_bf16_f32 v53, v134, v135
    ds_write_b64 v22, v[52:53] offset:0
    v_cvt_pk_bf16_f32 v54, v136, v137
    v_cvt_pk_bf16_f32 v55, v138, v139
    ds_write_b64 v22, v[54:55] offset:608
    v_cvt_pk_bf16_f32 v56, v140, v141
    v_cvt_pk_bf16_f32 v57, v142, v143
    ds_write_b64 v22, v[56:57] offset:1216
    v_cvt_pk_bf16_f32 v58, v144, v145
    v_cvt_pk_bf16_f32 v59, v146, v147
    ds_write_b64 v22, v[58:59] offset:1824
    v_cvt_pk_bf16_f32 v60, v148, v149
    v_cvt_pk_bf16_f32 v61, v150, v151
    ds_write_b64 v23, v[60:61] offset:0
    v_cvt_pk_bf16_f32 v62, v152, v153
    v_cvt_pk_bf16_f32 v63, v154, v155
    ds_write_b64 v23, v[62:63] offset:608
    v_cvt_pk_bf16_f32 v64, v156, v157
    v_cvt_pk_bf16_f32 v65, v158, v159
    ds_write_b64 v23, v[64:65] offset:1216
    v_cvt_pk_bf16_f32 v66, v160, v161
    v_cvt_pk_bf16_f32 v67, v162, v163
    ds_write_b64 v23, v[66:67] offset:1824
    s_branch L_qkv_epi2
L_qkv_v33:
    s_barrier
    s_cmp_gt_u32 s24, 2
    s_cbranch_scc1 L_nopf_23
    v_mov_b32 v5, 0x80000000
    s_cmp_ge_u32 s24, 1
    s_cbranch_scc1 L_p0_24
    v_mul_u32_u24 v2, 13108, v1
    v_lshrrev_b32 v2, 16, v2
    v_mul_u32_u24 v3, 5, v2
    v_sub_u32 v3, v1, v3
    v_cmp_gt_u32 vcc, 40, v1
    s_lshl_b32 s31, s2, 3
    v_add_u32 v2, s31, v2
    v_mul_u32_u24 v2, 1152, v2
    v_add_u32 v3, 4, v3
    v_lshlrev_b32 v3, 7, v3
    v_add_u32 v2, v2, v3
    v_cndmask_b32 v2, v5, v2, vcc
    buffer_load_dword v164, v2, s[12:15], 0 offen
    s_branch L_nopf_23
L_p0_24:
    s_lshr_b32 s31, s2, 3
    s_lshl_b32 s31, s31, 2
    s_and_b32 s32, s2, 3
    s_add_u32 s31, s31, s32
    s_mul_i32 s31, s31, 68
    s_add_u32 s31, s31, 6912
    s_sub_u32 s32, s24, 1
    s_lshl_b32 s32, s32, 6
    v_add_u32 v2, s32, v1
    v_cmp_gt_u32 vcc, 68, v2
    v_add_u32 v2, s31, v2
    v_lshlrev_b32 v2, 7, v2
    v_cndmask_b32 v2, v5, v2, vcc
    buffer_load_dword v164, v2, s[16:19], 0 offen
L_nopf_23:
    ds_read_b128 v[68:71], v14 offset:0
    ds_read_b128 v[72:75], v14 offset:2048
    ds_read_b128 v[76:79], v14 offset:4096
    ds_read_b128 v[80:83], v14 offset:6144
    ds_read_b64_tr_b16 v[36:37], v10 offset:0
    ds_read_b64_tr_b16 v[38:39], v10 offset:8448
    ds_read_b64_tr_b16 v[40:41], v10 offset:32
    ds_read_b64_tr_b16 v[42:43], v10 offset:8480
    ds_read_b64_tr_b16 v[44:45], v10 offset:64
    ds_read_b64_tr_b16 v[46:47], v10 offset:8512
L_qkv_loop33:
    s_waitcnt lgkmcnt(0)
    v_mfma_f32_16x16x32_bf16 v[100:103], v[36:39], v[68:71], v[100:103]
    v_add_u32 v9, s48, v10
    v_add_u32 v17, s49, v15
    v_mfma_f32_16x16x32_bf16 v[104:107], v[36:39], v[72:75], v[104:107]
    s_add_u32 s48, s48, 16896
    s_cmp_eq_u32 s48, 101376
    s_cselect_b32 s48, 0, s48
    v_mfma_f32_16x16x32_bf16 v[108:111], v[36:39], v[76:79], v[108:111]
    ds_read_b128 v[84:87], v17 offset:0
    ds_read_b128 v[88:91], v17 offset:2048
    v_mfma_f32_16x16x32_bf16 v[112:115], v[36:39], v[80:83], v[112:115]
    ds_read_b128 v[92:95], v17 offset:4096
    ds_read_b128 v[96:99], v17 offset:6144
    v_mfma_f32_16x16x32_bf16 v[116:119], v[40:43], v[68:71], v[116:119]
    ds_read_b64_tr_b16 v[52:53], v9 offset:0
    ds_read_b64_tr_b16 v[54:55], v9 offset:8448
    v_mfma_f32_16x16x32_bf16 v[120:123], v[40:43], v[72:75], v[120:123]
    ds_read_b64_tr_b16 v[56:57], v9 offset:32
    ds_read_b64_tr_b16 v[58:59], v9 offset:8480
    v_mfma_f32_16x16x32_bf16 v[124:127], v[40:43], v[76:79], v[124:127]
    ds_read_b64_tr_b16 v[60:61], v9 offset:64
    ds_read_b64_tr_b16 v[62:63], v9 offset:8512
    v_mfma_f32_16x16x32_bf16 v[128:131], v[40:43], v[80:83], v[128:131]
    v_mfma_f32_16x16x32_bf16 v[132:135], v[44:47], v[68:71], v[132:135]
    v_mfma_f32_16x16x32_bf16 v[136:139], v[44:47], v[72:75], v[136:139]
    v_mfma_f32_16x16x32_bf16 v[140:143], v[44:47], v[76:79], v[140:143]
    v_mfma_f32_16x16x32_bf16 v[144:147], v[44:47], v[80:83], v[144:147]
    s_barrier
    s_waitcnt lgkmcnt(0)
    v_mfma_f32_16x16x32_bf16 v[100:103], v[52:55], v[84:87], v[100:103]
    v_add_u32 v8, s48, v10
    s_add_u32 s49, s49, 16384
    s_cmp_eq_u32 s49, 49152
    s_cselect_b32 s49, 0, s49
    v_add_u32 v16, s49, v14
    v_mfma_f32_16x16x32_bf16 v[104:107], v[52:55], v[88:91], v[104:107]
    s_add_u32 s48, s48, 16896
    s_cmp_eq_u32 s48, 101376
    s_cselect_b32 s48, 0, s48
    v_mfma_f32_16x16x32_bf16 v[108:111], v[52:55], v[92:95], v[108:111]
    ds_read_b128 v[68:71], v16 offset:0
    ds_read_b128 v[72:75], v16 offset:2048
    v_mfma_f32_16x16x32_bf16 v[112:115], v[52:55], v[96:99], v[112:115]
    ds_read_b128 v[76:79], v16 offset:4096
    ds_read_b128 v[80:83], v16 offset:6144
    v_mfma_f32_16x16x32_bf16 v[116:119], v[56:59], v[84:87], v[116:119]
    ds_read_b64_tr_b16 v[36:37], v8 offset:0
    ds_read_b64_tr_b16 v[38:39], v8 offset:8448
    v_mfma_f32_16x16x32_bf16 v[120:123], v[56:59], v[88:91], v[120:123]
    ds_read_b64_tr_b16 v[40:41], v8 offset:32
    ds_read_b64_tr_b16 v[42:43], v8 offset:8480
    v_mfma_f32_16x16x32_bf16 v[124:127], v[56:59], v[92:95], v[124:127]
    ds_read_b64_tr_b16 v[44:45], v8 offset:64
    ds_read_b64_tr_b16 v[46:47], v8 offset:8512
    v_mfma_f32_16x16x32_bf16 v[128:131], v[56:59], v[96:99], v[128:131]
    v_mfma_f32_16x16x32_bf16 v[132:135], v[60:63], v[84:87], v[132:135]
    v_mfma_f32_16x16x32_bf16 v[136:139], v[60:63], v[88:91], v[136:139]
    v_mfma_f32_16x16x32_bf16 v[140:143], v[60:63], v[92:95], v[140:143]
    v_mfma_f32_16x16x32_bf16 v[144:147], v[60:63], v[96:99], v[144:147]
    s_barrier
    s_add_u32 s50, s50, 1
    s_cmp_lt_u32 s50, 9
    s_cbranch_scc1 L_qkv_loop33
    s_waitcnt lgkmcnt(0)
    v_cvt_pk_bf16_f32 v36, v100, v101
    v_cvt_pk_bf16_f32 v37, v102, v103
    ds_write_b64 v20, v[36:37] offset:0
    v_cvt_pk_bf16_f32 v38, v104, v105
    v_cvt_pk_bf16_f32 v39, v106, v107
    ds_write_b64 v20, v[38:39] offset:256
    v_cvt_pk_bf16_f32 v40, v108, v109
    v_cvt_pk_bf16_f32 v41, v110, v111
    ds_write_b64 v20, v[40:41] offset:1024
    v_cvt_pk_bf16_f32 v42, v112, v113
    v_cvt_pk_bf16_f32 v43, v114, v115
    ds_write_b64 v20, v[42:43] offset:1280
    s_bitcmp1_b32 s44, 0
    s_cbranch_scc0 L_ed_25
    ds_write_b32 v24, v36 offset:0
    ds_write_b32 v24, v37 offset:4864
    ds_write_b32 v24, v38 offset:64
    ds_write_b32 v24, v39 offset:4928
    ds_write_b32 v24, v40 offset:128
    ds_write_b32 v24, v41 offset:4992
    ds_write_b32 v24, v42 offset:192
    ds_write_b32 v24, v43 offset:5056
L_ed_25:
    v_cvt_pk_bf16_f32 v44, v116, v117
    v_cvt_pk_bf16_f32 v45, v118, v119
    ds_write_b64 v21, v[44:45] offset:0
    v_cvt_pk_bf16_f32 v46, v120, v121
    v_cvt_pk_bf16_f32 v47, v122, v123
    ds_write_b64 v21, v[46:47] offset:256
    v_cvt_pk_bf16_f32 v48, v124, v125
    v_cvt_pk_bf16_f32 v49, v126, v127
    ds_write_b64 v21, v[48:49] offset:1024
    v_cvt_pk_bf16_f32 v50, v128, v129
    v_cvt_pk_bf16_f32 v51, v130, v131
    ds_write_b64 v21, v[50:51] offset:1280
    s_bitcmp1_b32 s44, 1
    s_cbranch_scc0 L_ed_26
    ds_write_b32 v25, v44 offset:0
    ds_write_b32 v25, v45 offset:4864
    ds_write_b32 v25, v46 offset:64
    ds_write_b32 v25, v47 offset:4928
    ds_write_b32 v25, v48 offset:128
    ds_write_b32 v25, v49 offset:4992
    ds_write_b32 v25, v50 offset:192
    ds_write_b32 v25, v51 offset:5056
L_ed_26:
    v_cvt_pk_bf16_f32 v52, v132, v133
    v_cvt_pk_bf16_f32 v53, v134, v135
    ds_write_b64 v22, v[52:53] offset:0
    v_cvt_pk_bf16_f32 v54, v136, v137
    v_cvt_pk_bf16_f32 v55, v138, v139
    ds_write_b64 v22, v[54:55] offset:256
    v_cvt_pk_bf16_f32 v56, v140, v141
    v_cvt_pk_bf16_f32 v57, v142, v143
    ds_write_b64 v22, v[56:57] offset:1024
    v_cvt_pk_bf16_f32 v58, v144, v145
    v_cvt_pk_bf16_f32 v59, v146, v147
    ds_write_b64 v22, v[58:59] offset:1280
    s_bitcmp1_b32 s44, 2
    s_cbranch_scc0 L_ed_27
    ds_write_b32 v26, v52 offset:0
    ds_write_b32 v26, v53 offset:4864
    ds_write_b32 v26, v54 offset:64
    ds_write_b32 v26, v55 offset:4928
    ds_write_b32 v26, v56 offset:128
    ds_write_b32 v26, v57 offset:4992
    ds_write_b32 v26, v58 offset:192
    ds_write_b32 v26, v59 offset:5056
L_ed_27:
    s_branch L_qkv_epi2
L_qkv_v30:
    s_barrier
    s_cmp_gt_u32 s24, 2
    s_cbranch_scc1 L_nopf_28
    v_mov_b32 v5, 0x80000000
    s_cmp_ge_u32 s24, 1
    s_cbranch_scc1 L_p0_29
    v_mul_u32_u24 v2, 13108, v1
    v_lshrrev_b32 v2, 16, v2
    v_mul_u32_u24 v3, 5, v2
    v_sub_u32 v3, v1, v3
    v_cmp_gt_u32 vcc, 40, v1
    s_lshl_b32 s31, s2, 3
    v_add_u32 v2, s31, v2
    v_mul_u32_u24 v2, 1152, v2
    v_add_u32 v3, 4, v3
    v_lshlrev_b32 v3, 7, v3
    v_add_u32 v2, v2, v3
    v_cndmask_b32 v2, v5, v2, vcc
    buffer_load_dword v164, v2, s[12:15], 0 offen
    s_branch L_nopf_28
L_p0_29:
    s_lshr_b32 s31, s2, 3
    s_lshl_b32 s31, s31, 2
    s_and_b32 s32, s2, 3
    s_add_u32 s31, s31, s32
    s_mul_i32 s31, s31, 68
    s_add_u32 s31, s31, 6912
    s_sub_u32 s32, s24, 1
    s_lshl_b32 s32, s32, 6
    v_add_u32 v2, s32, v1
    v_cmp_gt_u32 vcc, 68, v2
    v_add_u32 v2, s31, v2
    v_lshlrev_b32 v2, 7, v2
    v_cndmask_b32 v2, v5, v2, vcc
    buffer_load_dword v164, v2, s[16:19], 0 offen
L_nopf_28:
    ds_read_b128 v[68:71], v14 offset:0
    ds_read_b128 v[72:75], v14 offset:2048
    ds_read_b128 v[76:79], v14 offset:4096
    ds_read_b128 v[80:83], v14 offset:6144
    ds_read_b64_tr_b16 v[36:37], v10 offset:0
    ds_read_b64_tr_b16 v[38:39], v10 offset:8448
    ds_read_b64_tr_b16 v[40:41], v10 offset:32
    ds_read_b64_tr_b16 v[42:43], v10 offset:8480
    ds_read_b64_tr_b16 v[44:45], v10 offset:64
    ds_read_b64_tr_b16 v[46:47], v10 offset:8512
L_qkv_loop30:
    s_waitcnt lgkmcnt(0)
    v_mfma_f32_16x16x32_bf16 v[100:103], v[68:71], v[36:39], v[100:103]
    v_add_u32 v9, s48, v10
    v_add_u32 v17, s49, v15
    v_mfma_f32_16x16x32_bf16 v[104:107], v[72:75], v[36:39], v[104:107]
    s_add_u32 s48, s48, 16896
    s_cmp_eq_u32 s48, 101376
    s_cselect_b32 s48, 0, s48
    v_mfma_f32_16x16x32_bf16 v[108:111], v[76:79], v[36:39], v[108:111]
    ds_read_b128 v[84:87], v17 offset:0
    ds_read_b128 v[88:91], v17 offset:2048
    v_mfma_f32_16x16x32_bf16 v[112:115], v[80:83], v[36:39], v[112:115]
    ds_read_b128 v[92:95], v17 offset:4096
    ds_read_b128 v[96:99], v17 offset:6144
    v_mfma_f32_16x16x32_bf16 v[116:119], v[68:71], v[40:43], v[116:119]
    ds_read_b64_tr_b16 v[52:53], v9 offset:0
    ds_read_b64_tr_b16 v[54:55], v9 offset:8448
    v_mfma_f32_16x16x32_bf16 v[120:123], v[72:75], v[40:43], v[120:123]
    ds_read_b64_tr_b16 v[56:57], v9 offset:32
    ds_read_b64_tr_b16 v[58:59], v9 offset:8480
    v_mfma_f32_16x16x32_bf16 v[124:127], v[76:79], v[40:43], v[124:127]
    ds_read_b64_tr_b16 v[60:61], v9 offset:64
    ds_read_b64_tr_b16 v[62:63], v9 offset:8512
    v_mfma_f32_16x16x32_bf16 v[128:131], v[80:83], v[40:43], v[128:131]
    v_mfma_f32_16x16x32_bf16 v[132:135], v[68:71], v[44:47], v[132:135]
    v_mfma_f32_16x16x32_bf16 v[136:139], v[72:75], v[44:47], v[136:139]
    v_mfma_f32_16x16x32_bf16 v[140:143], v[76:79], v[44:47], v[140:143]
    v_mfma_f32_16x16x32_bf16 v[144:147], v[80:83], v[44:47], v[144:147]
    s_barrier
    s_waitcnt lgkmcnt(0)
    v_mfma_f32_16x16x32_bf16 v[100:103], v[84:87], v[52:55], v[100:103]
    v_add_u32 v8, s48, v10
    s_add_u32 s49, s49, 16384
    s_cmp_eq_u32 s49, 49152
    s_cselect_b32 s49, 0, s49
    v_add_u32 v16, s49, v14
    v_mfma_f32_16x16x32_bf16 v[104:107], v[88:91], v[52:55], v[104:107]
    s_add_u32 s48, s48, 16896
    s_cmp_eq_u32 s48, 101376
    s_cselect_b32 s48, 0, s48
    v_mfma_f32_16x16x32_bf16 v[108:111], v[92:95], v[52:55], v[108:111]
    ds_read_b128 v[68:71], v16 offset:0
    ds_read_b128 v[72:75], v16 offset:2048
    v_mfma_f32_16x16x32_bf16 v[112:115], v[96:99], v[52:55], v[112:115]
    ds_read_b128 v[76:79], v16 offset:4096
    ds_read_b128 v[80:83], v16 offset:6144
    v_mfma_f32_16x16x32_bf16 v[116:119], v[84:87], v[56:59], v[116:119]
    ds_read_b64_tr_b16 v[36:37], v8 offset:0
    ds_read_b64_tr_b16 v[38:39], v8 offset:8448
    v_mfma_f32_16x16x32_bf16 v[120:123], v[88:91], v[56:59], v[120:123]
    ds_read_b64_tr_b16 v[40:41], v8 offset:32
    ds_read_b64_tr_b16 v[42:43], v8 offset:8480
    v_mfma_f32_16x16x32_bf16 v[124:127], v[92:95], v[56:59], v[124:127]
    ds_read_b64_tr_b16 v[44:45], v8 offset:64
    ds_read_b64_tr_b16 v[46:47], v8 offset:8512
    v_mfma_f32_16x16x32_bf16 v[128:131], v[96:99], v[56:59], v[128:131]
    v_mfma_f32_16x16x32_bf16 v[132:135], v[84:87], v[60:63], v[132:135]
    v_mfma_f32_16x16x32_bf16 v[136:139], v[88:91], v[60:63], v[136:139]
    v_mfma_f32_16x16x32_bf16 v[140:143], v[92:95], v[60:63], v[140:143]
    v_mfma_f32_16x16x32_bf16 v[144:147], v[96:99], v[60:63], v[144:147]
    s_barrier
    s_add_u32 s50, s50, 1
    s_cmp_lt_u32 s50, 9
    s_cbranch_scc1 L_qkv_loop30
    s_waitcnt lgkmcnt(0)
    v_cvt_pk_bf16_f32 v36, v100, v101
    v_cvt_pk_bf16_f32 v37, v102, v103
    ds_write_b64 v20, v[36:37] offset:0
    v_cvt_pk_bf16_f32 v38, v104, v105
    v_cvt_pk_bf16_f32 v39, v106, v107
    ds_write_b64 v20, v[38:39] offset:608
    v_cvt_pk_bf16_f32 v40, v108, v109
    v_cvt_pk_bf16_f32 v41, v110, v111
    ds_write_b64 v20, v[40:41] offset:1216
    v_cvt_pk_bf16_f32 v42, v112, v113
    v_cvt_pk_bf16_f32 v43, v114, v115
    ds_write_b64 v20, v[42:43] offset:1824
    v_cvt_pk_bf16_f32 v44, v116, v117
    v_cvt_pk_bf16_f32 v45, v118, v119
    ds_write_b64 v21, v[44:45] offset:0
    v_cvt_pk_bf16_f32 v46, v120, v121
    v_cvt_pk_bf16_f32 v47, v122, v123
    ds_write_b64 v21, v[46:47] offset:608
    v_cvt_pk_bf16_f32 v48, v124, v125
    v_cvt_pk_bf16_f32 v49, v126, v127
    ds_write_b64 v21, v[48:49] offset:1216
    v_cvt_pk_bf16_f32 v50, v128, v129
    v_cvt_pk_bf16_f32 v51, v130, v131
    ds_write_b64 v21, v[50:51] offset:1824
    v_cvt_pk_bf16_f32 v52, v132, v133
    v_cvt_pk_bf16_f32 v53, v134, v135
    ds_write_b64 v22, v[52:53] offset:0
    v_cvt_pk_bf16_f32 v54, v136, v137
    v_cvt_pk_bf16_f32 v55, v138, v139
    ds_write_b64 v22, v[54:55] offset:608
    v_cvt_pk_bf16_f32 v56, v140, v141
    v_cvt_pk_bf16_f32 v57, v142, v143
    ds_write_b64 v22, v[56:57] offset:1216
    v_cvt_pk_bf16_f32 v58, v144, v145
    v_cvt_pk_bf16_f32 v59, v146, v147
    ds_write_b64 v22, v[58:59] offset:1824
    s_branch L_qkv_epi2
L_qkv_epi2:
    s_cmp_ge_u32 s24, 4
    s_cbranch_scc1 L_qkv_noones
    v_lshrrev_b32 v32, 2, v1
    v_mul_u32_u24 v33, 18, v32
    s_lshl_b32 s31, s37, 4
    s_add_i32 s31, s31, s36
    s_cmp_eq_u32 s37, 14
    s_cselect_b32 s31, 1000, s31
    s_max_i32 s31, s31, 0
    v_cmp_le_u32 vcc, s31, v33
    v_cmp_gt_u32 s[38:39], 12, v32
    s_and_b64 vcc, vcc, s[38:39]
    v_mul_u32_u24 v32, 4864, v32
    v_and_b32 v33, 3, v1
    v_mul_u32_u24 v33, 304, v33
    v_add_u32 v32, v32, v33
    s_mul_i32 s31, s24, 1216
    s_add_u32 s31, s31, 288
    v_add_u32 v32, s31, v32
    v_cndmask_b32 v32, v13, v32, vcc
    v_mov_b32 v28, 0x3f803f80
    v_mov_b32 v29, 0x3f803f80
    v_mov_b32 v30, 0x3f803f80
    v_mov_b32 v31, 0x3f803f80
    ds_write_b128 v32, v[28:31]
L_qkv_noones:
    s_waitcnt lgkmcnt(0)
    s_barrier
    s_branch L_qkv_copy
L_qkv_loader:
    s_sub_u32 s29, s24, 8
    s_lshl_b32 s34, s35, 1
    s_and_b32 s34, s34, 0xffffffc0
    v_lshrrev_b32 v2, 5, v1
    v_mul_u32_u24 v2, 55296, v2
    v_and_b32 v6, 31, v1
    v_lshlrev_b32 v6, 4, v6
    v_add_u32 v2, v2, v6
    v_add_u32 v14, s34, v2
    v_lshrrev_b32 v2, 3, v1
    v_lshrrev_b32 v3, 4, v1
    s_and_b32 s31, s29, 1
    s_lshl_b32 s31, s31, 2
    v_add_u32 v3, s31, v3
    v_and_b32 v4, 7, v1
    v_xor_b32 v3, v3, v4
    v_lshlrev_b32 v3, 4, v3
    s_lshl_b32 s31, s26, 7
    s_lshl_b32 s32, s29, 3
    s_add_u32 s31, s31, s32
    v_add_u32 v2, s31, v2
    v_mul_u32_u24 v2, 1152, v2
    v_add_u32 v18, v2, v3
    s_mul_i32 s33, s29, 1056
    s_lshl_b32 s34, s29, 10
    s_mul_i32 s59, s29, 3456
    s_add_u32 s31, s34, 101376
    s_mov_b32 m0, s31
    s_mov_b32 s32, 0
    buffer_load_dwordx4 v18, s[12:15], s32 offen lds
    s_add_u32 s31, s34, 105472
    s_mov_b32 m0, s31
    s_mov_b32 s32, 36864
    buffer_load_dwordx4 v18, s[12:15], s32 offen lds
    s_add_u32 s31, s34, 109568
    s_mov_b32 m0, s31
    s_mov_b32 s32, 73728
    buffer_load_dwordx4 v18, s[12:15], s32 offen lds
    s_add_u32 s31, s34, 113664
    s_mov_b32 m0, s31
    s_mov_b32 s32, 110592
    buffer_load_dwordx4 v18, s[12:15], s32 offen lds
    s_add_u32 s31, s33, 0
    s_mov_b32 m0, s31
    s_add_u32 s32, s59, 0
    buffer_load_dwordx4 v14, s[16:19], s32 offen lds
    s_add_u32 s31, s33, 4224
    s_mov_b32 m0, s31
    s_add_u32 s32, s59, 27648
    buffer_load_dwordx4 v14, s[16:19], s32 offen lds
    s_add_u32 s31, s33, 8448
    s_mov_b32 m0, s31
    s_add_u32 s32, s59, 13824
    buffer_load_dwordx4 v14, s[16:19], s32 offen lds
    s_add_u32 s31, s33, 12672
    s_mov_b32 m0, s31
    s_add_u32 s32, s59, 41472
    buffer_load_dwordx4 v14, s[16:19], s32 offen lds
    s_add_u32 s31, s33, 16896
    s_mov_b32 m0, s31
    s_add_u32 s32, s59, 110592
    buffer_load_dwordx4 v14, s[16:19], s32 offen lds
    s_add_u32 s31, s33, 21120
    s_mov_b32 m0, s31
    s_add_u32 s32, s59, 138240
    buffer_load_dwordx4 v14, s[16:19], s32 offen lds
    s_add_u32 s31, s33, 25344
    s_mov_b32 m0, s31
    s_add_u32 s32, s59, 124416
    buffer_load_dwordx4 v14, s[16:19], s32 offen lds
    s_add_u32 s31, s33, 29568
    s_mov_b32 m0, s31
    s_add_u32 s32, s59, 152064
    buffer_load_dwordx4 v14, s[16:19], s32 offen lds
    s_add_u32 s31, s33, 33792
    s_mov_b32 m0, s31
    s_add_u32 s32, s59, 221184
    buffer_load_dwordx4 v14, s[16:19], s32 offen lds
    s_add_u32 s31, s33, 38016
    s_mov_b32 m0, s31
    s_add_u32 s32, s59, 248832
    buffer_load_dwordx4 v14, s[16:19], s32 offen lds
    s_add_u32 s31, s33, 42240
    s_mov_b32 m0, s31
    s_add_u32 s32, s59, 235008
    buffer_load_dwordx4 v14, s[16:19], s32 offen lds
    s_add_u32 s31, s33, 46464
    s_mov_b32 m0, s31
    s_add_u32 s32, s59, 262656
    buffer_load_dwordx4 v14, s[16:19], s32 offen lds
    s_add_u32 s31, s34, 117760
    s_mov_b32 m0, s31
    s_mov_b32 s32, 128
    buffer_load_dwordx4 v18, s[12:15], s32 offen lds
    s_add_u32 s31, s34, 121856
    s_mov_b32 m0, s31
    s_mov_b32 s32, 36992
    buffer_load_dwordx4 v18, s[12:15], s32 offen lds
    s_add_u32 s31, s34, 125952
    s_mov_b32 m0, s31
    s_mov_b32 s32, 73856
    buffer_load_dwordx4 v18, s[12:15], s32 offen lds
    s_add_u32 s31, s34, 130048
    s_mov_b32 m0, s31
    s_mov_b32 s32, 110720
    buffer_load_dwordx4 v18, s[12:15], s32 offen lds
    s_waitcnt vmcnt(8)
    s_barrier
    s_add_u32 s31, s33, 50688
    s_mov_b32 m0, s31
    s_add_u32 s32, s59, 331776
    buffer_load_dwordx4 v14, s[16:19], s32 offen lds
    s_add_u32 s31, s33, 54912
    s_mov_b32 m0, s31
    s_add_u32 s32, s59, 359424
    buffer_load_dwordx4 v14, s[16:19], s32 offen lds
    s_add_u32 s31, s33, 59136
    s_mov_b32 m0, s31
    s_add_u32 s32, s59, 345600
    buffer_load_dwordx4 v14, s[16:19], s32 offen lds
    s_add_u32 s31, s33, 63360
    s_mov_b32 m0, s31
    s_add_u32 s32, s59, 373248
    buffer_load_dwordx4 v14, s[16:19], s32 offen lds
    s_add_u32 s31, s33, 67584
    s_mov_b32 m0, s31
    s_add_u32 s32, s59, 442368
    buffer_load_dwordx4 v14, s[16:19], s32 offen lds
    s_add_u32 s31, s33, 71808
    s_mov_b32 m0, s31
    s_add_u32 s32, s59, 470016
    buffer_load_dwordx4 v14, s[16:19], s32 offen lds
    s_add_u32 s31, s33, 76032
    s_mov_b32 m0, s31
    s_add_u32 s32, s59, 456192
    buffer_load_dwordx4 v14, s[16:19], s32 offen lds
    s_add_u32 s31, s33, 80256
    s_mov_b32 m0, s31
    s_add_u32 s32, s59, 483840
    buffer_load_dwordx4 v14, s[16:19], s32 offen lds
    s_add_u32 s31, s34, 134144
    s_mov_b32 m0, s31
    s_mov_b32 s32, 256
    buffer_load_dwordx4 v18, s[12:15], s32 offen lds
    s_add_u32 s31, s34, 138240
    s_mov_b32 m0, s31
    s_mov_b32 s32, 37120
    buffer_load_dwordx4 v18, s[12:15], s32 offen lds
    s_add_u32 s31, s34, 142336
    s_mov_b32 m0, s31
    s_mov_b32 s32, 73984
    buffer_load_dwordx4 v18, s[12:15], s32 offen lds
    s_add_u32 s31, s34, 146432
    s_mov_b32 m0, s31
    s_mov_b32 s32, 110848
    buffer_load_dwordx4 v18, s[12:15], s32 offen lds
    s_add_u32 s31, s33, 84480
    s_mov_b32 m0, s31
    s_add_u32 s32, s59, 552960
    buffer_load_dwordx4 v14, s[16:19], s32 offen lds
    s_add_u32 s31, s33, 88704
    s_mov_b32 m0, s31
    s_add_u32 s32, s59, 580608
    buffer_load_dwordx4 v14, s[16:19], s32 offen lds
    s_add_u32 s31, s33, 92928
    s_mov_b32 m0, s31
    s_add_u32 s32, s59, 566784
    buffer_load_dwordx4 v14, s[16:19], s32 offen lds
    s_add_u32 s31, s33, 97152
    s_mov_b32 m0, s31
    s_add_u32 s32, s59, 594432
    buffer_load_dwordx4 v14, s[16:19], s32 offen lds
    s_waitcnt vmcnt(16)
    s_barrier
    s_add_u32 s31, s33, 0
    s_mov_b32 m0, s31
    s_add_u32 s32, s59, 663552
    buffer_load_dwordx4 v14, s[16:19], s32 offen lds
    s_add_u32 s31, s33, 4224
    s_mov_b32 m0, s31
    s_add_u32 s32, s59, 691200
    buffer_load_dwordx4 v14, s[16:19], s32 offen lds
    s_add_u32 s31, s33, 8448
    s_mov_b32 m0, s31
    s_add_u32 s32, s59, 677376
    buffer_load_dwordx4 v14, s[16:19], s32 offen lds
    s_add_u32 s31, s33, 12672
    s_mov_b32 m0, s31
    s_add_u32 s32, s59, 705024
    buffer_load_dwordx4 v14, s[16:19], s32 offen lds
    s_waitcnt vmcnt(16)
    s_barrier
    s_add_u32 s31, s33, 16896
    s_mov_b32 m0, s31
    s_add_u32 s32, s59, 774144
    buffer_load_dwordx4 v14, s[16:19], s32 offen lds
    s_add_u32 s31, s33, 21120
    s_mov_b32 m0, s31
    s_add_u32 s32, s59, 801792
    buffer_load_dwordx4 v14, s[16:19], s32 offen lds
    s_add_u32 s31, s33, 25344
    s_mov_b32 m0, s31
    s_add_u32 s32, s59, 787968
    buffer_load_dwordx4 v14, s[16:19], s32 offen lds
    s_add_u32 s31, s33, 29568
    s_mov_b32 m0, s31
    s_add_u32 s32, s59, 815616
    buffer_load_dwordx4 v14, s[16:19], s32 offen lds
    s_add_u32 s31, s34, 101376
    s_mov_b32 m0, s31
    s_mov_b32 s32, 384
    buffer_load_dwordx4 v18, s[12:15], s32 offen lds
    s_add_u32 s31, s34, 105472
    s_mov_b32 m0, s31
    s_mov_b32 s32, 37248
    buffer_load_dwordx4 v18, s[12:15], s32 offen lds
    s_add_u32 s31, s34, 109568
    s_mov_b32 m0, s31
    s_mov_b32 s32, 74112
    buffer_load_dwordx4 v18, s[12:15], s32 offen lds
    s_add_u32 s31, s34, 113664
    s_mov_b32 m0, s31
    s_mov_b32 s32, 110976
    buffer_load_dwordx4 v18, s[12:15], s32 offen lds
    s_waitcnt vmcnt(16)
    s_barrier
    s_add_u32 s31, s33, 33792
    s_mov_b32 m0, s31
    s_add_u32 s32, s59, 884736
    buffer_load_dwordx4 v14, s[16:19], s32 offen lds
    s_add_u32 s31, s33, 38016
    s_mov_b32 m0, s31
    s_add_u32 s32, s59, 912384
    buffer_load_dwordx4 v14, s[16:19], s32 offen lds
    s_add_u32 s31, s33, 42240
    s_mov_b32 m0, s31
    s_add_u32 s32, s59, 898560
    buffer_load_dwordx4 v14, s[16:19], s32 offen lds
    s_add_u32 s31, s33, 46464
    s_mov_b32 m0, s31
    s_add_u32 s32, s59, 926208
    buffer_load_dwordx4 v14, s[16:19], s32 offen lds
    s_waitcnt vmcnt(16)
    s_barrier
    s_add_u32 s31, s33, 50688
    s_mov_b32 m0, s31
    s_add_u32 s32, s59, 995328
    buffer_load_dwordx4 v14, s[16:19], s32 offen lds
    s_add_u32 s31, s33, 54912
    s_mov_b32 m0, s31
    s_add_u32 s32, s59, 1022976
    buffer_load_dwordx4 v14, s[16:19], s32 offen lds
    s_add_u32 s31, s33, 59136
    s_mov_b32 m0, s31
    s_add_u32 s32, s59, 1009152
    buffer_load_dwordx4 v14, s[16:19], s32 offen lds
    s_add_u32 s31, s33, 63360
    s_mov_b32 m0, s31
    s_add_u32 s32, s59, 1036800
    buffer_load_dwordx4 v14, s[16:19], s32 offen lds
    s_add_u32 s31, s34, 117760
    s_mov_b32 m0, s31
    s_mov_b32 s32, 512
    buffer_load_dwordx4 v18, s[12:15], s32 offen lds
    s_add_u32 s31, s34, 121856
    s_mov_b32 m0, s31
    s_mov_b32 s32, 37376
    buffer_load_dwordx4 v18, s[12:15], s32 offen lds
    s_add_u32 s31, s34, 125952
    s_mov_b32 m0, s31
    s_mov_b32 s32, 74240
    buffer_load_dwordx4 v18, s[12:15], s32 offen lds
    s_add_u32 s31, s34, 130048
    s_mov_b32 m0, s31
    s_mov_b32 s32, 111104
    buffer_load_dwordx4 v18, s[12:15], s32 offen lds
    s_waitcnt vmcnt(12)
    s_barrier
    s_add_u32 s31, s33, 67584
    s_mov_b32 m0, s31
    s_add_u32 s32, s59, 1105920
    buffer_load_dwordx4 v14, s[16:19], s32 offen lds
    s_add_u32 s31, s33, 71808
    s_mov_b32 m0, s31
    s_add_u32 s32, s59, 1133568
    buffer_load_dwordx4 v14, s[16:19], s32 offen lds
    s_add_u32 s31, s33, 76032
    s_mov_b32 m0, s31
    s_add_u32 s32, s59, 1119744
    buffer_load_dwordx4 v14, s[16:19], s32 offen lds
    s_add_u32 s31, s33, 80256
    s_mov_b32 m0, s31
    s_add_u32 s32, s59, 1147392
    buffer_load_dwordx4 v14, s[16:19], s32 offen lds
    s_waitcnt vmcnt(16)
    s_barrier
    s_add_u32 s31, s33, 84480
    s_mov_b32 m0, s31
    s_add_u32 s32, s59, 1216512
    buffer_load_dwordx4 v14, s[16:19], s32 offen lds
    s_add_u32 s31, s33, 88704
    s_mov_b32 m0, s31
    s_add_u32 s32, s59, 1244160
    buffer_load_dwordx4 v14, s[16:19], s32 offen lds
    s_add_u32 s31, s33, 92928
    s_mov_b32 m0, s31
    s_add_u32 s32, s59, 1230336
    buffer_load_dwordx4 v14, s[16:19], s32 offen lds
    s_add_u32 s31, s33, 97152
    s_mov_b32 m0, s31
    s_add_u32 s32, s59, 1257984
    buffer_load_dwordx4 v14, s[16:19], s32 offen lds
    s_add_u32 s31, s34, 134144
    s_mov_b32 m0, s31
    s_mov_b32 s32, 640
    buffer_load_dwordx4 v18, s[12:15], s32 offen lds
    s_add_u32 s31, s34, 138240
    s_mov_b32 m0, s31
    s_mov_b32 s32, 37504
    buffer_load_dwordx4 v18, s[12:15], s32 offen lds
    s_add_u32 s31, s34, 142336
    s_mov_b32 m0, s31
    s_mov_b32 s32, 74368
    buffer_load_dwordx4 v18, s[12:15], s32 offen lds
    s_add_u32 s31, s34, 146432
    s_mov_b32 m0, s31
    s_mov_b32 s32, 111232
    buffer_load_dwordx4 v18, s[12:15], s32 offen lds
    s_waitcnt vmcnt(12)
    s_barrier
    s_add_u32 s31, s33, 0
    s_mov_b32 m0, s31
    s_add_u32 s32, s59, 1327104
    buffer_load_dwordx4 v14, s[16:19], s32 offen lds
    s_add_u32 s31, s33, 4224
    s_mov_b32 m0, s31
    s_add_u32 s32, s59, 1354752
    buffer_load_dwordx4 v14, s[16:19], s32 offen lds
    s_add_u32 s31, s33, 8448
    s_mov_b32 m0, s31
    s_add_u32 s32, s59, 1340928
    buffer_load_dwordx4 v14, s[16:19], s32 offen lds
    s_add_u32 s31, s33, 12672
    s_mov_b32 m0, s31
    s_add_u32 s32, s59, 1368576
    buffer_load_dwordx4 v14, s[16:19], s32 offen lds
    s_waitcnt vmcnt(16)
    s_barrier
    s_add_u32 s31, s33, 16896
    s_mov_b32 m0, s31
    s_add_u32 s32, s59, 1437696
    buffer_load_dwordx4 v14, s[16:19], s32 offen lds
    s_add_u32 s31, s33, 21120
    s_mov_b32 m0, s31
    s_add_u32 s32, s59, 1465344
    buffer_load_dwordx4 v14, s[16:19], s32 offen lds
    s_add_u32 s31, s33, 25344
    s_mov_b32 m0, s31
    s_add_u32 s32, s59, 1451520
    buffer_load_dwordx4 v14, s[16:19], s32 offen lds
    s_add_u32 s31, s33, 29568
    s_mov_b32 m0, s31
    s_add_u32 s32, s59, 1479168
    buffer_load_dwordx4 v14, s[16:19], s32 offen lds
    s_add_u32 s31, s34, 101376
    s_mov_b32 m0, s31
    s_mov_b32 s32, 768
    buffer_load_dwordx4 v18, s[12:15], s32 offen lds
    s_add_u32 s31, s34, 105472
    s_mov_b32 m0, s31
    s_mov_b32 s32, 37632
    buffer_load_dwordx4 v18, s[12:15], s32 offen lds
    s_add_u32 s31, s34, 109568
    s_mov_b32 m0, s31
    s_mov_b32 s32, 74496
    buffer_load_dwordx4 v18, s[12:15], s32 offen lds
    s_add_u32 s31, s34, 113664
    s_mov_b32 m0, s31
    s_mov_b32 s32, 111360
    buffer_load_dwordx4 v18, s[12:15], s32 offen lds
    s_waitcnt vmcnt(12)
    s_barrier
    s_add_u32 s31, s33, 33792
    s_mov_b32 m0, s31
    s_add_u32 s32, s59, 1548288
    buffer_load_dwordx4 v14, s[16:19], s32 offen lds
    s_add_u32 s31, s33, 38016
    s_mov_b32 m0, s31
    s_add_u32 s32, s59, 1575936
    buffer_load_dwordx4 v14, s[16:19], s32 offen lds
    s_add_u32 s31, s33, 42240
    s_mov_b32 m0, s31
    s_add_u32 s32, s59, 1562112
    buffer_load_dwordx4 v14, s[16:19], s32 offen lds
    s_add_u32 s31, s33, 46464
    s_mov_b32 m0, s31
    s_add_u32 s32, s59, 1589760
    buffer_load_dwordx4 v14, s[16:19], s32 offen lds
    s_waitcnt vmcnt(16)
    s_barrier
    s_add_u32 s31, s33, 50688
    s_mov_b32 m0, s31
    s_add_u32 s32, s59, 1658880
    buffer_load_dwordx4 v14, s[16:19], s32 offen lds
    s_add_u32 s31, s33, 54912
    s_mov_b32 m0, s31
    s_add_u32 s32, s59, 1686528
    buffer_load_dwordx4 v14, s[16:19], s32 offen lds
    s_add_u32 s31, s33, 59136
    s_mov_b32 m0, s31
    s_add_u32 s32, s59, 1672704
    buffer_load_dwordx4 v14, s[16:19], s32 offen lds
    s_add_u32 s31, s33, 63360
    s_mov_b32 m0, s31
    s_add_u32 s32, s59, 1700352
    buffer_load_dwordx4 v14, s[16:19], s32 offen lds
    s_add_u32 s31, s34, 117760
    s_mov_b32 m0, s31
    s_mov_b32 s32, 896
    buffer_load_dwordx4 v18, s[12:15], s32 offen lds
    s_add_u32 s31, s34, 121856
    s_mov_b32 m0, s31
    s_mov_b32 s32, 37760
    buffer_load_dwordx4 v18, s[12:15], s32 offen lds
    s_add_u32 s31, s34, 125952
    s_mov_b32 m0, s31
    s_mov_b32 s32, 74624
    buffer_load_dwordx4 v18, s[12:15], s32 offen lds
    s_add_u32 s31, s34, 130048
    s_mov_b32 m0, s31
    s_mov_b32 s32, 111488
    buffer_load_dwordx4 v18, s[12:15], s32 offen lds
    s_waitcnt vmcnt(12)
    s_barrier
    s_add_u32 s31, s33, 67584
    s_mov_b32 m0, s31
    s_add_u32 s32, s59, 1769472
    buffer_load_dwordx4 v14, s[16:19], s32 offen lds
    s_add_u32 s31, s33, 71808
    s_mov_b32 m0, s31
    s_add_u32 s32, s59, 1797120
    buffer_load_dwordx4 v14, s[16:19], s32 offen lds
    s_add_u32 s31, s33, 76032
    s_mov_b32 m0, s31
    s_add_u32 s32, s59, 1783296
    buffer_load_dwordx4 v14, s[16:19], s32 offen lds
    s_add_u32 s31, s33, 80256
    s_mov_b32 m0, s31
    s_add_u32 s32, s59, 1810944
    buffer_load_dwordx4 v14, s[16:19], s32 offen lds
    s_waitcnt vmcnt(16)
    s_barrier
    s_add_u32 s31, s33, 84480
    s_mov_b32 m0, s31
    s_add_u32 s32, s59, 1880064
    buffer_load_dwordx4 v14, s[16:19], s32 offen lds
    s_add_u32 s31, s33, 88704
    s_mov_b32 m0, s31
    s_add_u32 s32, s59, 1907712
    buffer_load_dwordx4 v14, s[16:19], s32 offen lds
    s_add_u32 s31, s33, 92928
    s_mov_b32 m0, s31
    s_add_u32 s32, s59, 1893888
    buffer_load_dwordx4 v14, s[16:19], s32 offen lds
    s_add_u32 s31, s33, 97152
    s_mov_b32 m0, s31
    s_add_u32 s32, s59, 1921536
    buffer_load_dwordx4 v14, s[16:19], s32 offen lds
    s_add_u32 s31, s34, 134144
    s_mov_b32 m0, s31
    s_mov_b32 s32, 1024
    buffer_load_dwordx4 v18, s[12:15], s32 offen lds
    s_add_u32 s31, s34, 138240
    s_mov_b32 m0, s31
    s_mov_b32 s32, 37888
    buffer_load_dwordx4 v18, s[12:15], s32 offen lds
    s_add_u32 s31, s34, 142336
    s_mov_b32 m0, s31
    s_mov_b32 s32, 74752
    buffer_load_dwordx4 v18, s[12:15], s32 offen lds
    s_add_u32 s31, s34, 146432
    s_mov_b32 m0, s31
    s_mov_b32 s32, 111616
    buffer_load_dwordx4 v18, s[12:15], s32 offen lds
    s_waitcnt vmcnt(12)
    s_barrier
    s_waitcnt vmcnt(12)
    s_barrier
    s_waitcnt vmcnt(0)
    s_barrier
    s_waitcnt vmcnt(0)
    s_barrier
    s_waitcnt vmcnt(0)
    s_barrier
    s_barrier
    s_barrier
L_qkv_copy:
    v_lshlrev_b32 v7, 4, v1
    s_mul_i32 s31, s24, 4864
    v_add_u32 v2, s31, v7
    ds_read_b128 v[36:39], v2 offset:0
    ds_read_b128 v[40:43], v2 offset:1024
    ds_read_b128 v[44:47], v2 offset:2048
    ds_read_b128 v[48:51], v2 offset:3072
    ds_read_b128 v[52:55], v2 offset:4096
    v_mov_b32 v3, 0x80000000
    v_cmp_gt_u32 vcc, 32, v1
    v_cmp_gt_u32 s[38:39], 48, v1
    s_lshl_b32 s51, s26, 2
    v_cndmask_b32 v4, v3, v7, vcc
    v_cndmask_b32_e64 v5, v3, v7, s[38:39]
    s_mul_i32 s49, s27, 12
    s_add_u32 s49, s49, s24
    s_lshr_b32 s50, s49, 5
    s_and_b32 s52, s49, 31
    s_cmp_eq_u32 s50, 0
    s_cbranch_scc0 L_ck_30
    s_lshl_b32 s31, s25, 5
    s_add_u32 s31, s31, s52
    s_lshl_b32 s31, s31, 6
    s_add_u32 s31, s31, s51
    s_lshl_b32 s53, s31, 10
    s_add_u32 s53, s53, 10485760
    s_lshl_b32 s58, s31, 7
    s_add_u32 s58, s58, 14680064
    s_branch L_cs_32
L_ck_30:
    s_cmp_eq_u32 s25, 1
    s_cbranch_scc1 L_ca_33
    s_lshl_b32 s31, s52, 3
    s_lshr_b32 s32, s51, 3
    s_add_u32 s31, s31, s32
    s_mul_i32 s31, s31, 19456
    s_and_b32 s32, s51, 7
    s_cmp_eq_u32 s50, 1
    s_cbranch_scc0 L_cv_31
    s_lshl_b32 s33, s32, 10
    s_add_u32 s53, s31, s33
    s_lshl_b32 s33, s32, 7
    s_add_u32 s58, s31, s33
    s_add_u32 s58, s58, 8192
    s_branch L_cs_32
L_cv_31:
    s_mul_i32 s33, s32, 1216
    s_add_u32 s53, s31, s33
    s_add_u32 s53, s53, 9216
    s_branch L_cvv_35
L_ca_33:
    s_mul_i32 s31, s52, 151552
    s_add_u32 s31, s31, 4980224
    s_cmp_eq_u32 s50, 1
    s_cbranch_scc0 L_cav_34
    s_lshl_b32 s33, s51, 10
    s_add_u32 s53, s31, s33
    s_lshl_b32 s33, s51, 7
    s_add_u32 s58, s31, s33
    s_add_u32 s58, s58, 65536
    s_branch L_cs_32
L_cav_34:
    s_mul_i32 s33, s51, 1216
    s_add_u32 s53, s31, s33
    s_add_u32 s53, s53, 73728
L_cvv_35:
    s_waitcnt lgkmcnt(0)
    buffer_store_dwordx4 v[36:39], v7, s[20:23], s53 offen offset:0 sc1
    buffer_store_dwordx4 v[40:43], v7, s[20:23], s53 offen offset:1024 sc1
    buffer_store_dwordx4 v[44:47], v7, s[20:23], s53 offen offset:2048 sc1
    buffer_store_dwordx4 v[48:51], v7, s[20:23], s53 offen offset:3072 sc1
    s_add_u32 s53, s53, 4096
    buffer_store_dwordx4 v[52:55], v5, s[20:23], s53 offen sc1
    s_branch L_cend_36
L_cs_32:
    s_waitcnt lgkmcnt(0)
    buffer_store_dwordx4 v[36:39], v7, s[20:23], s53 offen offset:0 sc1
    buffer_store_dwordx4 v[40:43], v7, s[20:23], s53 offen offset:1024 sc1
    buffer_store_dwordx4 v[44:47], v7, s[20:23], s53 offen offset:2048 sc1
    buffer_store_dwordx4 v[48:51], v7, s[20:23], s53 offen offset:3072 sc1
    buffer_store_dwordx4 v[52:55], v4, s[20:23], s58 offen sc1
L_cend_36:
L_qkv_end:
    s_endpgm
.globl attn_kernel
.p2align 8
.type attn_kernel,@function
attn_kernel:
    s_load_dwordx2 s[4:5], s[0:1], 72
    s_cmp_ge_u32 s2, 256
    s_cbranch_scc1 L_at_end
    s_getpc_b64 s[94:95]
L_pc_37:
    s_sub_u32 s94, s94, L_pc_37-code_start
    s_subb_u32 s95, s95, 0
    v_lshlrev_b32 v164, 7, v0
    v_min_u32 v164, code_end-code_start-4, v164
    v_mov_b32 v165, s95
    v_add_co_u32 v164, vcc, s94, v164
    s_nop 1
    v_addc_co_u32 v165, vcc, 0, v165, vcc
    global_load_dword v166, v[164:165], off
    v_and_b32 v1, 63, v0
    v_lshrrev_b32 v5, 6, v0
    v_lshlrev_b32 v2, 4, v1
    v_readfirstlane_b32 s14, v5
    s_and_b32 s16, s2, 7
    s_lshr_b32 s17, s2, 3
    s_lshl_b32 s12, s16, 2
    s_lshr_b32 s18, s17, 3
    s_add_u32 s12, s12, s18
    s_and_b32 s13, s17, 7
    s_waitcnt lgkmcnt(0)
    s_mov_b32 s8, s4
    s_and_b32 s9, s5, 0xffff
    s_mov_b32 s10, 268435456
    s_mov_b32 s11, 0x20000
    s_cmp_eq_u32 s14, 8
    s_cbranch_scc1 L_at_loader
    s_and_b32 s21, s14, 3
    s_lshl_b32 s21, s21, 1
    s_lshl_b32 s15, s13, 3
    s_add_u32 s15, s15, s21
    v_and_b32 v5, 31, v1
    v_lshrrev_b32 v6, 5, v1
    v_lshlrev_b32 v3, 2, v5
    v_mov_b32 v7, 0x80000000
    v_cmp_gt_u32 vcc, 32, v1
    v_lshlrev_b32 v140, 4, v5
    s_lshr_b32 s22, s14, 2
    s_lshl_b32 s22, s22, 5
    s_add_u32 s18, s22, s12
    s_lshl_b32 s18, s18, 6
    s_add_u32 s18, s18, s15
    v_cndmask_b32 v147, v7, v3, vcc
    v_cndmask_b32 v140, v7, v140, vcc
    s_lshl_b32 s19, s18, 10
    s_add_u32 s16, s19, 10485760
    buffer_load_dwordx4 v[12:15], v2, s[8:11], s16 offen
    buffer_load_dwordx4 v[18:21], v2, s[8:11], s16 offen offset:1024
    s_lshl_b32 s19, s18, 7
    s_add_u32 s16, s19, 14680064
    buffer_load_dword v16, v147, s[8:11], s16 offen
    buffer_load_dword v22, v147, s[8:11], s16 offen offset:128
    s_mul_i32 s19, s12, 155648
    s_cmp_ge_u32 s14, 4
    s_cbranch_scc1 L_k0_38
    buffer_load_dwordx4 v[24:27], v2, s[8:11], s19 offen
    s_add_u32 s19, s19, 8192
    buffer_load_dword v28, v3, s[8:11], s19 offen
L_k0_38:
    v_mov_b32 v7, 0
    v_mov_b32 v8, 0x3f80
    v_cndmask_b32 v17, v7, v8, vcc
    v_cndmask_b32 v23, v7, v8, vcc
    v_mov_b32 v8, -1
    v_cndmask_b32 v142, v7, v8, vcc
    v_mul_u32_u24 v4, 304, v6
    v_lshlrev_b32 v8, 4, v5
    v_add_u32 v4, v4, v8
    v_add_u32 v4, 9216, v4
    v_cmp_lt_u32 vcc, 18, v5
    v_mov_b32 v7, 0x100000
    v_add_u32 v3, 8192, v3
    v_cndmask_b32 v4, v4, v7, vcc
    s_mov_b32 s31, 0x3f800000
    s_mov_b32 s32, 0x3f80f149
    s_mov_b32 s23, 0x207
    v_mov_b32 v141, 0x207
    v_mov_b32 v146, 1
    v_mov_b32 v145, 163776
    v_mov_b32 v10, 0xf149f2ca
    s_barrier
    s_cmp_ge_u32 s14, 4
    s_cbranch_scc1 L_at_A
    s_setprio 2
    v_mov_b32 v132, v2
    v_mov_b32 v133, v3
    v_mov_b32 v134, v4
    v_add_u32 v135, 58368, v2
    v_add_u32 v136, 58368, v3
    v_add_u32 v137, 58368, v4
    v_mov_b32 v29, s31
    v_mov_b32 v35, s31
    v_mov_b64 v[100:101], 0
    v_mov_b64 v[116:117], 0
    v_mov_b64 v[102:103], 0
    v_mov_b64 v[118:119], 0
    v_mov_b64 v[104:105], 0
    v_mov_b64 v[120:121], 0
    v_mov_b64 v[106:107], 0
    v_mov_b64 v[122:123], 0
    v_mov_b64 v[108:109], 0
    v_mov_b64 v[124:125], 0
    v_mov_b64 v[110:111], 0
    v_mov_b64 v[126:127], 0
    v_mov_b64 v[112:113], 0
    v_mov_b64 v[128:129], 0
    v_mov_b64 v[114:115], 0
    v_mov_b64 v[130:131], 0
    v_mov_b64 v[60:61], 0
    v_mov_b64 v[44:45], 0
    v_mov_b64 v[62:63], 0
    v_mov_b64 v[46:47], 0
    v_mov_b64 v[64:65], 0
    v_mov_b64 v[48:49], 0
    v_mov_b64 v[66:67], 0
    v_mov_b64 v[50:51], 0
    s_waitcnt vmcnt(0)
    s_mov_b32 s16, 0x3eae1a93
    v_lshlrev_b32 v5, 16, v12
    v_and_b32 v6, 0xffff0000, v12
    v_mul_f32 v5, s16, v5
    v_mul_f32 v6, s16, v6
    v_cvt_pk_bf16_f32 v12, v5, v6
    v_lshlrev_b32 v7, 16, v13
    v_and_b32 v8, 0xffff0000, v13
    v_mul_f32 v7, s16, v7
    v_mul_f32 v8, s16, v8
    v_cvt_pk_bf16_f32 v13, v7, v8
    v_lshlrev_b32 v5, 16, v14
    v_and_b32 v6, 0xffff0000, v14
    v_mul_f32 v5, s16, v5
    v_mul_f32 v6, s16, v6
    v_cvt_pk_bf16_f32 v14, v5, v6
    v_lshlrev_b32 v7, 16, v15
    v_and_b32 v8, 0xffff0000, v15
    v_mul_f32 v7, s16, v7
    v_mul_f32 v8, s16, v8
    v_cvt_pk_bf16_f32 v15, v7, v8
    v_lshlrev_b32 v5, 16, v16
    v_and_b32 v6, 0xffff0000, v16
    v_mul_f32 v5, s16, v5
    v_mul_f32 v6, s16, v6
    v_cvt_pk_bf16_f32 v16, v5, v6
    v_lshlrev_b32 v7, 16, v18
    v_and_b32 v8, 0xffff0000, v18
    v_mul_f32 v7, s16, v7
    v_mul_f32 v8, s16, v8
    v_cvt_pk_bf16_f32 v18, v7, v8
    v_lshlrev_b32 v5, 16, v19
    v_and_b32 v6, 0xffff0000, v19
    v_mul_f32 v5, s16, v5
    v_mul_f32 v6, s16, v6
    v_cvt_pk_bf16_f32 v19, v5, v6
    v_lshlrev_b32 v7, 16, v20
    v_and_b32 v8, 0xffff0000, v20
    v_mul_f32 v7, s16, v7
    v_mul_f32 v8, s16, v8
    v_cvt_pk_bf16_f32 v20, v7, v8
    v_lshlrev_b32 v5, 16, v21
    v_and_b32 v6, 0xffff0000, v21
    v_mul_f32 v5, s16, v5
    v_mul_f32 v6, s16, v6
    v_cvt_pk_bf16_f32 v21, v5, v6
    v_lshlrev_b32 v7, 16, v22
    v_and_b32 v8, 0xffff0000, v22
    v_mul_f32 v7, s16, v7
    v_mul_f32 v8, s16, v8
    v_cvt_pk_bf16_f32 v22, v7, v8
    s_nop 1
    v_mfma_f32_32x32x16_bf16 v[68:83], v[24:27], v[12:15], 0
    v_mfma_f32_32x32x16_bf16 v[84:99], v[24:27], v[18:21], 0
    v_mfma_f32_32x32x8_bf16 v[68:83], v[28:29], v[16:17], v[68:83]
    v_mfma_f32_32x32x8_bf16 v[84:99], v[28:29], v[22:23], v[84:99]
    s_nop 7
    s_nop 2
    v_max_f32 v9, v68, v69
    v_max_f32 v138, v84, v85
    v_max_f32 v11, v70, v71
    v_max_f32 v139, v86, v87
    v_max3_f32 v9, v72, v73, v9
    v_max3_f32 v138, v88, v89, v138
    v_max3_f32 v11, v74, v75, v11
    v_max3_f32 v139, v90, v91, v139
    v_max3_f32 v9, v76, v77, v9
    v_max3_f32 v138, v92, v93, v138
    v_max3_f32 v11, v78, v79, v11
    v_max3_f32 v139, v94, v95, v139
    v_max3_f32 v9, v80, v81, v9
    v_max3_f32 v138, v96, v97, v138
    v_max3_f32 v11, v82, v83, v11
    v_max3_f32 v139, v98, v99, v139
    v_max_f32 v9, v9, v11
    v_max_f32 v138, v138, v139
    v_mov_b32 v5, v9
    v_mov_b32 v6, v138
    v_mov_b32 v7, 1.0
    s_nop 0
    v_permlane32_swap_b32 v5, v9
    v_permlane32_swap_b32 v6, v138
    s_nop 0
    v_max_f32 v9, v5, v9
    v_max_f32 v138, v6, v138
    v_sub_f32 v9, 0, v9
    v_sub_f32 v138, 0, v138
    v_cvt_pk_bf16_f32 v9, v7, v9
    v_cvt_pk_bf16_f32 v138, v7, v138
    v_and_b32 v17, v9, v142
    v_and_b32 v23, v138, v142
    v_mfma_f32_32x32x16_bf16 v[68:83], v[24:27], v[12:15], 0
    s_nop 0
    v_mfma_f32_32x32x8_bf16 v[68:83], v[28:29], v[16:17], v[68:83]
    ds_read_b32 v144, v145
    s_waitcnt lgkmcnt(0)
    v_readfirstlane_b32 s33, v144
    s_nop 0
    s_cmp_eq_u32 s33, 0
    s_cbranch_scc1 L_at_f0_spin
L_at_f0_ok:
    ds_read_b128 v[30:33], v132 offset:1024
    ds_read_b32 v34, v133 offset:128
    ds_read_b128 v[36:39], v134
    ds_read_b128 v[40:43], v134 offset:608
    s_nop 3
    v_mfma_f32_32x32x16_bf16 v[84:99], v[24:27], v[18:21], 0
    v_exp_f32 v68, v68
    v_exp_f32 v69, v69
    v_exp_f32 v70, v70
    v_exp_f32 v71, v71
    v_mfma_f32_32x32x16_bf16 v[116:131], v[44:47], v[60:63], v[116:131]
    v_exp_f32 v72, v72
    v_exp_f32 v73, v73
    v_cvt_pk_bf16_f32 v52, v68, v69
    v_exp_f32 v74, v74
    v_cvt_pk_bf16_f32 v53, v70, v71
    v_exp_f32 v75, v75
    v_mfma_f32_32x32x8_bf16 v[84:99], v[28:29], v[22:23], v[84:99]
    v_exp_f32 v76, v76
    v_cvt_pk_bf16_f32 v54, v72, v73
    v_exp_f32 v77, v77
    v_cvt_pk_bf16_f32 v55, v74, v75
    v_exp_f32 v78, v78
    v_exp_f32 v79, v79
    v_mfma_f32_32x32x16_bf16 v[116:131], v[48:51], v[64:67], v[116:131]
    v_exp_f32 v80, v80
    v_exp_f32 v81, v81
    v_cvt_pk_bf16_f32 v56, v76, v77
    v_exp_f32 v82, v82
    v_cvt_pk_bf16_f32 v57, v78, v79
    v_exp_f32 v83, v83
    v_cvt_pk_bf16_f32 v58, v80, v81
    v_cvt_pk_bf16_f32 v59, v82, v83
    s_waitcnt lgkmcnt(0)
    v_mfma_f32_32x32x16_bf16 v[68:83], v[30:33], v[12:15], 0
    ds_read_b128 v[24:27], v132 offset:2048
    ds_read_b32 v28, v133 offset:256
    v_exp_f32 v84, v84
    v_exp_f32 v85, v85
    v_exp_f32 v86, v86
    v_exp_f32 v87, v87
    v_mfma_f32_32x32x16_bf16 v[100:115], v[36:39], v[52:55], v[100:115]
    ds_read_b128 v[44:47], v134 offset:1216
    ds_read_b128 v[48:51], v134 offset:1824
    v_exp_f32 v88, v88
    v_exp_f32 v89, v89
    v_cvt_pk_bf16_f32 v60, v84, v85
    v_exp_f32 v90, v90
    v_cvt_pk_bf16_f32 v61, v86, v87
    v_exp_f32 v91, v91
    v_mfma_f32_32x32x8_bf16 v[68:83], v[34:35], v[16:17], v[68:83]
    v_exp_f32 v92, v92
    v_cvt_pk_bf16_f32 v62, v88, v89
    v_exp_f32 v93, v93
    v_cvt_pk_bf16_f32 v63, v90, v91
    v_exp_f32 v94, v94
    v_exp_f32 v95, v95
    v_mfma_f32_32x32x16_bf16 v[100:115], v[40:43], v[56:59], v[100:115]
    v_exp_f32 v96, v96
    v_exp_f32 v97, v97
    v_cvt_pk_bf16_f32 v64, v92, v93
    v_exp_f32 v98, v98
    v_cvt_pk_bf16_f32 v65, v94, v95
    v_exp_f32 v99, v99
    v_cvt_pk_bf16_f32 v66, v96, v97
    v_cvt_pk_bf16_f32 v67, v98, v99
    v_mfma_f32_32x32x16_bf16 v[84:99], v[30:33], v[18:21], 0
    v_exp_f32 v68, v68
    v_exp_f32 v69, v69
    v_exp_f32 v70, v70
    v_exp_f32 v71, v71
    v_mfma_f32_32x32x16_bf16 v[116:131], v[36:39], v[60:63], v[116:131]
    v_exp_f32 v72, v72
    v_exp_f32 v73, v73
    v_cvt_pk_bf16_f32 v52, v68, v69
    v_exp_f32 v74, v74
    v_cvt_pk_bf16_f32 v53, v70, v71
    v_exp_f32 v75, v75
    v_mfma_f32_32x32x8_bf16 v[84:99], v[34:35], v[22:23], v[84:99]
    v_exp_f32 v76, v76
    v_cvt_pk_bf16_f32 v54, v72, v73
    v_exp_f32 v77, v77
    v_cvt_pk_bf16_f32 v55, v74, v75
    v_exp_f32 v78, v78
    v_exp_f32 v79, v79
    v_mfma_f32_32x32x16_bf16 v[116:131], v[40:43], v[64:67], v[116:131]
    v_exp_f32 v80, v80
    v_exp_f32 v81, v81
    v_cvt_pk_bf16_f32 v56, v76, v77
    v_exp_f32 v82, v82
    v_cvt_pk_bf16_f32 v57, v78, v79
    v_exp_f32 v83, v83
    v_cvt_pk_bf16_f32 v58, v80, v81
    v_cvt_pk_bf16_f32 v59, v82, v83
    s_waitcnt lgkmcnt(0)
    v_mfma_f32_32x32x16_bf16 v[68:83], v[24:27], v[12:15], 0
    ds_read_b128 v[30:33], v132 offset:3072
    ds_read_b32 v34, v133 offset:384
    v_exp_f32 v84, v84
    v_exp_f32 v85, v85
    v_exp_f32 v86, v86
    v_exp_f32 v87, v87
    v_mfma_f32_32x32x16_bf16 v[100:115], v[44:47], v[52:55], v[100:115]
    ds_read_b128 v[36:39], v134 offset:2432
    ds_read_b128 v[40:43], v134 offset:3040
    v_exp_f32 v88, v88
    v_exp_f32 v89, v89
    v_cvt_pk_bf16_f32 v60, v84, v85
    v_exp_f32 v90, v90
    v_cvt_pk_bf16_f32 v61, v86, v87
    v_exp_f32 v91, v91
    v_mfma_f32_32x32x8_bf16 v[68:83], v[28:29], v[16:17], v[68:83]
    v_exp_f32 v92, v92
    v_cvt_pk_bf16_f32 v62, v88, v89
    v_exp_f32 v93, v93
    v_cvt_pk_bf16_f32 v63, v90, v91
    v_exp_f32 v94, v94
    v_exp_f32 v95, v95
    v_mfma_f32_32x32x16_bf16 v[100:115], v[48:51], v[56:59], v[100:115]
    v_exp_f32 v96, v96
    v_exp_f32 v97, v97
    v_cvt_pk_bf16_f32 v64, v92, v93
    v_exp_f32 v98, v98
    v_cvt_pk_bf16_f32 v65, v94, v95
    v_exp_f32 v99, v99
    v_cvt_pk_bf16_f32 v66, v96, v97
    v_cvt_pk_bf16_f32 v67, v98, v99
    v_mfma_f32_32x32x16_bf16 v[84:99], v[24:27], v[18:21], 0
    v_exp_f32 v68, v68
    v_exp_f32 v69, v69
    v_exp_f32 v70, v70
    v_exp_f32 v71, v71
    v_mfma_f32_32x32x16_bf16 v[116:131], v[44:47], v[60:63], v[116:131]
    v_exp_f32 v72, v72
    v_exp_f32 v73, v73
    v_cvt_pk_bf16_f32 v52, v68, v69
    v_exp_f32 v74, v74
    v_cvt_pk_bf16_f32 v53, v70, v71
    v_exp_f32 v75, v75
    v_mfma_f32_32x32x8_bf16 v[84:99], v[28:29], v[22:23], v[84:99]
    v_exp_f32 v76, v76
    v_cvt_pk_bf16_f32 v54, v72, v73
    v_exp_f32 v77, v77
    v_cvt_pk_bf16_f32 v55, v74, v75
    v_exp_f32 v78, v78
    v_exp_f32 v79, v79
    v_mfma_f32_32x32x16_bf16 v[116:131], v[48:51], v[64:67], v[116:131]
    v_exp_f32 v80, v80
    v_exp_f32 v81, v81
    v_cvt_pk_bf16_f32 v56, v76, v77
    v_exp_f32 v82, v82
    v_cvt_pk_bf16_f32 v57, v78, v79
    v_exp_f32 v83, v83
    v_cvt_pk_bf16_f32 v58, v80, v81
    v_cvt_pk_bf16_f32 v59, v82, v83
    s_waitcnt lgkmcnt(0)
    v_mfma_f32_32x32x16_bf16 v[68:83], v[30:33], v[12:15], 0
    ds_read_b128 v[24:27], v132 offset:4096
    ds_read_b32 v28, v133 offset:512
    v_exp_f32 v84, v84
    v_exp_f32 v85, v85
    v_exp_f32 v86, v86
    v_exp_f32 v87, v87
    v_mfma_f32_32x32x16_bf16 v[100:115], v[36:39], v[52:55], v[100:115]
    ds_read_b128 v[44:47], v134 offset:3648
    ds_read_b128 v[48:51], v134 offset:4256
    v_exp_f32 v88, v88
    v_exp_f32 v89, v89
    v_cvt_pk_bf16_f32 v60, v84, v85
    v_exp_f32 v90, v90
    v_cvt_pk_bf16_f32 v61, v86, v87
    v_exp_f32 v91, v91
    v_mfma_f32_32x32x8_bf16 v[68:83], v[34:35], v[16:17], v[68:83]
    v_exp_f32 v92, v92
    v_cvt_pk_bf16_f32 v62, v88, v89
    v_exp_f32 v93, v93
    v_cvt_pk_bf16_f32 v63, v90, v91
    v_exp_f32 v94, v94
    v_exp_f32 v95, v95
    v_mfma_f32_32x32x16_bf16 v[100:115], v[40:43], v[56:59], v[100:115]
    v_exp_f32 v96, v96
    v_exp_f32 v97, v97
    v_cvt_pk_bf16_f32 v64, v92, v93
    v_exp_f32 v98, v98
    v_cvt_pk_bf16_f32 v65, v94, v95
    v_exp_f32 v99, v99
    v_cvt_pk_bf16_f32 v66, v96, v97
    v_cvt_pk_bf16_f32 v67, v98, v99
    v_mfma_f32_32x32x16_bf16 v[84:99], v[30:33], v[18:21], 0
    v_exp_f32 v68, v68
    v_exp_f32 v69, v69
    v_exp_f32 v70, v70
    v_exp_f32 v71, v71
    v_mfma_f32_32x32x16_bf16 v[116:131], v[36:39], v[60:63], v[116:131]
    v_exp_f32 v72, v72
    v_exp_f32 v73, v73
    v_cvt_pk_bf16_f32 v52, v68, v69
    v_exp_f32 v74, v74
    v_cvt_pk_bf16_f32 v53, v70, v71
    v_exp_f32 v75, v75
    v_mfma_f32_32x32x8_bf16 v[84:99], v[34:35], v[22:23], v[84:99]
    v_exp_f32 v76, v76
    v_cvt_pk_bf16_f32 v54, v72, v73
    v_exp_f32 v77, v77
    v_cvt_pk_bf16_f32 v55, v74, v75
    v_exp_f32 v78, v78
    v_exp_f32 v79, v79
    v_mfma_f32_32x32x16_bf16 v[116:131], v[40:43], v[64:67], v[116:131]
    v_exp_f32 v80, v80
    v_exp_f32 v81, v81
    v_cvt_pk_bf16_f32 v56, v76, v77
    v_exp_f32 v82, v82
    v_cvt_pk_bf16_f32 v57, v78, v79
    v_exp_f32 v83, v83
    v_cvt_pk_bf16_f32 v58, v80, v81
    v_cvt_pk_bf16_f32 v59, v82, v83
    s_waitcnt lgkmcnt(0)
    v_mfma_f32_32x32x16_bf16 v[68:83], v[24:27], v[12:15], 0
    ds_read_b128 v[30:33], v132 offset:5120
    ds_read_b32 v34, v133 offset:640
    v_exp_f32 v84, v84
    v_exp_f32 v85, v85
    v_exp_f32 v86, v86
    v_exp_f32 v87, v87
    v_mfma_f32_32x32x16_bf16 v[100:115], v[44:47], v[52:55], v[100:115]
    ds_read_b128 v[36:39], v134 offset:4864
    ds_read_b128 v[40:43], v134 offset:5472
    v_exp_f32 v88, v88
    v_exp_f32 v89, v89
    v_cvt_pk_bf16_f32 v60, v84, v85
    v_exp_f32 v90, v90
    v_cvt_pk_bf16_f32 v61, v86, v87
    v_exp_f32 v91, v91
    v_mfma_f32_32x32x8_bf16 v[68:83], v[28:29], v[16:17], v[68:83]
    v_exp_f32 v92, v92
    v_cvt_pk_bf16_f32 v62, v88, v89
    v_exp_f32 v93, v93
    v_cvt_pk_bf16_f32 v63, v90, v91
    v_exp_f32 v94, v94
    v_exp_f32 v95, v95
    v_mfma_f32_32x32x16_bf16 v[100:115], v[48:51], v[56:59], v[100:115]
    v_exp_f32 v96, v96
    v_exp_f32 v97, v97
    v_cvt_pk_bf16_f32 v64, v92, v93
    v_exp_f32 v98, v98
    v_cvt_pk_bf16_f32 v65, v94, v95
    v_exp_f32 v99, v99
    v_cvt_pk_bf16_f32 v66, v96, v97
    v_cvt_pk_bf16_f32 v67, v98, v99
    v_mfma_f32_32x32x16_bf16 v[84:99], v[24:27], v[18:21], 0
    v_exp_f32 v68, v68
    v_exp_f32 v69, v69
    v_exp_f32 v70, v70
    v_exp_f32 v71, v71
    v_mfma_f32_32x32x16_bf16 v[116:131], v[44:47], v[60:63], v[116:131]
    v_exp_f32 v72, v72
    v_exp_f32 v73, v73
    v_cvt_pk_bf16_f32 v52, v68, v69
    v_exp_f32 v74, v74
    v_cvt_pk_bf16_f32 v53, v70, v71
    v_exp_f32 v75, v75
    v_mfma_f32_32x32x8_bf16 v[84:99], v[28:29], v[22:23], v[84:99]
    v_exp_f32 v76, v76
    v_cvt_pk_bf16_f32 v54, v72, v73
    v_exp_f32 v77, v77
    v_cvt_pk_bf16_f32 v55, v74, v75
    v_exp_f32 v78, v78
    v_exp_f32 v79, v79
    v_mfma_f32_32x32x16_bf16 v[116:131], v[48:51], v[64:67], v[116:131]
    v_exp_f32 v80, v80
    v_exp_f32 v81, v81
    v_cvt_pk_bf16_f32 v56, v76, v77
    v_exp_f32 v82, v82
    v_cvt_pk_bf16_f32 v57, v78, v79
    v_exp_f32 v83, v83
    v_cvt_pk_bf16_f32 v58, v80, v81
    v_cvt_pk_bf16_f32 v59, v82, v83
    s_waitcnt lgkmcnt(0)
    v_mfma_f32_32x32x16_bf16 v[68:83], v[30:33], v[12:15], 0
    ds_read_b128 v[24:27], v132 offset:6144
    ds_read_b32 v28, v133 offset:768
    v_exp_f32 v84, v84
    v_exp_f32 v85, v85
    v_exp_f32 v86, v86
    v_exp_f32 v87, v87
    v_mfma_f32_32x32x16_bf16 v[100:115], v[36:39], v[52:55], v[100:115]
    ds_read_b128 v[44:47], v134 offset:6080
    ds_read_b128 v[48:51], v134 offset:6688
    v_exp_f32 v88, v88
    v_exp_f32 v89, v89
    v_cvt_pk_bf16_f32 v60, v84, v85
    v_exp_f32 v90, v90
    v_cvt_pk_bf16_f32 v61, v86, v87
    v_exp_f32 v91, v91
    v_mfma_f32_32x32x8_bf16 v[68:83], v[34:35], v[16:17], v[68:83]
    v_exp_f32 v92, v92
    v_cvt_pk_bf16_f32 v62, v88, v89
    v_exp_f32 v93, v93
    v_cvt_pk_bf16_f32 v63, v90, v91
    v_exp_f32 v94, v94
    v_exp_f32 v95, v95
    v_mfma_f32_32x32x16_bf16 v[100:115], v[40:43], v[56:59], v[100:115]
    v_exp_f32 v96, v96
    v_exp_f32 v97, v97
    v_cvt_pk_bf16_f32 v64, v92, v93
    v_exp_f32 v98, v98
    v_cvt_pk_bf16_f32 v65, v94, v95
    v_exp_f32 v99, v99
    v_cvt_pk_bf16_f32 v66, v96, v97
    v_cvt_pk_bf16_f32 v67, v98, v99
    v_mfma_f32_32x32x16_bf16 v[84:99], v[30:33], v[18:21], 0
    v_exp_f32 v68, v68
    v_exp_f32 v69, v69
    v_exp_f32 v70, v70
    v_exp_f32 v71, v71
    v_mfma_f32_32x32x16_bf16 v[116:131], v[36:39], v[60:63], v[116:131]
    v_exp_f32 v72, v72
    v_exp_f32 v73, v73
    v_cvt_pk_bf16_f32 v52, v68, v69
    v_exp_f32 v74, v74
    v_cvt_pk_bf16_f32 v53, v70, v71
    v_exp_f32 v75, v75
    v_mfma_f32_32x32x8_bf16 v[84:99], v[34:35], v[22:23], v[84:99]
    v_exp_f32 v76, v76
    v_cvt_pk_bf16_f32 v54, v72, v73
    v_exp_f32 v77, v77
    v_cvt_pk_bf16_f32 v55, v74, v75
    v_exp_f32 v78, v78
    v_exp_f32 v79, v79
    v_mfma_f32_32x32x16_bf16 v[116:131], v[40:43], v[64:67], v[116:131]
    v_exp_f32 v80, v80
    v_exp_f32 v81, v81
    v_cvt_pk_bf16_f32 v56, v76, v77
    v_exp_f32 v82, v82
    v_cvt_pk_bf16_f32 v57, v78, v79
    v_exp_f32 v83, v83
    v_cvt_pk_bf16_f32 v58, v80, v81
    v_cvt_pk_bf16_f32 v59, v82, v83
    s_waitcnt lgkmcnt(0)
    v_mfma_f32_32x32x16_bf16 v[68:83], v[24:27], v[12:15], 0
    ds_read_b128 v[30:33], v132 offset:7168
    ds_read_b32 v34, v133 offset:896
    v_exp_f32 v84, v84
    v_exp_f32 v85, v85
    v_exp_f32 v86, v86
    v_exp_f32 v87, v87
    v_mfma_f32_32x32x16_bf16 v[100:115], v[44:47], v[52:55], v[100:115]
    ds_read_b128 v[36:39], v134 offset:7296
    ds_read_b128 v[40:43], v134 offset:7904
    ds_read_b32 v144, v145 offset:4
    v_exp_f32 v88, v88
    v_exp_f32 v89, v89
    v_cvt_pk_bf16_f32 v60, v84, v85
    v_exp_f32 v90, v90
    v_cvt_pk_bf16_f32 v61, v86, v87
    v_exp_f32 v91, v91
    v_mfma_f32_32x32x8_bf16 v[68:83], v[28:29], v[16:17], v[68:83]
    v_exp_f32 v92, v92
    v_cvt_pk_bf16_f32 v62, v88, v89
    v_exp_f32 v93, v93
    v_cvt_pk_bf16_f32 v63, v90, v91
    v_exp_f32 v94, v94
    v_exp_f32 v95, v95
    v_mfma_f32_32x32x16_bf16 v[100:115], v[48:51], v[56:59], v[100:115]
    v_exp_f32 v96, v96
    v_exp_f32 v97, v97
    v_cvt_pk_bf16_f32 v64, v92, v93
    v_exp_f32 v98, v98
    v_cvt_pk_bf16_f32 v65, v94, v95
    v_exp_f32 v99, v99
    v_cvt_pk_bf16_f32 v66, v96, v97
    v_cvt_pk_bf16_f32 v67, v98, v99
    v_mfma_f32_32x32x16_bf16 v[84:99], v[24:27], v[18:21], 0
    v_exp_f32 v68, v68
    v_exp_f32 v69, v69
    v_exp_f32 v70, v70
    v_exp_f32 v71, v71
    v_mfma_f32_32x32x16_bf16 v[116:131], v[44:47], v[60:63], v[116:131]
    v_exp_f32 v72, v72
    v_exp_f32 v73, v73
    v_cvt_pk_bf16_f32 v52, v68, v69
    v_exp_f32 v74, v74
    v_cvt_pk_bf16_f32 v53, v70, v71
    v_exp_f32 v75, v75
    v_mfma_f32_32x32x8_bf16 v[84:99], v[28:29], v[22:23], v[84:99]
    v_exp_f32 v76, v76
    v_cvt_pk_bf16_f32 v54, v72, v73
    v_exp_f32 v77, v77
    v_cvt_pk_bf16_f32 v55, v74, v75
    v_exp_f32 v78, v78
    v_exp_f32 v79, v79
    v_mfma_f32_32x32x16_bf16 v[116:131], v[48:51], v[64:67], v[116:131]
    v_exp_f32 v80, v80
    v_exp_f32 v81, v81
    v_cvt_pk_bf16_f32 v56, v76, v77
    v_exp_f32 v82, v82
    v_cvt_pk_bf16_f32 v57, v78, v79
    v_exp_f32 v83, v83
    v_cvt_pk_bf16_f32 v58, v80, v81
    v_cvt_pk_bf16_f32 v59, v82, v83
    s_waitcnt lgkmcnt(0)
    v_readfirstlane_b32 s33, v144
    s_nop 0
    s_cmp_eq_u32 s33, 0
    s_cbranch_scc1 L_at_fc0_spin
L_at_fc0_ok:
    v_mfma_f32_32x32x16_bf16 v[68:83], v[30:33], v[12:15], 0
    ds_read_b128 v[24:27], v132 offset:19456
    ds_read_b32 v28, v133 offset:19456
    v_exp_f32 v84, v84
    v_exp_f32 v85, v85
    v_exp_f32 v86, v86
    v_exp_f32 v87, v87
    v_mfma_f32_32x32x16_bf16 v[100:115], v[36:39], v[52:55], v[100:115]
    ds_read_b128 v[44:47], v134 offset:8512
    ds_read_b128 v[48:51], v134 offset:9120
    v_exp_f32 v88, v88
    v_exp_f32 v89, v89
    v_cvt_pk_bf16_f32 v60, v84, v85
    v_exp_f32 v90, v90
    v_cvt_pk_bf16_f32 v61, v86, v87
    v_exp_f32 v91, v91
    v_mfma_f32_32x32x8_bf16 v[68:83], v[34:35], v[16:17], v[68:83]
    v_exp_f32 v92, v92
    v_cvt_pk_bf16_f32 v62, v88, v89
    v_exp_f32 v93, v93
    v_cvt_pk_bf16_f32 v63, v90, v91
    v_exp_f32 v94, v94
    v_exp_f32 v95, v95
    v_mfma_f32_32x32x16_bf16 v[100:115], v[40:43], v[56:59], v[100:115]
    v_exp_f32 v96, v96
    v_exp_f32 v97, v97
    v_cvt_pk_bf16_f32 v64, v92, v93
    v_exp_f32 v98, v98
    v_cvt_pk_bf16_f32 v65, v94, v95
    v_exp_f32 v99, v99
    v_cvt_pk_bf16_f32 v66, v96, v97
    v_cvt_pk_bf16_f32 v67, v98, v99
    v_mfma_f32_32x32x16_bf16 v[84:99], v[30:33], v[18:21], 0
    v_exp_f32 v68, v68
    v_exp_f32 v69, v69
    v_exp_f32 v70, v70
    v_exp_f32 v71, v71
    v_mfma_f32_32x32x16_bf16 v[116:131], v[36:39], v[60:63], v[116:131]
    v_exp_f32 v72, v72
    v_exp_f32 v73, v73
    v_cvt_pk_bf16_f32 v52, v68, v69
    v_exp_f32 v74, v74
    v_cvt_pk_bf16_f32 v53, v70, v71
    v_exp_f32 v75, v75
    v_mfma_f32_32x32x8_bf16 v[84:99], v[34:35], v[22:23], v[84:99]
    v_exp_f32 v76, v76
    v_cvt_pk_bf16_f32 v54, v72, v73
    v_exp_f32 v77, v77
    v_cvt_pk_bf16_f32 v55, v74, v75
    v_exp_f32 v78, v78
    v_exp_f32 v79, v79
    v_mfma_f32_32x32x16_bf16 v[116:131], v[40:43], v[64:67], v[116:131]
    v_exp_f32 v80, v80
    v_exp_f32 v81, v81
    v_cvt_pk_bf16_f32 v56, v76, v77
    v_exp_f32 v82, v82
    v_cvt_pk_bf16_f32 v57, v78, v79
    v_exp_f32 v83, v83
    v_cvt_pk_bf16_f32 v58, v80, v81
    v_cvt_pk_bf16_f32 v59, v82, v83
    s_waitcnt lgkmcnt(0)
    v_mfma_f32_32x32x16_bf16 v[68:83], v[24:27], v[12:15], 0
    ds_read_b128 v[30:33], v132 offset:20480
    ds_read_b32 v34, v133 offset:19584
    v_exp_f32 v84, v84
    v_exp_f32 v85, v85
    v_exp_f32 v86, v86
    v_exp_f32 v87, v87
    v_mfma_f32_32x32x16_bf16 v[100:115], v[44:47], v[52:55], v[100:115]
    ds_read_b128 v[36:39], v134 offset:19456
    ds_read_b128 v[40:43], v134 offset:20064
    v_exp_f32 v88, v88
    v_exp_f32 v89, v89
    v_cvt_pk_bf16_f32 v60, v84, v85
    v_exp_f32 v90, v90
    v_cvt_pk_bf16_f32 v61, v86, v87
    v_exp_f32 v91, v91
    v_mfma_f32_32x32x8_bf16 v[68:83], v[28:29], v[16:17], v[68:83]
    v_exp_f32 v92, v92
    v_cvt_pk_bf16_f32 v62, v88, v89
    v_exp_f32 v93, v93
    v_cvt_pk_bf16_f32 v63, v90, v91
    v_exp_f32 v94, v94
    v_exp_f32 v95, v95
    v_mfma_f32_32x32x16_bf16 v[100:115], v[48:51], v[56:59], v[100:115]
    v_exp_f32 v96, v96
    v_exp_f32 v97, v97
    v_cvt_pk_bf16_f32 v64, v92, v93
    v_exp_f32 v98, v98
    v_cvt_pk_bf16_f32 v65, v94, v95
    v_exp_f32 v99, v99
    v_cvt_pk_bf16_f32 v66, v96, v97
    v_cvt_pk_bf16_f32 v67, v98, v99
    v_mfma_f32_32x32x16_bf16 v[84:99], v[24:27], v[18:21], 0
    v_exp_f32 v68, v68
    v_exp_f32 v69, v69
    v_exp_f32 v70, v70
    v_exp_f32 v71, v71
    v_mfma_f32_32x32x16_bf16 v[116:131], v[44:47], v[60:63], v[116:131]
    v_exp_f32 v72, v72
    v_exp_f32 v73, v73
    v_cvt_pk_bf16_f32 v52, v68, v69
    v_exp_f32 v74, v74
    v_cvt_pk_bf16_f32 v53, v70, v71
    v_exp_f32 v75, v75
    v_mfma_f32_32x32x8_bf16 v[84:99], v[28:29], v[22:23], v[84:99]
    v_exp_f32 v76, v76
    v_cvt_pk_bf16_f32 v54, v72, v73
    v_exp_f32 v77, v77
    v_cvt_pk_bf16_f32 v55, v74, v75
    v_exp_f32 v78, v78
    v_exp_f32 v79, v79
    v_mfma_f32_32x32x16_bf16 v[116:131], v[48:51], v[64:67], v[116:131]
    v_exp_f32 v80, v80
    v_exp_f32 v81, v81
    v_cvt_pk_bf16_f32 v56, v76, v77
    v_exp_f32 v82, v82
    v_cvt_pk_bf16_f32 v57, v78, v79
    v_exp_f32 v83, v83
    v_cvt_pk_bf16_f32 v58, v80, v81
    v_cvt_pk_bf16_f32 v59, v82, v83
    s_waitcnt lgkmcnt(0)
    v_mfma_f32_32x32x16_bf16 v[68:83], v[30:33], v[12:15], 0
    ds_read_b128 v[24:27], v132 offset:21504
    ds_read_b32 v28, v133 offset:19712
    v_exp_f32 v84, v84
    v_exp_f32 v85, v85
    v_exp_f32 v86, v86
    v_exp_f32 v87, v87
    v_mfma_f32_32x32x16_bf16 v[100:115], v[36:39], v[52:55], v[100:115]
    ds_read_b128 v[44:47], v134 offset:20672
    ds_read_b128 v[48:51], v134 offset:21280
    v_exp_f32 v88, v88
    v_exp_f32 v89, v89
    v_cvt_pk_bf16_f32 v60, v84, v85
    v_exp_f32 v90, v90
    v_cvt_pk_bf16_f32 v61, v86, v87
    v_exp_f32 v91, v91
    v_mfma_f32_32x32x8_bf16 v[68:83], v[34:35], v[16:17], v[68:83]
    v_exp_f32 v92, v92
    v_cvt_pk_bf16_f32 v62, v88, v89
    v_exp_f32 v93, v93
    v_cvt_pk_bf16_f32 v63, v90, v91
    v_exp_f32 v94, v94
    v_exp_f32 v95, v95
    v_mfma_f32_32x32x16_bf16 v[100:115], v[40:43], v[56:59], v[100:115]
    v_exp_f32 v96, v96
    v_exp_f32 v97, v97
    v_cvt_pk_bf16_f32 v64, v92, v93
    v_exp_f32 v98, v98
    v_cvt_pk_bf16_f32 v65, v94, v95
    v_exp_f32 v99, v99
    v_cvt_pk_bf16_f32 v66, v96, v97
    v_cvt_pk_bf16_f32 v67, v98, v99
    v_mfma_f32_32x32x16_bf16 v[84:99], v[30:33], v[18:21], 0
    v_exp_f32 v68, v68
    v_exp_f32 v69, v69
    v_exp_f32 v70, v70
    v_exp_f32 v71, v71
    v_mfma_f32_32x32x16_bf16 v[116:131], v[36:39], v[60:63], v[116:131]
    v_exp_f32 v72, v72
    v_exp_f32 v73, v73
    v_cvt_pk_bf16_f32 v52, v68, v69
    v_exp_f32 v74, v74
    v_cvt_pk_bf16_f32 v53, v70, v71
    v_exp_f32 v75, v75
    v_mfma_f32_32x32x8_bf16 v[84:99], v[34:35], v[22:23], v[84:99]
    v_exp_f32 v76, v76
    v_cvt_pk_bf16_f32 v54, v72, v73
    v_exp_f32 v77, v77
    v_cvt_pk_bf16_f32 v55, v74, v75
    v_exp_f32 v78, v78
    v_exp_f32 v79, v79
    v_mfma_f32_32x32x16_bf16 v[116:131], v[40:43], v[64:67], v[116:131]
    v_exp_f32 v80, v80
    v_exp_f32 v81, v81
    v_cvt_pk_bf16_f32 v56, v76, v77
    v_exp_f32 v82, v82
    v_cvt_pk_bf16_f32 v57, v78, v79
    v_exp_f32 v83, v83
    v_cvt_pk_bf16_f32 v58, v80, v81
    v_cvt_pk_bf16_f32 v59, v82, v83
    s_waitcnt lgkmcnt(0)
    v_mfma_f32_32x32x16_bf16 v[68:83], v[24:27], v[12:15], 0
    ds_read_b128 v[30:33], v132 offset:22528
    ds_read_b32 v34, v133 offset:19840
    v_exp_f32 v84, v84
    v_exp_f32 v85, v85
    v_exp_f32 v86, v86
    v_exp_f32 v87, v87
    v_mfma_f32_32x32x16_bf16 v[100:115], v[44:47], v[52:55], v[100:115]
    ds_read_b128 v[36:39], v134 offset:21888
    ds_read_b128 v[40:43], v134 offset:22496
    v_exp_f32 v88, v88
    v_exp_f32 v89, v89
    v_cvt_pk_bf16_f32 v60, v84, v85
    v_exp_f32 v90, v90
    v_cvt_pk_bf16_f32 v61, v86, v87
    v_exp_f32 v91, v91
    v_mfma_f32_32x32x8_bf16 v[68:83], v[28:29], v[16:17], v[68:83]
    v_exp_f32 v92, v92
    v_cvt_pk_bf16_f32 v62, v88, v89
    v_exp_f32 v93, v93
    v_cvt_pk_bf16_f32 v63, v90, v91
    v_exp_f32 v94, v94
    v_exp_f32 v95, v95
    v_mfma_f32_32x32x16_bf16 v[100:115], v[48:51], v[56:59], v[100:115]
    v_exp_f32 v96, v96
    v_exp_f32 v97, v97
    v_cvt_pk_bf16_f32 v64, v92, v93
    v_exp_f32 v98, v98
    v_cvt_pk_bf16_f32 v65, v94, v95
    v_exp_f32 v99, v99
    v_cvt_pk_bf16_f32 v66, v96, v97
    v_cvt_pk_bf16_f32 v67, v98, v99
    v_mfma_f32_32x32x16_bf16 v[84:99], v[24:27], v[18:21], 0
    v_exp_f32 v68, v68
    v_exp_f32 v69, v69
    v_exp_f32 v70, v70
    v_exp_f32 v71, v71
    v_mfma_f32_32x32x16_bf16 v[116:131], v[44:47], v[60:63], v[116:131]
    v_exp_f32 v72, v72
    v_exp_f32 v73, v73
    v_cvt_pk_bf16_f32 v52, v68, v69
    v_exp_f32 v74, v74
    v_cvt_pk_bf16_f32 v53, v70, v71
    v_exp_f32 v75, v75
    v_mfma_f32_32x32x8_bf16 v[84:99], v[28:29], v[22:23], v[84:99]
    v_exp_f32 v76, v76
    v_cvt_pk_bf16_f32 v54, v72, v73
    v_exp_f32 v77, v77
    v_cvt_pk_bf16_f32 v55, v74, v75
    v_exp_f32 v78, v78
    v_exp_f32 v79, v79
    v_mfma_f32_32x32x16_bf16 v[116:131], v[48:51], v[64:67], v[116:131]
    v_exp_f32 v80, v80
    v_exp_f32 v81, v81
    v_cvt_pk_bf16_f32 v56, v76, v77
    v_exp_f32 v82, v82
    v_cvt_pk_bf16_f32 v57, v78, v79
    v_exp_f32 v83, v83
    v_cvt_pk_bf16_f32 v58, v80, v81
    v_cvt_pk_bf16_f32 v59, v82, v83
    s_waitcnt lgkmcnt(0)
    v_mfma_f32_32x32x16_bf16 v[68:83], v[30:33], v[12:15], 0
    ds_read_b128 v[24:27], v132 offset:23552
    ds_read_b32 v28, v133 offset:19968
    v_exp_f32 v84, v84
    v_exp_f32 v85, v85
    v_exp_f32 v86, v86
    v_exp_f32 v87, v87
    v_mfma_f32_32x32x16_bf16 v[100:115], v[36:39], v[52:55], v[100:115]
    ds_read_b128 v[44:47], v134 offset:23104
    ds_read_b128 v[48:51], v134 offset:23712
    v_exp_f32 v88, v88
    v_exp_f32 v89, v89
    v_cvt_pk_bf16_f32 v60, v84, v85
    v_exp_f32 v90, v90
    v_cvt_pk_bf16_f32 v61, v86, v87
    v_exp_f32 v91, v91
    v_mfma_f32_32x32x8_bf16 v[68:83], v[34:35], v[16:17], v[68:83]
    v_exp_f32 v92, v92
    v_cvt_pk_bf16_f32 v62, v88, v89
    v_exp_f32 v93, v93
    v_cvt_pk_bf16_f32 v63, v90, v91
    v_exp_f32 v94, v94
    v_exp_f32 v95, v95
    v_mfma_f32_32x32x16_bf16 v[100:115], v[40:43], v[56:59], v[100:115]
    v_exp_f32 v96, v96
    v_exp_f32 v97, v97
    v_cvt_pk_bf16_f32 v64, v92, v93
    v_exp_f32 v98, v98
    v_cvt_pk_bf16_f32 v65, v94, v95
    v_exp_f32 v99, v99
    v_cvt_pk_bf16_f32 v66, v96, v97
    v_cvt_pk_bf16_f32 v67, v98, v99
    v_mfma_f32_32x32x16_bf16 v[84:99], v[30:33], v[18:21], 0
    v_exp_f32 v68, v68
    v_exp_f32 v69, v69
    v_exp_f32 v70, v70
    v_exp_f32 v71, v71
    v_mfma_f32_32x32x16_bf16 v[116:131], v[36:39], v[60:63], v[116:131]
    v_exp_f32 v72, v72
    v_exp_f32 v73, v73
    v_cvt_pk_bf16_f32 v52, v68, v69
    v_exp_f32 v74, v74
    v_cvt_pk_bf16_f32 v53, v70, v71
    v_exp_f32 v75, v75
    v_mfma_f32_32x32x8_bf16 v[84:99], v[34:35], v[22:23], v[84:99]
    v_exp_f32 v76, v76
    v_cvt_pk_bf16_f32 v54, v72, v73
    v_exp_f32 v77, v77
    v_cvt_pk_bf16_f32 v55, v74, v75
    v_exp_f32 v78, v78
    v_exp_f32 v79, v79
    v_mfma_f32_32x32x16_bf16 v[116:131], v[40:43], v[64:67], v[116:131]
    v_exp_f32 v80, v80
    v_exp_f32 v81, v81
    v_cvt_pk_bf16_f32 v56, v76, v77
    v_exp_f32 v82, v82
    v_cvt_pk_bf16_f32 v57, v78, v79
    v_exp_f32 v83, v83
    v_cvt_pk_bf16_f32 v58, v80, v81
    v_cvt_pk_bf16_f32 v59, v82, v83
    s_waitcnt lgkmcnt(0)
    v_mfma_f32_32x32x16_bf16 v[68:83], v[24:27], v[12:15], 0
    ds_read_b128 v[30:33], v132 offset:24576
    ds_read_b32 v34, v133 offset:20096
    v_exp_f32 v84, v84
    v_exp_f32 v85, v85
    v_exp_f32 v86, v86
    v_exp_f32 v87, v87
    v_mfma_f32_32x32x16_bf16 v[100:115], v[44:47], v[52:55], v[100:115]
    ds_read_b128 v[36:39], v134 offset:24320
    ds_read_b128 v[40:43], v134 offset:24928
    v_exp_f32 v88, v88
    v_exp_f32 v89, v89
    v_cvt_pk_bf16_f32 v60, v84, v85
    v_exp_f32 v90, v90
    v_cvt_pk_bf16_f32 v61, v86, v87
    v_exp_f32 v91, v91
    v_mfma_f32_32x32x8_bf16 v[68:83], v[28:29], v[16:17], v[68:83]
    v_exp_f32 v92, v92
    v_cvt_pk_bf16_f32 v62, v88, v89
    v_exp_f32 v93, v93
    v_cvt_pk_bf16_f32 v63, v90, v91
    v_exp_f32 v94, v94
    v_exp_f32 v95, v95
    v_mfma_f32_32x32x16_bf16 v[100:115], v[48:51], v[56:59], v[100:115]
    v_exp_f32 v96, v96
    v_exp_f32 v97, v97
    v_cvt_pk_bf16_f32 v64, v92, v93
    v_exp_f32 v98, v98
    v_cvt_pk_bf16_f32 v65, v94, v95
    v_exp_f32 v99, v99
    v_cvt_pk_bf16_f32 v66, v96, v97
    v_cvt_pk_bf16_f32 v67, v98, v99
    v_mfma_f32_32x32x16_bf16 v[84:99], v[24:27], v[18:21], 0
    v_exp_f32 v68, v68
    v_exp_f32 v69, v69
    v_exp_f32 v70, v70
    v_exp_f32 v71, v71
    v_mfma_f32_32x32x16_bf16 v[116:131], v[44:47], v[60:63], v[116:131]
    v_exp_f32 v72, v72
    v_exp_f32 v73, v73
    v_cvt_pk_bf16_f32 v52, v68, v69
    v_exp_f32 v74, v74
    v_cvt_pk_bf16_f32 v53, v70, v71
    v_exp_f32 v75, v75
    v_mfma_f32_32x32x8_bf16 v[84:99], v[28:29], v[22:23], v[84:99]
    v_exp_f32 v76, v76
    v_cvt_pk_bf16_f32 v54, v72, v73
    v_exp_f32 v77, v77
    v_cvt_pk_bf16_f32 v55, v74, v75
    v_exp_f32 v78, v78
    v_exp_f32 v79, v79
    v_mfma_f32_32x32x16_bf16 v[116:131], v[48:51], v[64:67], v[116:131]
    v_exp_f32 v80, v80
    v_exp_f32 v81, v81
    v_cvt_pk_bf16_f32 v56, v76, v77
    v_exp_f32 v82, v82
    v_cvt_pk_bf16_f32 v57, v78, v79
    v_exp_f32 v83, v83
    v_cvt_pk_bf16_f32 v58, v80, v81
    v_cvt_pk_bf16_f32 v59, v82, v83
    s_waitcnt lgkmcnt(0)
    v_mfma_f32_32x32x16_bf16 v[68:83], v[30:33], v[12:15], 0
    ds_read_b128 v[24:27], v132 offset:25600
    ds_read_b32 v28, v133 offset:20224
    v_exp_f32 v84, v84
    v_exp_f32 v85, v85
    v_exp_f32 v86, v86
    v_exp_f32 v87, v87
    v_mfma_f32_32x32x16_bf16 v[100:115], v[36:39], v[52:55], v[100:115]
    ds_read_b128 v[44:47], v134 offset:25536
    ds_read_b128 v[48:51], v134 offset:26144
    v_exp_f32 v88, v88
    v_exp_f32 v89, v89
    v_cvt_pk_bf16_f32 v60, v84, v85
    v_exp_f32 v90, v90
    v_cvt_pk_bf16_f32 v61, v86, v87
    v_exp_f32 v91, v91
    v_mfma_f32_32x32x8_bf16 v[68:83], v[34:35], v[16:17], v[68:83]
    v_exp_f32 v92, v92
    v_cvt_pk_bf16_f32 v62, v88, v89
    v_exp_f32 v93, v93
    v_cvt_pk_bf16_f32 v63, v90, v91
    v_exp_f32 v94, v94
    v_exp_f32 v95, v95
    v_mfma_f32_32x32x16_bf16 v[100:115], v[40:43], v[56:59], v[100:115]
    v_exp_f32 v96, v96
    v_exp_f32 v97, v97
    v_cvt_pk_bf16_f32 v64, v92, v93
    v_exp_f32 v98, v98
    v_cvt_pk_bf16_f32 v65, v94, v95
    v_exp_f32 v99, v99
    v_cvt_pk_bf16_f32 v66, v96, v97
    v_cvt_pk_bf16_f32 v67, v98, v99
    v_mfma_f32_32x32x16_bf16 v[84:99], v[30:33], v[18:21], 0
    v_exp_f32 v68, v68
    v_exp_f32 v69, v69
    v_exp_f32 v70, v70
    v_exp_f32 v71, v71
    v_mfma_f32_32x32x16_bf16 v[116:131], v[36:39], v[60:63], v[116:131]
    v_exp_f32 v72, v72
    v_exp_f32 v73, v73
    v_cvt_pk_bf16_f32 v52, v68, v69
    v_exp_f32 v74, v74
    v_cvt_pk_bf16_f32 v53, v70, v71
    v_exp_f32 v75, v75
    v_mfma_f32_32x32x8_bf16 v[84:99], v[34:35], v[22:23], v[84:99]
    v_exp_f32 v76, v76
    v_cvt_pk_bf16_f32 v54, v72, v73
    v_exp_f32 v77, v77
    v_cvt_pk_bf16_f32 v55, v74, v75
    v_exp_f32 v78, v78
    v_exp_f32 v79, v79
    v_mfma_f32_32x32x16_bf16 v[116:131], v[40:43], v[64:67], v[116:131]
    v_exp_f32 v80, v80
    v_exp_f32 v81, v81
    v_cvt_pk_bf16_f32 v56, v76, v77
    v_exp_f32 v82, v82
    v_cvt_pk_bf16_f32 v57, v78, v79
    v_exp_f32 v83, v83
    v_cvt_pk_bf16_f32 v58, v80, v81
    v_cvt_pk_bf16_f32 v59, v82, v83
    s_waitcnt lgkmcnt(0)
    v_mfma_f32_32x32x16_bf16 v[68:83], v[24:27], v[12:15], 0
    ds_read_b128 v[30:33], v132 offset:26624
    ds_read_b32 v34, v133 offset:20352
    v_exp_f32 v84, v84
    v_exp_f32 v85, v85
    v_exp_f32 v86, v86
    v_exp_f32 v87, v87
    v_mfma_f32_32x32x16_bf16 v[100:115], v[44:47], v[52:55], v[100:115]
    ds_read_b128 v[36:39], v134 offset:26752
    ds_read_b128 v[40:43], v134 offset:27360
    ds_read_b32 v144, v145 offset:8
    v_exp_f32 v88, v88
    v_exp_f32 v89, v89
    v_cvt_pk_bf16_f32 v60, v84, v85
    v_exp_f32 v90, v90
    v_cvt_pk_bf16_f32 v61, v86, v87
    v_exp_f32 v91, v91
    v_mfma_f32_32x32x8_bf16 v[68:83], v[28:29], v[16:17], v[68:83]
    v_exp_f32 v92, v92
    v_cvt_pk_bf16_f32 v62, v88, v89
    v_exp_f32 v93, v93
    v_cvt_pk_bf16_f32 v63, v90, v91
    v_exp_f32 v94, v94
    v_exp_f32 v95, v95
    v_mfma_f32_32x32x16_bf16 v[100:115], v[48:51], v[56:59], v[100:115]
    v_exp_f32 v96, v96
    v_exp_f32 v97, v97
    v_cvt_pk_bf16_f32 v64, v92, v93
    v_exp_f32 v98, v98
    v_cvt_pk_bf16_f32 v65, v94, v95
    v_exp_f32 v99, v99
    v_cvt_pk_bf16_f32 v66, v96, v97
    v_cvt_pk_bf16_f32 v67, v98, v99
    v_mfma_f32_32x32x16_bf16 v[84:99], v[24:27], v[18:21], 0
    v_exp_f32 v68, v68
    v_exp_f32 v69, v69
    v_exp_f32 v70, v70
    v_exp_f32 v71, v71
    v_mfma_f32_32x32x16_bf16 v[116:131], v[44:47], v[60:63], v[116:131]
    v_exp_f32 v72, v72
    v_exp_f32 v73, v73
    v_cvt_pk_bf16_f32 v52, v68, v69
    v_exp_f32 v74, v74
    v_cvt_pk_bf16_f32 v53, v70, v71
    v_exp_f32 v75, v75
    v_mfma_f32_32x32x8_bf16 v[84:99], v[28:29], v[22:23], v[84:99]
    v_exp_f32 v76, v76
    v_cvt_pk_bf16_f32 v54, v72, v73
    v_exp_f32 v77, v77
    v_cvt_pk_bf16_f32 v55, v74, v75
    v_exp_f32 v78, v78
    v_exp_f32 v79, v79
    v_mfma_f32_32x32x16_bf16 v[116:131], v[48:51], v[64:67], v[116:131]
    v_exp_f32 v80, v80
    v_exp_f32 v81, v81
    v_cvt_pk_bf16_f32 v56, v76, v77
    v_exp_f32 v82, v82
    v_cvt_pk_bf16_f32 v57, v78, v79
    v_exp_f32 v83, v83
    v_cvt_pk_bf16_f32 v58, v80, v81
    v_cvt_pk_bf16_f32 v59, v82, v83
    s_waitcnt lgkmcnt(0)
    v_readfirstlane_b32 s33, v144
    s_nop 0
    s_cmp_eq_u32 s33, 0
    s_cbranch_scc1 L_at_fc1_spin
L_at_fc1_ok:
    v_mfma_f32_32x32x16_bf16 v[68:83], v[30:33], v[12:15], 0
    ds_read_b128 v[24:27], v132 offset:38912
    ds_read_b32 v28, v133 offset:38912
    v_exp_f32 v84, v84
    v_exp_f32 v85, v85
    v_exp_f32 v86, v86
    v_exp_f32 v87, v87
    v_mfma_f32_32x32x16_bf16 v[100:115], v[36:39], v[52:55], v[100:115]
    ds_read_b128 v[44:47], v134 offset:27968
    ds_read_b128 v[48:51], v134 offset:28576
    v_exp_f32 v88, v88
    v_exp_f32 v89, v89
    v_cvt_pk_bf16_f32 v60, v84, v85
    v_exp_f32 v90, v90
    v_cvt_pk_bf16_f32 v61, v86, v87
    v_exp_f32 v91, v91
    v_mfma_f32_32x32x8_bf16 v[68:83], v[34:35], v[16:17], v[68:83]
    v_exp_f32 v92, v92
    v_cvt_pk_bf16_f32 v62, v88, v89
    v_exp_f32 v93, v93
    v_cvt_pk_bf16_f32 v63, v90, v91
    v_exp_f32 v94, v94
    v_exp_f32 v95, v95
    v_mfma_f32_32x32x16_bf16 v[100:115], v[40:43], v[56:59], v[100:115]
    v_exp_f32 v96, v96
    v_exp_f32 v97, v97
    v_cvt_pk_bf16_f32 v64, v92, v93
    v_exp_f32 v98, v98
    v_cvt_pk_bf16_f32 v65, v94, v95
    v_exp_f32 v99, v99
    v_cvt_pk_bf16_f32 v66, v96, v97
    v_cvt_pk_bf16_f32 v67, v98, v99
    v_mfma_f32_32x32x16_bf16 v[84:99], v[30:33], v[18:21], 0
    v_exp_f32 v68, v68
    v_exp_f32 v69, v69
    v_exp_f32 v70, v70
    v_exp_f32 v71, v71
    v_mfma_f32_32x32x16_bf16 v[116:131], v[36:39], v[60:63], v[116:131]
    v_exp_f32 v72, v72
    v_exp_f32 v73, v73
    v_cvt_pk_bf16_f32 v52, v68, v69
    v_exp_f32 v74, v74
    v_cvt_pk_bf16_f32 v53, v70, v71
    v_exp_f32 v75, v75
    v_mfma_f32_32x32x8_bf16 v[84:99], v[34:35], v[22:23], v[84:99]
    v_exp_f32 v76, v76
    v_cvt_pk_bf16_f32 v54, v72, v73
    v_exp_f32 v77, v77
    v_cvt_pk_bf16_f32 v55, v74, v75
    v_exp_f32 v78, v78
    v_exp_f32 v79, v79
    v_mfma_f32_32x32x16_bf16 v[116:131], v[40:43], v[64:67], v[116:131]
    v_exp_f32 v80, v80
    v_exp_f32 v81, v81
    v_cvt_pk_bf16_f32 v56, v76, v77
    v_exp_f32 v82, v82
    v_cvt_pk_bf16_f32 v57, v78, v79
    v_exp_f32 v83, v83
    v_cvt_pk_bf16_f32 v58, v80, v81
    v_cvt_pk_bf16_f32 v59, v82, v83
    s_waitcnt lgkmcnt(0)
    v_mfma_f32_32x32x16_bf16 v[68:83], v[24:27], v[12:15], 0
    ds_read_b128 v[30:33], v132 offset:39936
    ds_read_b32 v34, v133 offset:39040
    v_exp_f32 v84, v84
    v_exp_f32 v85, v85
    v_exp_f32 v86, v86
    v_exp_f32 v87, v87
    v_mfma_f32_32x32x16_bf16 v[100:115], v[44:47], v[52:55], v[100:115]
    ds_read_b128 v[36:39], v134 offset:38912
    ds_read_b128 v[40:43], v134 offset:39520
    v_exp_f32 v88, v88
    v_exp_f32 v89, v89
    v_cvt_pk_bf16_f32 v60, v84, v85
    v_exp_f32 v90, v90
    v_cvt_pk_bf16_f32 v61, v86, v87
    v_exp_f32 v91, v91
    v_mfma_f32_32x32x8_bf16 v[68:83], v[28:29], v[16:17], v[68:83]
    v_exp_f32 v92, v92
    v_cvt_pk_bf16_f32 v62, v88, v89
    v_exp_f32 v93, v93
    v_cvt_pk_bf16_f32 v63, v90, v91
    v_exp_f32 v94, v94
    v_exp_f32 v95, v95
    v_mfma_f32_32x32x16_bf16 v[100:115], v[48:51], v[56:59], v[100:115]
    v_exp_f32 v96, v96
    v_exp_f32 v97, v97
    v_cvt_pk_bf16_f32 v64, v92, v93
    v_exp_f32 v98, v98
    v_cvt_pk_bf16_f32 v65, v94, v95
    v_exp_f32 v99, v99
    v_cvt_pk_bf16_f32 v66, v96, v97
    v_cvt_pk_bf16_f32 v67, v98, v99
    v_mfma_f32_32x32x16_bf16 v[84:99], v[24:27], v[18:21], 0
    v_exp_f32 v68, v68
    v_exp_f32 v69, v69
    v_exp_f32 v70, v70
    v_exp_f32 v71, v71
    v_mfma_f32_32x32x16_bf16 v[116:131], v[44:47], v[60:63], v[116:131]
    v_exp_f32 v72, v72
    v_exp_f32 v73, v73
    v_cvt_pk_bf16_f32 v52, v68, v69
    v_exp_f32 v74, v74
    v_cvt_pk_bf16_f32 v53, v70, v71
    v_exp_f32 v75, v75
    v_mfma_f32_32x32x8_bf16 v[84:99], v[28:29], v[22:23], v[84:99]
    v_exp_f32 v76, v76
    v_cvt_pk_bf16_f32 v54, v72, v73
    v_exp_f32 v77, v77
    v_cvt_pk_bf16_f32 v55, v74, v75
    v_exp_f32 v78, v78
    v_exp_f32 v79, v79
    v_mfma_f32_32x32x16_bf16 v[116:131], v[48:51], v[64:67], v[116:131]
    v_exp_f32 v80, v80
    v_exp_f32 v81, v81
    v_cvt_pk_bf16_f32 v56, v76, v77
    v_exp_f32 v82, v82
    v_cvt_pk_bf16_f32 v57, v78, v79
    v_exp_f32 v83, v83
    v_cvt_pk_bf16_f32 v58, v80, v81
    v_cvt_pk_bf16_f32 v59, v82, v83
    s_waitcnt lgkmcnt(0)
    s_mov_b64 exec, 1
    ds_add_u32 v145, v146 offset:36
    s_mov_b64 exec, -1
    v_mfma_f32_32x32x16_bf16 v[68:83], v[30:33], v[12:15], 0
    ds_read_b128 v[24:27], v132 offset:40960
    ds_read_b32 v28, v133 offset:39168
    v_exp_f32 v84, v84
    v_exp_f32 v85, v85
    v_exp_f32 v86, v86
    v_exp_f32 v87, v87
    v_mfma_f32_32x32x16_bf16 v[100:115], v[36:39], v[52:55], v[100:115]
    ds_read_b128 v[44:47], v134 offset:40128
    ds_read_b128 v[48:51], v134 offset:40736
    v_exp_f32 v88, v88
    v_exp_f32 v89, v89
    v_cvt_pk_bf16_f32 v60, v84, v85
    v_exp_f32 v90, v90
    v_cvt_pk_bf16_f32 v61, v86, v87
    v_exp_f32 v91, v91
    v_mfma_f32_32x32x8_bf16 v[68:83], v[34:35], v[16:17], v[68:83]
    v_exp_f32 v92, v92
    v_cvt_pk_bf16_f32 v62, v88, v89
    v_exp_f32 v93, v93
    v_cvt_pk_bf16_f32 v63, v90, v91
    v_exp_f32 v94, v94
    v_exp_f32 v95, v95
    v_mfma_f32_32x32x16_bf16 v[100:115], v[40:43], v[56:59], v[100:115]
    v_exp_f32 v96, v96
    v_exp_f32 v97, v97
    v_cvt_pk_bf16_f32 v64, v92, v93
    v_exp_f32 v98, v98
    v_cvt_pk_bf16_f32 v65, v94, v95
    v_exp_f32 v99, v99
    v_cvt_pk_bf16_f32 v66, v96, v97
    v_cvt_pk_bf16_f32 v67, v98, v99
    v_mfma_f32_32x32x16_bf16 v[84:99], v[30:33], v[18:21], 0
    v_exp_f32 v68, v68
    v_exp_f32 v69, v69
    v_exp_f32 v70, v70
    v_exp_f32 v71, v71
    v_mfma_f32_32x32x16_bf16 v[116:131], v[36:39], v[60:63], v[116:131]
    v_exp_f32 v72, v72
    v_exp_f32 v73, v73
    v_cvt_pk_bf16_f32 v52, v68, v69
    v_exp_f32 v74, v74
    v_cvt_pk_bf16_f32 v53, v70, v71
    v_exp_f32 v75, v75
    v_mfma_f32_32x32x8_bf16 v[84:99], v[34:35], v[22:23], v[84:99]
    v_exp_f32 v76, v76
    v_cvt_pk_bf16_f32 v54, v72, v73
    v_exp_f32 v77, v77
    v_cvt_pk_bf16_f32 v55, v74, v75
    v_exp_f32 v78, v78
    v_exp_f32 v79, v79
    v_mfma_f32_32x32x16_bf16 v[116:131], v[40:43], v[64:67], v[116:131]
    v_exp_f32 v80, v80
    v_exp_f32 v81, v81
    v_cvt_pk_bf16_f32 v56, v76, v77
    v_exp_f32 v82, v82
    v_cvt_pk_bf16_f32 v57, v78, v79
    v_exp_f32 v83, v83
    v_cvt_pk_bf16_f32 v58, v80, v81
    v_cvt_pk_bf16_f32 v59, v82, v83
    s_waitcnt lgkmcnt(0)
    v_mfma_f32_32x32x16_bf16 v[68:83], v[24:27], v[12:15], 0
    ds_read_b128 v[30:33], v132 offset:41984
    ds_read_b32 v34, v133 offset:39296
    v_exp_f32 v84, v84
    v_exp_f32 v85, v85
    v_exp_f32 v86, v86
    v_exp_f32 v87, v87
    v_mfma_f32_32x32x16_bf16 v[100:115], v[44:47], v[52:55], v[100:115]
    ds_read_b128 v[36:39], v134 offset:41344
    ds_read_b128 v[40:43], v134 offset:41952
    v_exp_f32 v88, v88
    v_exp_f32 v89, v89
    v_cvt_pk_bf16_f32 v60, v84, v85
    v_exp_f32 v90, v90
    v_cvt_pk_bf16_f32 v61, v86, v87
    v_exp_f32 v91, v91
    v_mfma_f32_32x32x8_bf16 v[68:83], v[28:29], v[16:17], v[68:83]
    v_exp_f32 v92, v92
    v_cvt_pk_bf16_f32 v62, v88, v89
    v_exp_f32 v93, v93
    v_cvt_pk_bf16_f32 v63, v90, v91
    v_exp_f32 v94, v94
    v_exp_f32 v95, v95
    v_mfma_f32_32x32x16_bf16 v[100:115], v[48:51], v[56:59], v[100:115]
    v_exp_f32 v96, v96
    v_exp_f32 v97, v97
    v_cvt_pk_bf16_f32 v64, v92, v93
    v_exp_f32 v98, v98
    v_cvt_pk_bf16_f32 v65, v94, v95
    v_exp_f32 v99, v99
    v_cvt_pk_bf16_f32 v66, v96, v97
    v_cvt_pk_bf16_f32 v67, v98, v99
    v_mfma_f32_32x32x16_bf16 v[84:99], v[24:27], v[18:21], 0
    v_exp_f32 v68, v68
    v_exp_f32 v69, v69
    v_exp_f32 v70, v70
    v_exp_f32 v71, v71
    v_mfma_f32_32x32x16_bf16 v[116:131], v[44:47], v[60:63], v[116:131]
    v_exp_f32 v72, v72
    v_exp_f32 v73, v73
    v_cvt_pk_bf16_f32 v52, v68, v69
    v_exp_f32 v74, v74
    v_cvt_pk_bf16_f32 v53, v70, v71
    v_exp_f32 v75, v75
    v_mfma_f32_32x32x8_bf16 v[84:99], v[28:29], v[22:23], v[84:99]
    v_exp_f32 v76, v76
    v_cvt_pk_bf16_f32 v54, v72, v73
    v_exp_f32 v77, v77
    v_cvt_pk_bf16_f32 v55, v74, v75
    v_exp_f32 v78, v78
    v_exp_f32 v79, v79
    v_mfma_f32_32x32x16_bf16 v[116:131], v[48:51], v[64:67], v[116:131]
    v_exp_f32 v80, v80
    v_exp_f32 v81, v81
    v_cvt_pk_bf16_f32 v56, v76, v77
    v_exp_f32 v82, v82
    v_cvt_pk_bf16_f32 v57, v78, v79
    v_exp_f32 v83, v83
    v_cvt_pk_bf16_f32 v58, v80, v81
    v_cvt_pk_bf16_f32 v59, v82, v83
    s_waitcnt lgkmcnt(0)
    v_mfma_f32_32x32x16_bf16 v[68:83], v[30:33], v[12:15], 0
    ds_read_b128 v[24:27], v132 offset:43008
    ds_read_b32 v28, v133 offset:39424
    v_exp_f32 v84, v84
    v_exp_f32 v85, v85
    v_exp_f32 v86, v86
    v_exp_f32 v87, v87
    v_mfma_f32_32x32x16_bf16 v[100:115], v[36:39], v[52:55], v[100:115]
    ds_read_b128 v[44:47], v134 offset:42560
    ds_read_b128 v[48:51], v134 offset:43168
    v_exp_f32 v88, v88
    v_exp_f32 v89, v89
    v_cvt_pk_bf16_f32 v60, v84, v85
    v_exp_f32 v90, v90
    v_cvt_pk_bf16_f32 v61, v86, v87
    v_exp_f32 v91, v91
    v_mfma_f32_32x32x8_bf16 v[68:83], v[34:35], v[16:17], v[68:83]
    v_exp_f32 v92, v92
    v_cvt_pk_bf16_f32 v62, v88, v89
    v_exp_f32 v93, v93
    v_cvt_pk_bf16_f32 v63, v90, v91
    v_exp_f32 v94, v94
    v_exp_f32 v95, v95
    v_mfma_f32_32x32x16_bf16 v[100:115], v[40:43], v[56:59], v[100:115]
    v_exp_f32 v96, v96
    v_exp_f32 v97, v97
    v_cvt_pk_bf16_f32 v64, v92, v93
    v_exp_f32 v98, v98
    v_cvt_pk_bf16_f32 v65, v94, v95
    v_exp_f32 v99, v99
    v_cvt_pk_bf16_f32 v66, v96, v97
    v_cvt_pk_bf16_f32 v67, v98, v99
    v_mfma_f32_32x32x16_bf16 v[84:99], v[30:33], v[18:21], 0
    v_exp_f32 v68, v68
    v_exp_f32 v69, v69
    v_exp_f32 v70, v70
    v_exp_f32 v71, v71
    v_mfma_f32_32x32x16_bf16 v[116:131], v[36:39], v[60:63], v[116:131]
    v_exp_f32 v72, v72
    v_exp_f32 v73, v73
    v_cvt_pk_bf16_f32 v52, v68, v69
    v_exp_f32 v74, v74
    v_cvt_pk_bf16_f32 v53, v70, v71
    v_exp_f32 v75, v75
    v_mfma_f32_32x32x8_bf16 v[84:99], v[34:35], v[22:23], v[84:99]
    v_exp_f32 v76, v76
    v_cvt_pk_bf16_f32 v54, v72, v73
    v_exp_f32 v77, v77
    v_cvt_pk_bf16_f32 v55, v74, v75
    v_exp_f32 v78, v78
    v_exp_f32 v79, v79
    v_mfma_f32_32x32x16_bf16 v[116:131], v[40:43], v[64:67], v[116:131]
    v_exp_f32 v80, v80
    v_exp_f32 v81, v81
    v_cvt_pk_bf16_f32 v56, v76, v77
    v_exp_f32 v82, v82
    v_cvt_pk_bf16_f32 v57, v78, v79
    v_exp_f32 v83, v83
    v_cvt_pk_bf16_f32 v58, v80, v81
    v_cvt_pk_bf16_f32 v59, v82, v83
    s_waitcnt lgkmcnt(0)
    v_mfma_f32_32x32x16_bf16 v[68:83], v[24:27], v[12:15], 0
    ds_read_b128 v[30:33], v132 offset:44032
    ds_read_b32 v34, v133 offset:39552
    v_exp_f32 v84, v84
    v_exp_f32 v85, v85
    v_exp_f32 v86, v86
    v_exp_f32 v87, v87
    v_mfma_f32_32x32x16_bf16 v[100:115], v[44:47], v[52:55], v[100:115]
    ds_read_b128 v[36:39], v134 offset:43776
    ds_read_b128 v[40:43], v134 offset:44384
    v_exp_f32 v88, v88
    v_exp_f32 v89, v89
    v_cvt_pk_bf16_f32 v60, v84, v85
    v_exp_f32 v90, v90
    v_cvt_pk_bf16_f32 v61, v86, v87
    v_exp_f32 v91, v91
    v_mfma_f32_32x32x8_bf16 v[68:83], v[28:29], v[16:17], v[68:83]
    v_exp_f32 v92, v92
    v_cvt_pk_bf16_f32 v62, v88, v89
    v_exp_f32 v93, v93
    v_cvt_pk_bf16_f32 v63, v90, v91
    v_exp_f32 v94, v94
    v_exp_f32 v95, v95
    v_mfma_f32_32x32x16_bf16 v[100:115], v[48:51], v[56:59], v[100:115]
    v_exp_f32 v96, v96
    v_exp_f32 v97, v97
    v_cvt_pk_bf16_f32 v64, v92, v93
    v_exp_f32 v98, v98
    v_cvt_pk_bf16_f32 v65, v94, v95
    v_exp_f32 v99, v99
    v_cvt_pk_bf16_f32 v66, v96, v97
    v_cvt_pk_bf16_f32 v67, v98, v99
    v_mfma_f32_32x32x16_bf16 v[84:99], v[24:27], v[18:21], 0
    v_exp_f32 v68, v68
    v_exp_f32 v69, v69
    v_exp_f32 v70, v70
    v_exp_f32 v71, v71
    v_mfma_f32_32x32x16_bf16 v[116:131], v[44:47], v[60:63], v[116:131]
    v_exp_f32 v72, v72
    v_exp_f32 v73, v73
    v_cvt_pk_bf16_f32 v52, v68, v69
    v_exp_f32 v74, v74
    v_cvt_pk_bf16_f32 v53, v70, v71
    v_exp_f32 v75, v75
    v_mfma_f32_32x32x8_bf16 v[84:99], v[28:29], v[22:23], v[84:99]
    v_exp_f32 v76, v76
    v_cvt_pk_bf16_f32 v54, v72, v73
    v_exp_f32 v77, v77
    v_cvt_pk_bf16_f32 v55, v74, v75
    v_exp_f32 v78, v78
    v_exp_f32 v79, v79
    v_mfma_f32_32x32x16_bf16 v[116:131], v[48:51], v[64:67], v[116:131]
    v_exp_f32 v80, v80
    v_exp_f32 v81, v81
    v_cvt_pk_bf16_f32 v56, v76, v77
    v_exp_f32 v82, v82
    v_cvt_pk_bf16_f32 v57, v78, v79
    v_exp_f32 v83, v83
    v_cvt_pk_bf16_f32 v58, v80, v81
    v_cvt_pk_bf16_f32 v59, v82, v83
    s_waitcnt lgkmcnt(0)
    v_mfma_f32_32x32x16_bf16 v[68:83], v[30:33], v[12:15], 0
    ds_read_b128 v[24:27], v132 offset:45056
    ds_read_b32 v28, v133 offset:39680
    v_exp_f32 v84, v84
    v_exp_f32 v85, v85
    v_exp_f32 v86, v86
    v_exp_f32 v87, v87
    v_mfma_f32_32x32x16_bf16 v[100:115], v[36:39], v[52:55], v[100:115]
    ds_read_b128 v[44:47], v134 offset:44992
    ds_read_b128 v[48:51], v134 offset:45600
    v_exp_f32 v88, v88
    v_exp_f32 v89, v89
    v_cvt_pk_bf16_f32 v60, v84, v85
    v_exp_f32 v90, v90
    v_cvt_pk_bf16_f32 v61, v86, v87
    v_exp_f32 v91, v91
    v_mfma_f32_32x32x8_bf16 v[68:83], v[34:35], v[16:17], v[68:83]
    v_exp_f32 v92, v92
    v_cvt_pk_bf16_f32 v62, v88, v89
    v_exp_f32 v93, v93
    v_cvt_pk_bf16_f32 v63, v90, v91
    v_exp_f32 v94, v94
    v_exp_f32 v95, v95
    v_mfma_f32_32x32x16_bf16 v[100:115], v[40:43], v[56:59], v[100:115]
    v_exp_f32 v96, v96
    v_exp_f32 v97, v97
    v_cvt_pk_bf16_f32 v64, v92, v93
    v_exp_f32 v98, v98
    v_cvt_pk_bf16_f32 v65, v94, v95
    v_exp_f32 v99, v99
    v_cvt_pk_bf16_f32 v66, v96, v97
    v_cvt_pk_bf16_f32 v67, v98, v99
    v_mfma_f32_32x32x16_bf16 v[84:99], v[30:33], v[18:21], 0
    v_exp_f32 v68, v68
    v_exp_f32 v69, v69
    v_exp_f32 v70, v70
    v_exp_f32 v71, v71
    v_mfma_f32_32x32x16_bf16 v[116:131], v[36:39], v[60:63], v[116:131]
    v_exp_f32 v72, v72
    v_exp_f32 v73, v73
    v_cvt_pk_bf16_f32 v52, v68, v69
    v_exp_f32 v74, v74
    v_cvt_pk_bf16_f32 v53, v70, v71
    v_exp_f32 v75, v75
    v_mfma_f32_32x32x8_bf16 v[84:99], v[34:35], v[22:23], v[84:99]
    v_exp_f32 v76, v76
    v_cvt_pk_bf16_f32 v54, v72, v73
    v_exp_f32 v77, v77
    v_cvt_pk_bf16_f32 v55, v74, v75
    v_exp_f32 v78, v78
    v_exp_f32 v79, v79
    v_mfma_f32_32x32x16_bf16 v[116:131], v[40:43], v[64:67], v[116:131]
    v_exp_f32 v80, v80
    v_exp_f32 v81, v81
    v_cvt_pk_bf16_f32 v56, v76, v77
    v_exp_f32 v82, v82
    v_cvt_pk_bf16_f32 v57, v78, v79
    v_exp_f32 v83, v83
    v_cvt_pk_bf16_f32 v58, v80, v81
    v_cvt_pk_bf16_f32 v59, v82, v83
    s_waitcnt lgkmcnt(0)
    v_mfma_f32_32x32x16_bf16 v[68:83], v[24:27], v[12:15], 0
    ds_read_b128 v[30:33], v132 offset:46080
    ds_read_b32 v34, v133 offset:39808
    v_exp_f32 v84, v84
    v_exp_f32 v85, v85
    v_exp_f32 v86, v86
    v_exp_f32 v87, v87
    v_mfma_f32_32x32x16_bf16 v[100:115], v[44:47], v[52:55], v[100:115]
    ds_read_b128 v[36:39], v134 offset:46208
    ds_read_b128 v[40:43], v134 offset:46816
    ds_read_b32 v144, v145 offset:12
    v_exp_f32 v88, v88
    v_exp_f32 v89, v89
    v_cvt_pk_bf16_f32 v60, v84, v85
    v_exp_f32 v90, v90
    v_cvt_pk_bf16_f32 v61, v86, v87
    v_exp_f32 v91, v91
    v_mfma_f32_32x32x8_bf16 v[68:83], v[28:29], v[16:17], v[68:83]
    v_exp_f32 v92, v92
    v_cvt_pk_bf16_f32 v62, v88, v89
    v_exp_f32 v93, v93
    v_cvt_pk_bf16_f32 v63, v90, v91
    v_exp_f32 v94, v94
    v_exp_f32 v95, v95
    v_mfma_f32_32x32x16_bf16 v[100:115], v[48:51], v[56:59], v[100:115]
    v_exp_f32 v96, v96
    v_exp_f32 v97, v97
    v_cvt_pk_bf16_f32 v64, v92, v93
    v_exp_f32 v98, v98
    v_cvt_pk_bf16_f32 v65, v94, v95
    v_exp_f32 v99, v99
    v_cvt_pk_bf16_f32 v66, v96, v97
    v_cvt_pk_bf16_f32 v67, v98, v99
    v_mfma_f32_32x32x16_bf16 v[84:99], v[24:27], v[18:21], 0
    v_exp_f32 v68, v68
    v_exp_f32 v69, v69
    v_exp_f32 v70, v70
    v_exp_f32 v71, v71
    v_mfma_f32_32x32x16_bf16 v[116:131], v[44:47], v[60:63], v[116:131]
    v_exp_f32 v72, v72
    v_exp_f32 v73, v73
    v_cvt_pk_bf16_f32 v52, v68, v69
    v_exp_f32 v74, v74
    v_cvt_pk_bf16_f32 v53, v70, v71
    v_exp_f32 v75, v75
    v_mfma_f32_32x32x8_bf16 v[84:99], v[28:29], v[22:23], v[84:99]
    v_exp_f32 v76, v76
    v_cvt_pk_bf16_f32 v54, v72, v73
    v_exp_f32 v77, v77
    v_cvt_pk_bf16_f32 v55, v74, v75
    v_exp_f32 v78, v78
    v_exp_f32 v79, v79
    v_mfma_f32_32x32x16_bf16 v[116:131], v[48:51], v[64:67], v[116:131]
    v_exp_f32 v80, v80
    v_exp_f32 v81, v81
    v_cvt_pk_bf16_f32 v56, v76, v77
    v_exp_f32 v82, v82
    v_cvt_pk_bf16_f32 v57, v78, v79
    v_exp_f32 v83, v83
    v_cvt_pk_bf16_f32 v58, v80, v81
    v_cvt_pk_bf16_f32 v59, v82, v83
    s_waitcnt lgkmcnt(0)
    v_readfirstlane_b32 s33, v144
    s_nop 0
    s_cmp_eq_u32 s33, 0
    s_cbranch_scc1 L_at_fc2_spin
L_at_fc2_ok:
    v_mfma_f32_32x32x16_bf16 v[68:83], v[30:33], v[12:15], 0
    ds_read_b128 v[24:27], v135 offset:0
    ds_read_b32 v28, v136 offset:0
    v_exp_f32 v84, v84
    v_exp_f32 v85, v85
    v_exp_f32 v86, v86
    v_exp_f32 v87, v87
    v_mfma_f32_32x32x16_bf16 v[100:115], v[36:39], v[52:55], v[100:115]
    ds_read_b128 v[44:47], v134 offset:47424
    ds_read_b128 v[48:51], v134 offset:48032
    v_exp_f32 v88, v88
    v_exp_f32 v89, v89
    v_cvt_pk_bf16_f32 v60, v84, v85
    v_exp_f32 v90, v90
    v_cvt_pk_bf16_f32 v61, v86, v87
    v_exp_f32 v91, v91
    v_mfma_f32_32x32x8_bf16 v[68:83], v[34:35], v[16:17], v[68:83]
    v_exp_f32 v92, v92
    v_cvt_pk_bf16_f32 v62, v88, v89
    v_exp_f32 v93, v93
    v_cvt_pk_bf16_f32 v63, v90, v91
    v_exp_f32 v94, v94
    v_exp_f32 v95, v95
    v_mfma_f32_32x32x16_bf16 v[100:115], v[40:43], v[56:59], v[100:115]
    v_exp_f32 v96, v96
    v_exp_f32 v97, v97
    v_cvt_pk_bf16_f32 v64, v92, v93
    v_exp_f32 v98, v98
    v_cvt_pk_bf16_f32 v65, v94, v95
    v_exp_f32 v99, v99
    v_cvt_pk_bf16_f32 v66, v96, v97
    v_cvt_pk_bf16_f32 v67, v98, v99
    v_mfma_f32_32x32x16_bf16 v[84:99], v[30:33], v[18:21], 0
    v_exp_f32 v68, v68
    v_exp_f32 v69, v69
    v_exp_f32 v70, v70
    v_exp_f32 v71, v71
    v_mfma_f32_32x32x16_bf16 v[116:131], v[36:39], v[60:63], v[116:131]
    v_exp_f32 v72, v72
    v_exp_f32 v73, v73
    v_cvt_pk_bf16_f32 v52, v68, v69
    v_exp_f32 v74, v74
    v_cvt_pk_bf16_f32 v53, v70, v71
    v_exp_f32 v75, v75
    v_mfma_f32_32x32x8_bf16 v[84:99], v[34:35], v[22:23], v[84:99]
    v_exp_f32 v76, v76
    v_cvt_pk_bf16_f32 v54, v72, v73
    v_exp_f32 v77, v77
    v_cvt_pk_bf16_f32 v55, v74, v75
    v_exp_f32 v78, v78
    v_exp_f32 v79, v79
    v_mfma_f32_32x32x16_bf16 v[116:131], v[40:43], v[64:67], v[116:131]
    v_exp_f32 v80, v80
    v_exp_f32 v81, v81
    v_cvt_pk_bf16_f32 v56, v76, v77
    v_exp_f32 v82, v82
    v_cvt_pk_bf16_f32 v57, v78, v79
    v_exp_f32 v83, v83
    v_cvt_pk_bf16_f32 v58, v80, v81
    v_cvt_pk_bf16_f32 v59, v82, v83
    s_waitcnt lgkmcnt(0)
    v_mfma_f32_32x32x16_bf16 v[68:83], v[24:27], v[12:15], 0
    ds_read_b128 v[30:33], v135 offset:1024
    ds_read_b32 v34, v136 offset:128
    v_exp_f32 v84, v84
    v_exp_f32 v85, v85
    v_exp_f32 v86, v86
    v_exp_f32 v87, v87
    v_mfma_f32_32x32x16_bf16 v[100:115], v[44:47], v[52:55], v[100:115]
    ds_read_b128 v[36:39], v137 offset:0
    ds_read_b128 v[40:43], v137 offset:608
    v_exp_f32 v88, v88
    v_exp_f32 v89, v89
    v_cvt_pk_bf16_f32 v60, v84, v85
    v_exp_f32 v90, v90
    v_cvt_pk_bf16_f32 v61, v86, v87
    v_exp_f32 v91, v91
    v_mfma_f32_32x32x8_bf16 v[68:83], v[28:29], v[16:17], v[68:83]
    v_exp_f32 v92, v92
    v_cvt_pk_bf16_f32 v62, v88, v89
    v_exp_f32 v93, v93
    v_cvt_pk_bf16_f32 v63, v90, v91
    v_exp_f32 v94, v94
    v_exp_f32 v95, v95
    v_mfma_f32_32x32x16_bf16 v[100:115], v[48:51], v[56:59], v[100:115]
    v_exp_f32 v96, v96
    v_exp_f32 v97, v97
    v_cvt_pk_bf16_f32 v64, v92, v93
    v_exp_f32 v98, v98
    v_cvt_pk_bf16_f32 v65, v94, v95
    v_exp_f32 v99, v99
    v_cvt_pk_bf16_f32 v66, v96, v97
    v_cvt_pk_bf16_f32 v67, v98, v99
    v_mfma_f32_32x32x16_bf16 v[84:99], v[24:27], v[18:21], 0
    v_exp_f32 v68, v68
    v_exp_f32 v69, v69
    v_exp_f32 v70, v70
    v_exp_f32 v71, v71
    v_mfma_f32_32x32x16_bf16 v[116:131], v[44:47], v[60:63], v[116:131]
    v_exp_f32 v72, v72
    v_exp_f32 v73, v73
    v_cvt_pk_bf16_f32 v52, v68, v69
    v_exp_f32 v74, v74
    v_cvt_pk_bf16_f32 v53, v70, v71
    v_exp_f32 v75, v75
    v_mfma_f32_32x32x8_bf16 v[84:99], v[28:29], v[22:23], v[84:99]
    v_exp_f32 v76, v76
    v_cvt_pk_bf16_f32 v54, v72, v73
    v_exp_f32 v77, v77
    v_cvt_pk_bf16_f32 v55, v74, v75
    v_exp_f32 v78, v78
    v_exp_f32 v79, v79
    v_mfma_f32_32x32x16_bf16 v[116:131], v[48:51], v[64:67], v[116:131]
    v_exp_f32 v80, v80
    v_exp_f32 v81, v81
    v_cvt_pk_bf16_f32 v56, v76, v77
    v_exp_f32 v82, v82
    v_cvt_pk_bf16_f32 v57, v78, v79
    v_exp_f32 v83, v83
    v_cvt_pk_bf16_f32 v58, v80, v81
    v_cvt_pk_bf16_f32 v59, v82, v83
    s_waitcnt lgkmcnt(0)
    v_mfma_f32_32x32x16_bf16 v[68:83], v[30:33], v[12:15], 0
    ds_read_b128 v[24:27], v135 offset:2048
    ds_read_b32 v28, v136 offset:256
    v_exp_f32 v84, v84
    v_exp_f32 v85, v85
    v_exp_f32 v86, v86
    v_exp_f32 v87, v87
    v_mfma_f32_32x32x16_bf16 v[100:115], v[36:39], v[52:55], v[100:115]
    ds_read_b128 v[44:47], v137 offset:1216
    ds_read_b128 v[48:51], v137 offset:1824
    v_exp_f32 v88, v88
    v_exp_f32 v89, v89
    v_cvt_pk_bf16_f32 v60, v84, v85
    v_exp_f32 v90, v90
    v_cvt_pk_bf16_f32 v61, v86, v87
    v_exp_f32 v91, v91
    v_mfma_f32_32x32x8_bf16 v[68:83], v[34:35], v[16:17], v[68:83]
    v_exp_f32 v92, v92
    v_cvt_pk_bf16_f32 v62, v88, v89
    v_exp_f32 v93, v93
    v_cvt_pk_bf16_f32 v63, v90, v91
    v_exp_f32 v94, v94
    v_exp_f32 v95, v95
    v_mfma_f32_32x32x16_bf16 v[100:115], v[40:43], v[56:59], v[100:115]
    v_exp_f32 v96, v96
    v_exp_f32 v97, v97
    v_cvt_pk_bf16_f32 v64, v92, v93
    v_exp_f32 v98, v98
    v_cvt_pk_bf16_f32 v65, v94, v95
    v_exp_f32 v99, v99
    v_cvt_pk_bf16_f32 v66, v96, v97
    v_cvt_pk_bf16_f32 v67, v98, v99
    v_mfma_f32_32x32x16_bf16 v[84:99], v[30:33], v[18:21], 0
    v_exp_f32 v68, v68
    v_exp_f32 v69, v69
    v_exp_f32 v70, v70
    v_exp_f32 v71, v71
    v_mfma_f32_32x32x16_bf16 v[116:131], v[36:39], v[60:63], v[116:131]
    v_exp_f32 v72, v72
    v_exp_f32 v73, v73
    v_cvt_pk_bf16_f32 v52, v68, v69
    v_exp_f32 v74, v74
    v_cvt_pk_bf16_f32 v53, v70, v71
    v_exp_f32 v75, v75
    v_mfma_f32_32x32x8_bf16 v[84:99], v[34:35], v[22:23], v[84:99]
    v_exp_f32 v76, v76
    v_cvt_pk_bf16_f32 v54, v72, v73
    v_exp_f32 v77, v77
    v_cvt_pk_bf16_f32 v55, v74, v75
    v_exp_f32 v78, v78
    v_exp_f32 v79, v79
    v_mfma_f32_32x32x16_bf16 v[116:131], v[40:43], v[64:67], v[116:131]
    v_exp_f32 v80, v80
    v_exp_f32 v81, v81
    v_cvt_pk_bf16_f32 v56, v76, v77
    v_exp_f32 v82, v82
    v_cvt_pk_bf16_f32 v57, v78, v79
    v_exp_f32 v83, v83
    v_cvt_pk_bf16_f32 v58, v80, v81
    v_cvt_pk_bf16_f32 v59, v82, v83
    s_waitcnt lgkmcnt(0)
    v_mfma_f32_32x32x16_bf16 v[68:83], v[24:27], v[12:15], 0
    ds_read_b128 v[30:33], v135 offset:3072
    ds_read_b32 v34, v136 offset:384
    v_exp_f32 v84, v84
    v_exp_f32 v85, v85
    v_exp_f32 v86, v86
    v_exp_f32 v87, v87
    v_mfma_f32_32x32x16_bf16 v[100:115], v[44:47], v[52:55], v[100:115]
    ds_read_b128 v[36:39], v137 offset:2432
    ds_read_b128 v[40:43], v137 offset:3040
    v_exp_f32 v88, v88
    v_exp_f32 v89, v89
    v_cvt_pk_bf16_f32 v60, v84, v85
    v_exp_f32 v90, v90
    v_cvt_pk_bf16_f32 v61, v86, v87
    v_exp_f32 v91, v91
    v_mfma_f32_32x32x8_bf16 v[68:83], v[28:29], v[16:17], v[68:83]
    v_exp_f32 v92, v92
    v_cvt_pk_bf16_f32 v62, v88, v89
    v_exp_f32 v93, v93
    v_cvt_pk_bf16_f32 v63, v90, v91
    v_exp_f32 v94, v94
    v_exp_f32 v95, v95
    v_mfma_f32_32x32x16_bf16 v[100:115], v[48:51], v[56:59], v[100:115]
    v_exp_f32 v96, v96
    v_exp_f32 v97, v97
    v_cvt_pk_bf16_f32 v64, v92, v93
    v_exp_f32 v98, v98
    v_cvt_pk_bf16_f32 v65, v94, v95
    v_exp_f32 v99, v99
    v_cvt_pk_bf16_f32 v66, v96, v97
    v_cvt_pk_bf16_f32 v67, v98, v99
    v_mfma_f32_32x32x16_bf16 v[84:99], v[24:27], v[18:21], 0
    v_exp_f32 v68, v68
    v_exp_f32 v69, v69
    v_exp_f32 v70, v70
    v_exp_f32 v71, v71
    v_mfma_f32_32x32x16_bf16 v[116:131], v[44:47], v[60:63], v[116:131]
    v_exp_f32 v72, v72
    v_exp_f32 v73, v73
    v_cvt_pk_bf16_f32 v52, v68, v69
    v_exp_f32 v74, v74
    v_cvt_pk_bf16_f32 v53, v70, v71
    v_exp_f32 v75, v75
    v_mfma_f32_32x32x8_bf16 v[84:99], v[28:29], v[22:23], v[84:99]
    v_exp_f32 v76, v76
    v_cvt_pk_bf16_f32 v54, v72, v73
    v_exp_f32 v77, v77
    v_cvt_pk_bf16_f32 v55, v74, v75
    v_exp_f32 v78, v78
    v_exp_f32 v79, v79
    v_mfma_f32_32x32x16_bf16 v[116:131], v[48:51], v[64:67], v[116:131]
    v_exp_f32 v80, v80
    v_exp_f32 v81, v81
    v_cvt_pk_bf16_f32 v56, v76, v77
    v_exp_f32 v82, v82
    v_cvt_pk_bf16_f32 v57, v78, v79
    v_exp_f32 v83, v83
    v_cvt_pk_bf16_f32 v58, v80, v81
    v_cvt_pk_bf16_f32 v59, v82, v83
    s_waitcnt lgkmcnt(0)
    v_mfma_f32_32x32x16_bf16 v[68:83], v[30:33], v[12:15], 0
    ds_read_b128 v[24:27], v135 offset:4096
    ds_read_b32 v28, v136 offset:512
    v_exp_f32 v84, v84
    v_exp_f32 v85, v85
    v_exp_f32 v86, v86
    v_exp_f32 v87, v87
    v_mfma_f32_32x32x16_bf16 v[100:115], v[36:39], v[52:55], v[100:115]
    ds_read_b128 v[44:47], v137 offset:3648
    ds_read_b128 v[48:51], v137 offset:4256
    v_exp_f32 v88, v88
    v_exp_f32 v89, v89
    v_cvt_pk_bf16_f32 v60, v84, v85
    v_exp_f32 v90, v90
    v_cvt_pk_bf16_f32 v61, v86, v87
    v_exp_f32 v91, v91
    v_mfma_f32_32x32x8_bf16 v[68:83], v[34:35], v[16:17], v[68:83]
    v_exp_f32 v92, v92
    v_cvt_pk_bf16_f32 v62, v88, v89
    v_exp_f32 v93, v93
    v_cvt_pk_bf16_f32 v63, v90, v91
    v_exp_f32 v94, v94
    v_exp_f32 v95, v95
    v_mfma_f32_32x32x16_bf16 v[100:115], v[40:43], v[56:59], v[100:115]
    v_exp_f32 v96, v96
    v_exp_f32 v97, v97
    v_cvt_pk_bf16_f32 v64, v92, v93
    v_exp_f32 v98, v98
    v_cvt_pk_bf16_f32 v65, v94, v95
    v_exp_f32 v99, v99
    v_cvt_pk_bf16_f32 v66, v96, v97
    v_cvt_pk_bf16_f32 v67, v98, v99
    v_mfma_f32_32x32x16_bf16 v[84:99], v[30:33], v[18:21], 0
    v_exp_f32 v68, v68
    v_exp_f32 v69, v69
    v_exp_f32 v70, v70
    v_exp_f32 v71, v71
    v_mfma_f32_32x32x16_bf16 v[116:131], v[36:39], v[60:63], v[116:131]
    v_exp_f32 v72, v72
    v_exp_f32 v73, v73
    v_cvt_pk_bf16_f32 v52, v68, v69
    v_exp_f32 v74, v74
    v_cvt_pk_bf16_f32 v53, v70, v71
    v_exp_f32 v75, v75
    v_mfma_f32_32x32x8_bf16 v[84:99], v[34:35], v[22:23], v[84:99]
    v_exp_f32 v76, v76
    v_cvt_pk_bf16_f32 v54, v72, v73
    v_exp_f32 v77, v77
    v_cvt_pk_bf16_f32 v55, v74, v75
    v_exp_f32 v78, v78
    v_exp_f32 v79, v79
    v_mfma_f32_32x32x16_bf16 v[116:131], v[40:43], v[64:67], v[116:131]
    v_exp_f32 v80, v80
    v_exp_f32 v81, v81
    v_cvt_pk_bf16_f32 v56, v76, v77
    v_exp_f32 v82, v82
    v_cvt_pk_bf16_f32 v57, v78, v79
    v_exp_f32 v83, v83
    v_cvt_pk_bf16_f32 v58, v80, v81
    v_cvt_pk_bf16_f32 v59, v82, v83
    s_waitcnt lgkmcnt(0)
    v_mfma_f32_32x32x16_bf16 v[68:83], v[24:27], v[12:15], 0
    ds_read_b128 v[30:33], v135 offset:5120
    ds_read_b32 v34, v136 offset:640
    v_exp_f32 v84, v84
    v_exp_f32 v85, v85
    v_exp_f32 v86, v86
    v_exp_f32 v87, v87
    v_mfma_f32_32x32x16_bf16 v[100:115], v[44:47], v[52:55], v[100:115]
    ds_read_b128 v[36:39], v137 offset:4864
    ds_read_b128 v[40:43], v137 offset:5472
    v_exp_f32 v88, v88
    v_exp_f32 v89, v89
    v_cvt_pk_bf16_f32 v60, v84, v85
    v_exp_f32 v90, v90
    v_cvt_pk_bf16_f32 v61, v86, v87
    v_exp_f32 v91, v91
    v_mfma_f32_32x32x8_bf16 v[68:83], v[28:29], v[16:17], v[68:83]
    v_exp_f32 v92, v92
    v_cvt_pk_bf16_f32 v62, v88, v89
    v_exp_f32 v93, v93
    v_cvt_pk_bf16_f32 v63, v90, v91
    v_exp_f32 v94, v94
    v_exp_f32 v95, v95
    v_mfma_f32_32x32x16_bf16 v[100:115], v[48:51], v[56:59], v[100:115]
    v_exp_f32 v96, v96
    v_exp_f32 v97, v97
    v_cvt_pk_bf16_f32 v64, v92, v93
    v_exp_f32 v98, v98
    v_cvt_pk_bf16_f32 v65, v94, v95
    v_exp_f32 v99, v99
    v_cvt_pk_bf16_f32 v66, v96, v97
    v_cvt_pk_bf16_f32 v67, v98, v99
    v_mfma_f32_32x32x16_bf16 v[84:99], v[24:27], v[18:21], 0
    v_exp_f32 v68, v68
    v_exp_f32 v69, v69
    v_exp_f32 v70, v70
    v_exp_f32 v71, v71
    v_mfma_f32_32x32x16_bf16 v[116:131], v[44:47], v[60:63], v[116:131]
    v_exp_f32 v72, v72
    v_exp_f32 v73, v73
    v_cvt_pk_bf16_f32 v52, v68, v69
    v_exp_f32 v74, v74
    v_cvt_pk_bf16_f32 v53, v70, v71
    v_exp_f32 v75, v75
    v_mfma_f32_32x32x8_bf16 v[84:99], v[28:29], v[22:23], v[84:99]
    v_exp_f32 v76, v76
    v_cvt_pk_bf16_f32 v54, v72, v73
    v_exp_f32 v77, v77
    v_cvt_pk_bf16_f32 v55, v74, v75
    v_exp_f32 v78, v78
    v_exp_f32 v79, v79
    v_mfma_f32_32x32x16_bf16 v[116:131], v[48:51], v[64:67], v[116:131]
    v_exp_f32 v80, v80
    v_exp_f32 v81, v81
    v_cvt_pk_bf16_f32 v56, v76, v77
    v_exp_f32 v82, v82
    v_cvt_pk_bf16_f32 v57, v78, v79
    v_exp_f32 v83, v83
    v_cvt_pk_bf16_f32 v58, v80, v81
    v_cvt_pk_bf16_f32 v59, v82, v83
    s_waitcnt lgkmcnt(0)
    v_mfma_f32_32x32x16_bf16 v[68:83], v[30:33], v[12:15], 0
    ds_read_b128 v[24:27], v135 offset:6144
    ds_read_b32 v28, v136 offset:768
    v_exp_f32 v84, v84
    v_exp_f32 v85, v85
    v_exp_f32 v86, v86
    v_exp_f32 v87, v87
    v_mfma_f32_32x32x16_bf16 v[100:115], v[36:39], v[52:55], v[100:115]
    ds_read_b128 v[44:47], v137 offset:6080
    ds_read_b128 v[48:51], v137 offset:6688
    v_exp_f32 v88, v88
    v_exp_f32 v89, v89
    v_cvt_pk_bf16_f32 v60, v84, v85
    v_exp_f32 v90, v90
    v_cvt_pk_bf16_f32 v61, v86, v87
    v_exp_f32 v91, v91
    v_mfma_f32_32x32x8_bf16 v[68:83], v[34:35], v[16:17], v[68:83]
    v_exp_f32 v92, v92
    v_cvt_pk_bf16_f32 v62, v88, v89
    v_exp_f32 v93, v93
    v_cvt_pk_bf16_f32 v63, v90, v91
    v_exp_f32 v94, v94
    v_exp_f32 v95, v95
    v_mfma_f32_32x32x16_bf16 v[100:115], v[40:43], v[56:59], v[100:115]
    v_exp_f32 v96, v96
    v_exp_f32 v97, v97
    v_cvt_pk_bf16_f32 v64, v92, v93
    v_exp_f32 v98, v98
    v_cvt_pk_bf16_f32 v65, v94, v95
    v_exp_f32 v99, v99
    v_cvt_pk_bf16_f32 v66, v96, v97
    v_cvt_pk_bf16_f32 v67, v98, v99
    v_mfma_f32_32x32x16_bf16 v[84:99], v[30:33], v[18:21], 0
    v_exp_f32 v68, v68
    v_exp_f32 v69, v69
    v_exp_f32 v70, v70
    v_exp_f32 v71, v71
    v_mfma_f32_32x32x16_bf16 v[116:131], v[36:39], v[60:63], v[116:131]
    v_exp_f32 v72, v72
    v_exp_f32 v73, v73
    v_cvt_pk_bf16_f32 v52, v68, v69
    v_exp_f32 v74, v74
    v_cvt_pk_bf16_f32 v53, v70, v71
    v_exp_f32 v75, v75
    v_mfma_f32_32x32x8_bf16 v[84:99], v[34:35], v[22:23], v[84:99]
    v_exp_f32 v76, v76
    v_cvt_pk_bf16_f32 v54, v72, v73
    v_exp_f32 v77, v77
    v_cvt_pk_bf16_f32 v55, v74, v75
    v_exp_f32 v78, v78
    v_exp_f32 v79, v79
    v_mfma_f32_32x32x16_bf16 v[116:131], v[40:43], v[64:67], v[116:131]
    v_exp_f32 v80, v80
    v_exp_f32 v81, v81
    v_cvt_pk_bf16_f32 v56, v76, v77
    v_exp_f32 v82, v82
    v_cvt_pk_bf16_f32 v57, v78, v79
    v_exp_f32 v83, v83
    v_cvt_pk_bf16_f32 v58, v80, v81
    v_cvt_pk_bf16_f32 v59, v82, v83
    s_waitcnt lgkmcnt(0)
    v_mfma_f32_32x32x16_bf16 v[68:83], v[24:27], v[12:15], 0
    ds_read_b128 v[30:33], v135 offset:7168
    ds_read_b32 v34, v136 offset:896
    v_exp_f32 v84, v84
    v_exp_f32 v85, v85
    v_exp_f32 v86, v86
    v_exp_f32 v87, v87
    v_mfma_f32_32x32x16_bf16 v[100:115], v[44:47], v[52:55], v[100:115]
    ds_read_b128 v[36:39], v137 offset:7296
    ds_read_b128 v[40:43], v137 offset:7904
    ds_read_b32 v144, v145 offset:16
    v_exp_f32 v88, v88
    v_exp_f32 v89, v89
    v_cvt_pk_bf16_f32 v60, v84, v85
    v_exp_f32 v90, v90
    v_cvt_pk_bf16_f32 v61, v86, v87
    v_exp_f32 v91, v91
    v_mfma_f32_32x32x8_bf16 v[68:83], v[28:29], v[16:17], v[68:83]
    v_exp_f32 v92, v92
    v_cvt_pk_bf16_f32 v62, v88, v89
    v_exp_f32 v93, v93
    v_cvt_pk_bf16_f32 v63, v90, v91
    v_exp_f32 v94, v94
    v_exp_f32 v95, v95
    v_mfma_f32_32x32x16_bf16 v[100:115], v[48:51], v[56:59], v[100:115]
    v_exp_f32 v96, v96
    v_exp_f32 v97, v97
    v_cvt_pk_bf16_f32 v64, v92, v93
    v_exp_f32 v98, v98
    v_cvt_pk_bf16_f32 v65, v94, v95
    v_exp_f32 v99, v99
    v_cvt_pk_bf16_f32 v66, v96, v97
    v_cvt_pk_bf16_f32 v67, v98, v99
    v_mfma_f32_32x32x16_bf16 v[84:99], v[24:27], v[18:21], 0
    v_exp_f32 v68, v68
    v_exp_f32 v69, v69
    v_exp_f32 v70, v70
    v_exp_f32 v71, v71
    v_mfma_f32_32x32x16_bf16 v[116:131], v[44:47], v[60:63], v[116:131]
    v_exp_f32 v72, v72
    v_exp_f32 v73, v73
    v_cvt_pk_bf16_f32 v52, v68, v69
    v_exp_f32 v74, v74
    v_cvt_pk_bf16_f32 v53, v70, v71
    v_exp_f32 v75, v75
    v_mfma_f32_32x32x8_bf16 v[84:99], v[28:29], v[22:23], v[84:99]
    v_exp_f32 v76, v76
    v_cvt_pk_bf16_f32 v54, v72, v73
    v_exp_f32 v77, v77
    v_cvt_pk_bf16_f32 v55, v74, v75
    v_exp_f32 v78, v78
    v_exp_f32 v79, v79
    v_mfma_f32_32x32x16_bf16 v[116:131], v[48:51], v[64:67], v[116:131]
    v_exp_f32 v80, v80
    v_exp_f32 v81, v81
    v_cvt_pk_bf16_f32 v56, v76, v77
    v_exp_f32 v82, v82
    v_cvt_pk_bf16_f32 v57, v78, v79
    v_exp_f32 v83, v83
    v_cvt_pk_bf16_f32 v58, v80, v81
    v_cvt_pk_bf16_f32 v59, v82, v83
    s_waitcnt lgkmcnt(0)
    v_readfirstlane_b32 s33, v144
    s_nop 0
    s_cmp_eq_u32 s33, 0
    s_cbranch_scc1 L_at_fc3_spin
L_at_fc3_ok:
    v_mfma_f32_32x32x16_bf16 v[68:83], v[30:33], v[12:15], 0
    ds_read_b128 v[24:27], v135 offset:19456
    ds_read_b32 v28, v136 offset:19456
    v_exp_f32 v84, v84
    v_exp_f32 v85, v85
    v_exp_f32 v86, v86
    v_exp_f32 v87, v87
    v_mfma_f32_32x32x16_bf16 v[100:115], v[36:39], v[52:55], v[100:115]
    ds_read_b128 v[44:47], v137 offset:8512
    ds_read_b128 v[48:51], v137 offset:9120
    v_exp_f32 v88, v88
    v_exp_f32 v89, v89
    v_cvt_pk_bf16_f32 v60, v84, v85
    v_exp_f32 v90, v90
    v_cvt_pk_bf16_f32 v61, v86, v87
    v_exp_f32 v91, v91
    v_mfma_f32_32x32x8_bf16 v[68:83], v[34:35], v[16:17], v[68:83]
    v_exp_f32 v92, v92
    v_cvt_pk_bf16_f32 v62, v88, v89
    v_exp_f32 v93, v93
    v_cvt_pk_bf16_f32 v63, v90, v91
    v_exp_f32 v94, v94
    v_exp_f32 v95, v95
    v_mfma_f32_32x32x16_bf16 v[100:115], v[40:43], v[56:59], v[100:115]
    v_exp_f32 v96, v96
    v_exp_f32 v97, v97
    v_cvt_pk_bf16_f32 v64, v92, v93
    v_exp_f32 v98, v98
    v_cvt_pk_bf16_f32 v65, v94, v95
    v_exp_f32 v99, v99
    v_cvt_pk_bf16_f32 v66, v96, v97
    v_cvt_pk_bf16_f32 v67, v98, v99
    v_mfma_f32_32x32x16_bf16 v[84:99], v[30:33], v[18:21], 0
    v_exp_f32 v68, v68
    v_exp_f32 v69, v69
    v_exp_f32 v70, v70
    v_exp_f32 v71, v71
    v_mfma_f32_32x32x16_bf16 v[116:131], v[36:39], v[60:63], v[116:131]
    v_exp_f32 v72, v72
    v_exp_f32 v73, v73
    v_cvt_pk_bf16_f32 v52, v68, v69
    v_exp_f32 v74, v74
    v_cvt_pk_bf16_f32 v53, v70, v71
    v_exp_f32 v75, v75
    v_mfma_f32_32x32x8_bf16 v[84:99], v[34:35], v[22:23], v[84:99]
    v_exp_f32 v76, v76
    v_cvt_pk_bf16_f32 v54, v72, v73
    v_exp_f32 v77, v77
    v_cvt_pk_bf16_f32 v55, v74, v75
    v_exp_f32 v78, v78
    v_exp_f32 v79, v79
    v_mfma_f32_32x32x16_bf16 v[116:131], v[40:43], v[64:67], v[116:131]
    v_exp_f32 v80, v80
    v_exp_f32 v81, v81
    v_cvt_pk_bf16_f32 v56, v76, v77
    v_exp_f32 v82, v82
    v_cvt_pk_bf16_f32 v57, v78, v79
    v_exp_f32 v83, v83
    v_cvt_pk_bf16_f32 v58, v80, v81
    v_cvt_pk_bf16_f32 v59, v82, v83
    s_waitcnt lgkmcnt(0)
    v_mfma_f32_32x32x16_bf16 v[68:83], v[24:27], v[12:15], 0
    ds_read_b128 v[30:33], v135 offset:20480
    ds_read_b32 v34, v136 offset:19584
    v_exp_f32 v84, v84
    v_exp_f32 v85, v85
    v_exp_f32 v86, v86
    v_exp_f32 v87, v87
    v_mfma_f32_32x32x16_bf16 v[100:115], v[44:47], v[52:55], v[100:115]
    ds_read_b128 v[36:39], v137 offset:19456
    ds_read_b128 v[40:43], v137 offset:20064
    v_exp_f32 v88, v88
    v_exp_f32 v89, v89
    v_cvt_pk_bf16_f32 v60, v84, v85
    v_exp_f32 v90, v90
    v_cvt_pk_bf16_f32 v61, v86, v87
    v_exp_f32 v91, v91
    v_mfma_f32_32x32x8_bf16 v[68:83], v[28:29], v[16:17], v[68:83]
    v_exp_f32 v92, v92
    v_cvt_pk_bf16_f32 v62, v88, v89
    v_exp_f32 v93, v93
    v_cvt_pk_bf16_f32 v63, v90, v91
    v_exp_f32 v94, v94
    v_exp_f32 v95, v95
    v_mfma_f32_32x32x16_bf16 v[100:115], v[48:51], v[56:59], v[100:115]
    v_exp_f32 v96, v96
    v_exp_f32 v97, v97
    v_cvt_pk_bf16_f32 v64, v92, v93
    v_exp_f32 v98, v98
    v_cvt_pk_bf16_f32 v65, v94, v95
    v_exp_f32 v99, v99
    v_cvt_pk_bf16_f32 v66, v96, v97
    v_cvt_pk_bf16_f32 v67, v98, v99
    v_mfma_f32_32x32x16_bf16 v[84:99], v[24:27], v[18:21], 0
    v_exp_f32 v68, v68
    v_exp_f32 v69, v69
    v_exp_f32 v70, v70
    v_exp_f32 v71, v71
    v_mfma_f32_32x32x16_bf16 v[116:131], v[44:47], v[60:63], v[116:131]
    v_exp_f32 v72, v72
    v_exp_f32 v73, v73
    v_cvt_pk_bf16_f32 v52, v68, v69
    v_exp_f32 v74, v74
    v_cvt_pk_bf16_f32 v53, v70, v71
    v_exp_f32 v75, v75
    v_mfma_f32_32x32x8_bf16 v[84:99], v[28:29], v[22:23], v[84:99]
    v_exp_f32 v76, v76
    v_cvt_pk_bf16_f32 v54, v72, v73
    v_exp_f32 v77, v77
    v_cvt_pk_bf16_f32 v55, v74, v75
    v_exp_f32 v78, v78
    v_exp_f32 v79, v79
    v_mfma_f32_32x32x16_bf16 v[116:131], v[48:51], v[64:67], v[116:131]
    v_exp_f32 v80, v80
    v_exp_f32 v81, v81
    v_cvt_pk_bf16_f32 v56, v76, v77
    v_exp_f32 v82, v82
    v_cvt_pk_bf16_f32 v57, v78, v79
    v_exp_f32 v83, v83
    v_cvt_pk_bf16_f32 v58, v80, v81
    v_cvt_pk_bf16_f32 v59, v82, v83
    s_waitcnt lgkmcnt(0)
    v_mfma_f32_32x32x16_bf16 v[68:83], v[30:33], v[12:15], 0
    ds_read_b128 v[24:27], v135 offset:21504
    ds_read_b32 v28, v136 offset:19712
    v_exp_f32 v84, v84
    v_exp_f32 v85, v85
    v_exp_f32 v86, v86
    v_exp_f32 v87, v87
    v_mfma_f32_32x32x16_bf16 v[100:115], v[36:39], v[52:55], v[100:115]
    ds_read_b128 v[44:47], v137 offset:20672
    ds_read_b128 v[48:51], v137 offset:21280
    v_exp_f32 v88, v88
    v_exp_f32 v89, v89
    v_cvt_pk_bf16_f32 v60, v84, v85
    v_exp_f32 v90, v90
    v_cvt_pk_bf16_f32 v61, v86, v87
    v_exp_f32 v91, v91
    v_mfma_f32_32x32x8_bf16 v[68:83], v[34:35], v[16:17], v[68:83]
    v_exp_f32 v92, v92
    v_cvt_pk_bf16_f32 v62, v88, v89
    v_exp_f32 v93, v93
    v_cvt_pk_bf16_f32 v63, v90, v91
    v_exp_f32 v94, v94
    v_exp_f32 v95, v95
    v_mfma_f32_32x32x16_bf16 v[100:115], v[40:43], v[56:59], v[100:115]
    v_exp_f32 v96, v96
    v_exp_f32 v97, v97
    v_cvt_pk_bf16_f32 v64, v92, v93
    v_exp_f32 v98, v98
    v_cvt_pk_bf16_f32 v65, v94, v95
    v_exp_f32 v99, v99
    v_cvt_pk_bf16_f32 v66, v96, v97
    v_cvt_pk_bf16_f32 v67, v98, v99
    v_mfma_f32_32x32x16_bf16 v[84:99], v[30:33], v[18:21], 0
    v_exp_f32 v68, v68
    v_exp_f32 v69, v69
    v_exp_f32 v70, v70
    v_exp_f32 v71, v71
    v_mfma_f32_32x32x16_bf16 v[116:131], v[36:39], v[60:63], v[116:131]
    v_exp_f32 v72, v72
    v_exp_f32 v73, v73
    v_cvt_pk_bf16_f32 v52, v68, v69
    v_exp_f32 v74, v74
    v_cvt_pk_bf16_f32 v53, v70, v71
    v_exp_f32 v75, v75
    v_mfma_f32_32x32x8_bf16 v[84:99], v[34:35], v[22:23], v[84:99]
    v_exp_f32 v76, v76
    v_cvt_pk_bf16_f32 v54, v72, v73
    v_exp_f32 v77, v77
    v_cvt_pk_bf16_f32 v55, v74, v75
    v_exp_f32 v78, v78
    v_exp_f32 v79, v79
    v_mfma_f32_32x32x16_bf16 v[116:131], v[40:43], v[64:67], v[116:131]
    v_exp_f32 v80, v80
    v_exp_f32 v81, v81
    v_cvt_pk_bf16_f32 v56, v76, v77
    v_exp_f32 v82, v82
    v_cvt_pk_bf16_f32 v57, v78, v79
    v_exp_f32 v83, v83
    v_cvt_pk_bf16_f32 v58, v80, v81
    v_cvt_pk_bf16_f32 v59, v82, v83
    s_waitcnt lgkmcnt(0)
    v_mfma_f32_32x32x16_bf16 v[68:83], v[24:27], v[12:15], 0
    ds_read_b128 v[30:33], v135 offset:22528
    ds_read_b32 v34, v136 offset:19840
    v_exp_f32 v84, v84
    v_exp_f32 v85, v85
    v_exp_f32 v86, v86
    v_exp_f32 v87, v87
    v_mfma_f32_32x32x16_bf16 v[100:115], v[44:47], v[52:55], v[100:115]
    ds_read_b128 v[36:39], v137 offset:21888
    ds_read_b128 v[40:43], v137 offset:22496
    v_exp_f32 v88, v88
    v_exp_f32 v89, v89
    v_cvt_pk_bf16_f32 v60, v84, v85
    v_exp_f32 v90, v90
    v_cvt_pk_bf16_f32 v61, v86, v87
    v_exp_f32 v91, v91
    v_mfma_f32_32x32x8_bf16 v[68:83], v[28:29], v[16:17], v[68:83]
    v_exp_f32 v92, v92
    v_cvt_pk_bf16_f32 v62, v88, v89
    v_exp_f32 v93, v93
    v_cvt_pk_bf16_f32 v63, v90, v91
    v_exp_f32 v94, v94
    v_exp_f32 v95, v95
    v_mfma_f32_32x32x16_bf16 v[100:115], v[48:51], v[56:59], v[100:115]
    v_exp_f32 v96, v96
    v_exp_f32 v97, v97
    v_cvt_pk_bf16_f32 v64, v92, v93
    v_exp_f32 v98, v98
    v_cvt_pk_bf16_f32 v65, v94, v95
    v_exp_f32 v99, v99
    v_cvt_pk_bf16_f32 v66, v96, v97
    v_cvt_pk_bf16_f32 v67, v98, v99
    v_mfma_f32_32x32x16_bf16 v[84:99], v[24:27], v[18:21], 0
    v_exp_f32 v68, v68
    v_exp_f32 v69, v69
    v_exp_f32 v70, v70
    v_exp_f32 v71, v71
    v_mfma_f32_32x32x16_bf16 v[116:131], v[44:47], v[60:63], v[116:131]
    v_exp_f32 v72, v72
    v_exp_f32 v73, v73
    v_cvt_pk_bf16_f32 v52, v68, v69
    v_exp_f32 v74, v74
    v_cvt_pk_bf16_f32 v53, v70, v71
    v_exp_f32 v75, v75
    v_mfma_f32_32x32x8_bf16 v[84:99], v[28:29], v[22:23], v[84:99]
    v_exp_f32 v76, v76
    v_cvt_pk_bf16_f32 v54, v72, v73
    v_exp_f32 v77, v77
    v_cvt_pk_bf16_f32 v55, v74, v75
    v_exp_f32 v78, v78
    v_exp_f32 v79, v79
    v_mfma_f32_32x32x16_bf16 v[116:131], v[48:51], v[64:67], v[116:131]
    v_exp_f32 v80, v80
    v_exp_f32 v81, v81
    v_cvt_pk_bf16_f32 v56, v76, v77
    v_exp_f32 v82, v82
    v_cvt_pk_bf16_f32 v57, v78, v79
    v_exp_f32 v83, v83
    v_cvt_pk_bf16_f32 v58, v80, v81
    v_cvt_pk_bf16_f32 v59, v82, v83
    s_waitcnt lgkmcnt(0)
    v_mfma_f32_32x32x16_bf16 v[68:83], v[30:33], v[12:15], 0
    ds_read_b128 v[24:27], v135 offset:23552
    ds_read_b32 v28, v136 offset:19968
    v_exp_f32 v84, v84
    v_exp_f32 v85, v85
    v_exp_f32 v86, v86
    v_exp_f32 v87, v87
    v_mfma_f32_32x32x16_bf16 v[100:115], v[36:39], v[52:55], v[100:115]
    ds_read_b128 v[44:47], v137 offset:23104
    ds_read_b128 v[48:51], v137 offset:23712
    v_exp_f32 v88, v88
    v_exp_f32 v89, v89
    v_cvt_pk_bf16_f32 v60, v84, v85
    v_exp_f32 v90, v90
    v_cvt_pk_bf16_f32 v61, v86, v87
    v_exp_f32 v91, v91
    v_mfma_f32_32x32x8_bf16 v[68:83], v[34:35], v[16:17], v[68:83]
    v_exp_f32 v92, v92
    v_cvt_pk_bf16_f32 v62, v88, v89
    v_exp_f32 v93, v93
    v_cvt_pk_bf16_f32 v63, v90, v91
    v_exp_f32 v94, v94
    v_exp_f32 v95, v95
    v_mfma_f32_32x32x16_bf16 v[100:115], v[40:43], v[56:59], v[100:115]
    v_exp_f32 v96, v96
    v_exp_f32 v97, v97
    v_cvt_pk_bf16_f32 v64, v92, v93
    v_exp_f32 v98, v98
    v_cvt_pk_bf16_f32 v65, v94, v95
    v_exp_f32 v99, v99
    v_cvt_pk_bf16_f32 v66, v96, v97
    v_cvt_pk_bf16_f32 v67, v98, v99
    v_mfma_f32_32x32x16_bf16 v[84:99], v[30:33], v[18:21], 0
    v_exp_f32 v68, v68
    v_exp_f32 v69, v69
    v_exp_f32 v70, v70
    v_exp_f32 v71, v71
    v_mfma_f32_32x32x16_bf16 v[116:131], v[36:39], v[60:63], v[116:131]
    v_exp_f32 v72, v72
    v_exp_f32 v73, v73
    v_cvt_pk_bf16_f32 v52, v68, v69
    v_exp_f32 v74, v74
    v_cvt_pk_bf16_f32 v53, v70, v71
    v_exp_f32 v75, v75
    v_mfma_f32_32x32x8_bf16 v[84:99], v[34:35], v[22:23], v[84:99]
    v_exp_f32 v76, v76
    v_cvt_pk_bf16_f32 v54, v72, v73
    v_exp_f32 v77, v77
    v_cvt_pk_bf16_f32 v55, v74, v75
    v_exp_f32 v78, v78
    v_exp_f32 v79, v79
    v_mfma_f32_32x32x16_bf16 v[116:131], v[40:43], v[64:67], v[116:131]
    v_exp_f32 v80, v80
    v_exp_f32 v81, v81
    v_cvt_pk_bf16_f32 v56, v76, v77
    v_exp_f32 v82, v82
    v_cvt_pk_bf16_f32 v57, v78, v79
    v_exp_f32 v83, v83
    v_cvt_pk_bf16_f32 v58, v80, v81
    v_cvt_pk_bf16_f32 v59, v82, v83
    s_waitcnt lgkmcnt(0)
    v_mfma_f32_32x32x16_bf16 v[68:83], v[24:27], v[12:15], 0
    ds_read_b128 v[30:33], v135 offset:24576
    ds_read_b32 v34, v136 offset:20096
    v_exp_f32 v84, v84
    v_exp_f32 v85, v85
    v_exp_f32 v86, v86
    v_exp_f32 v87, v87
    v_mfma_f32_32x32x16_bf16 v[100:115], v[44:47], v[52:55], v[100:115]
    ds_read_b128 v[36:39], v137 offset:24320
    ds_read_b128 v[40:43], v137 offset:24928
    v_exp_f32 v88, v88
    v_exp_f32 v89, v89
    v_cvt_pk_bf16_f32 v60, v84, v85
    v_exp_f32 v90, v90
    v_cvt_pk_bf16_f32 v61, v86, v87
    v_exp_f32 v91, v91
    v_mfma_f32_32x32x8_bf16 v[68:83], v[28:29], v[16:17], v[68:83]
    v_exp_f32 v92, v92
    v_cvt_pk_bf16_f32 v62, v88, v89
    v_exp_f32 v93, v93
    v_cvt_pk_bf16_f32 v63, v90, v91
    v_exp_f32 v94, v94
    v_exp_f32 v95, v95
    v_mfma_f32_32x32x16_bf16 v[100:115], v[48:51], v[56:59], v[100:115]
    v_exp_f32 v96, v96
    v_exp_f32 v97, v97
    v_cvt_pk_bf16_f32 v64, v92, v93
    v_exp_f32 v98, v98
    v_cvt_pk_bf16_f32 v65, v94, v95
    v_exp_f32 v99, v99
    v_cvt_pk_bf16_f32 v66, v96, v97
    v_cvt_pk_bf16_f32 v67, v98, v99
    v_mfma_f32_32x32x16_bf16 v[84:99], v[24:27], v[18:21], 0
    v_exp_f32 v68, v68
    v_exp_f32 v69, v69
    v_exp_f32 v70, v70
    v_exp_f32 v71, v71
    v_mfma_f32_32x32x16_bf16 v[116:131], v[44:47], v[60:63], v[116:131]
    v_exp_f32 v72, v72
    v_exp_f32 v73, v73
    v_cvt_pk_bf16_f32 v52, v68, v69
    v_exp_f32 v74, v74
    v_cvt_pk_bf16_f32 v53, v70, v71
    v_exp_f32 v75, v75
    v_mfma_f32_32x32x8_bf16 v[84:99], v[28:29], v[22:23], v[84:99]
    v_exp_f32 v76, v76
    v_cvt_pk_bf16_f32 v54, v72, v73
    v_exp_f32 v77, v77
    v_cvt_pk_bf16_f32 v55, v74, v75
    v_exp_f32 v78, v78
    v_exp_f32 v79, v79
    v_mfma_f32_32x32x16_bf16 v[116:131], v[48:51], v[64:67], v[116:131]
    v_exp_f32 v80, v80
    v_exp_f32 v81, v81
    v_cvt_pk_bf16_f32 v56, v76, v77
    v_exp_f32 v82, v82
    v_cvt_pk_bf16_f32 v57, v78, v79
    v_exp_f32 v83, v83
    v_cvt_pk_bf16_f32 v58, v80, v81
    v_cvt_pk_bf16_f32 v59, v82, v83
    s_waitcnt lgkmcnt(0)
    v_mfma_f32_32x32x16_bf16 v[68:83], v[30:33], v[12:15], 0
    ds_read_b128 v[24:27], v135 offset:25600
    ds_read_b32 v28, v136 offset:20224
    v_exp_f32 v84, v84
    v_exp_f32 v85, v85
    v_exp_f32 v86, v86
    v_exp_f32 v87, v87
    v_mfma_f32_32x32x16_bf16 v[100:115], v[36:39], v[52:55], v[100:115]
    ds_read_b128 v[44:47], v137 offset:25536
    ds_read_b128 v[48:51], v137 offset:26144
    v_exp_f32 v88, v88
    v_exp_f32 v89, v89
    v_cvt_pk_bf16_f32 v60, v84, v85
    v_exp_f32 v90, v90
    v_cvt_pk_bf16_f32 v61, v86, v87
    v_exp_f32 v91, v91
    v_mfma_f32_32x32x8_bf16 v[68:83], v[34:35], v[16:17], v[68:83]
    v_exp_f32 v92, v92
    v_cvt_pk_bf16_f32 v62, v88, v89
    v_exp_f32 v93, v93
    v_cvt_pk_bf16_f32 v63, v90, v91
    v_exp_f32 v94, v94
    v_exp_f32 v95, v95
    v_mfma_f32_32x32x16_bf16 v[100:115], v[40:43], v[56:59], v[100:115]
    v_exp_f32 v96, v96
    v_exp_f32 v97, v97
    v_cvt_pk_bf16_f32 v64, v92, v93
    v_exp_f32 v98, v98
    v_cvt_pk_bf16_f32 v65, v94, v95
    v_exp_f32 v99, v99
    v_cvt_pk_bf16_f32 v66, v96, v97
    v_cvt_pk_bf16_f32 v67, v98, v99
    v_mfma_f32_32x32x16_bf16 v[84:99], v[30:33], v[18:21], 0
    v_exp_f32 v68, v68
    v_exp_f32 v69, v69
    v_exp_f32 v70, v70
    v_exp_f32 v71, v71
    v_mfma_f32_32x32x16_bf16 v[116:131], v[36:39], v[60:63], v[116:131]
    v_exp_f32 v72, v72
    v_exp_f32 v73, v73
    v_cvt_pk_bf16_f32 v52, v68, v69
    v_exp_f32 v74, v74
    v_cvt_pk_bf16_f32 v53, v70, v71
    v_exp_f32 v75, v75
    v_mfma_f32_32x32x8_bf16 v[84:99], v[34:35], v[22:23], v[84:99]
    v_exp_f32 v76, v76
    v_cvt_pk_bf16_f32 v54, v72, v73
    v_exp_f32 v77, v77
    v_cvt_pk_bf16_f32 v55, v74, v75
    v_exp_f32 v78, v78
    v_exp_f32 v79, v79
    v_mfma_f32_32x32x16_bf16 v[116:131], v[40:43], v[64:67], v[116:131]
    v_exp_f32 v80, v80
    v_exp_f32 v81, v81
    v_cvt_pk_bf16_f32 v56, v76, v77
    v_exp_f32 v82, v82
    v_cvt_pk_bf16_f32 v57, v78, v79
    v_exp_f32 v83, v83
    v_cvt_pk_bf16_f32 v58, v80, v81
    v_cvt_pk_bf16_f32 v59, v82, v83
    s_waitcnt lgkmcnt(0)
    v_mfma_f32_32x32x16_bf16 v[68:83], v[24:27], v[12:15], 0
    ds_read_b128 v[30:33], v135 offset:26624
    ds_read_b32 v34, v136 offset:20352
    v_exp_f32 v84, v84
    v_exp_f32 v85, v85
    v_exp_f32 v86, v86
    v_exp_f32 v87, v87
    v_mfma_f32_32x32x16_bf16 v[100:115], v[44:47], v[52:55], v[100:115]
    ds_read_b128 v[36:39], v137 offset:26752
    ds_read_b128 v[40:43], v137 offset:27360
    ds_read_b32 v144, v145 offset:20
    v_exp_f32 v88, v88
    v_exp_f32 v89, v89
    v_cvt_pk_bf16_f32 v60, v84, v85
    v_exp_f32 v90, v90
    v_cvt_pk_bf16_f32 v61, v86, v87
    v_exp_f32 v91, v91
    v_mfma_f32_32x32x8_bf16 v[68:83], v[28:29], v[16:17], v[68:83]
    v_exp_f32 v92, v92
    v_cvt_pk_bf16_f32 v62, v88, v89
    v_exp_f32 v93, v93
    v_cvt_pk_bf16_f32 v63, v90, v91
    v_exp_f32 v94, v94
    v_exp_f32 v95, v95
    v_mfma_f32_32x32x16_bf16 v[100:115], v[48:51], v[56:59], v[100:115]
    v_exp_f32 v96, v96
    v_exp_f32 v97, v97
    v_cvt_pk_bf16_f32 v64, v92, v93
    v_exp_f32 v98, v98
    v_cvt_pk_bf16_f32 v65, v94, v95
    v_exp_f32 v99, v99
    v_cvt_pk_bf16_f32 v66, v96, v97
    v_cvt_pk_bf16_f32 v67, v98, v99
    v_mfma_f32_32x32x16_bf16 v[84:99], v[24:27], v[18:21], 0
    v_exp_f32 v68, v68
    v_exp_f32 v69, v69
    v_exp_f32 v70, v70
    v_exp_f32 v71, v71
    v_mfma_f32_32x32x16_bf16 v[116:131], v[44:47], v[60:63], v[116:131]
    v_exp_f32 v72, v72
    v_exp_f32 v73, v73
    v_cvt_pk_bf16_f32 v52, v68, v69
    v_exp_f32 v74, v74
    v_cvt_pk_bf16_f32 v53, v70, v71
    v_exp_f32 v75, v75
    v_mfma_f32_32x32x8_bf16 v[84:99], v[28:29], v[22:23], v[84:99]
    v_exp_f32 v76, v76
    v_cvt_pk_bf16_f32 v54, v72, v73
    v_exp_f32 v77, v77
    v_cvt_pk_bf16_f32 v55, v74, v75
    v_exp_f32 v78, v78
    v_exp_f32 v79, v79
    v_mfma_f32_32x32x16_bf16 v[116:131], v[48:51], v[64:67], v[116:131]
    v_exp_f32 v80, v80
    v_exp_f32 v81, v81
    v_cvt_pk_bf16_f32 v56, v76, v77
    v_exp_f32 v82, v82
    v_cvt_pk_bf16_f32 v57, v78, v79
    v_exp_f32 v83, v83
    v_cvt_pk_bf16_f32 v58, v80, v81
    v_cvt_pk_bf16_f32 v59, v82, v83
    s_waitcnt lgkmcnt(0)
    v_readfirstlane_b32 s33, v144
    s_nop 0
    s_cmp_eq_u32 s33, 0
    s_cbranch_scc1 L_at_fc4_spin
L_at_fc4_ok:
    v_mfma_f32_32x32x16_bf16 v[68:83], v[30:33], v[12:15], 0
    ds_read_b128 v[24:27], v135 offset:38912
    ds_read_b32 v28, v136 offset:38912
    v_exp_f32 v84, v84
    v_exp_f32 v85, v85
    v_exp_f32 v86, v86
    v_exp_f32 v87, v87
    v_mfma_f32_32x32x16_bf16 v[100:115], v[36:39], v[52:55], v[100:115]
    ds_read_b128 v[44:47], v137 offset:27968
    ds_read_b128 v[48:51], v137 offset:28576
    v_exp_f32 v88, v88
    v_exp_f32 v89, v89
    v_cvt_pk_bf16_f32 v60, v84, v85
    v_exp_f32 v90, v90
    v_cvt_pk_bf16_f32 v61, v86, v87
    v_exp_f32 v91, v91
    v_mfma_f32_32x32x8_bf16 v[68:83], v[34:35], v[16:17], v[68:83]
    v_exp_f32 v92, v92
    v_cvt_pk_bf16_f32 v62, v88, v89
    v_exp_f32 v93, v93
    v_cvt_pk_bf16_f32 v63, v90, v91
    v_exp_f32 v94, v94
    v_exp_f32 v95, v95
    v_mfma_f32_32x32x16_bf16 v[100:115], v[40:43], v[56:59], v[100:115]
    v_exp_f32 v96, v96
    v_exp_f32 v97, v97
    v_cvt_pk_bf16_f32 v64, v92, v93
    v_exp_f32 v98, v98
    v_cvt_pk_bf16_f32 v65, v94, v95
    v_exp_f32 v99, v99
    v_cvt_pk_bf16_f32 v66, v96, v97
    v_cvt_pk_bf16_f32 v67, v98, v99
    v_mfma_f32_32x32x16_bf16 v[84:99], v[30:33], v[18:21], 0
    v_exp_f32 v68, v68
    v_exp_f32 v69, v69
    v_exp_f32 v70, v70
    v_exp_f32 v71, v71
    v_mfma_f32_32x32x16_bf16 v[116:131], v[36:39], v[60:63], v[116:131]
    v_exp_f32 v72, v72
    v_exp_f32 v73, v73
    v_cvt_pk_bf16_f32 v52, v68, v69
    v_exp_f32 v74, v74
    v_cvt_pk_bf16_f32 v53, v70, v71
    v_exp_f32 v75, v75
    v_mfma_f32_32x32x8_bf16 v[84:99], v[34:35], v[22:23], v[84:99]
    v_exp_f32 v76, v76
    v_cvt_pk_bf16_f32 v54, v72, v73
    v_exp_f32 v77, v77
    v_cvt_pk_bf16_f32 v55, v74, v75
    v_exp_f32 v78, v78
    v_exp_f32 v79, v79
    v_mfma_f32_32x32x16_bf16 v[116:131], v[40:43], v[64:67], v[116:131]
    v_exp_f32 v80, v80
    v_exp_f32 v81, v81
    v_cvt_pk_bf16_f32 v56, v76, v77
    v_exp_f32 v82, v82
    v_cvt_pk_bf16_f32 v57, v78, v79
    v_exp_f32 v83, v83
    v_cvt_pk_bf16_f32 v58, v80, v81
    v_cvt_pk_bf16_f32 v59, v82, v83
    s_waitcnt lgkmcnt(0)
    v_mfma_f32_32x32x16_bf16 v[68:83], v[24:27], v[12:15], 0
    ds_read_b128 v[30:33], v135 offset:39936
    ds_read_b32 v34, v136 offset:39040
    v_exp_f32 v84, v84
    v_exp_f32 v85, v85
    v_exp_f32 v86, v86
    v_exp_f32 v87, v87
    v_mfma_f32_32x32x16_bf16 v[100:115], v[44:47], v[52:55], v[100:115]
    ds_read_b128 v[36:39], v137 offset:38912
    ds_read_b128 v[40:43], v137 offset:39520
    v_exp_f32 v88, v88
    v_exp_f32 v89, v89
    v_cvt_pk_bf16_f32 v60, v84, v85
    v_exp_f32 v90, v90
    v_cvt_pk_bf16_f32 v61, v86, v87
    v_exp_f32 v91, v91
    v_mfma_f32_32x32x8_bf16 v[68:83], v[28:29], v[16:17], v[68:83]
    v_exp_f32 v92, v92
    v_cvt_pk_bf16_f32 v62, v88, v89
    v_exp_f32 v93, v93
    v_cvt_pk_bf16_f32 v63, v90, v91
    v_exp_f32 v94, v94
    v_exp_f32 v95, v95
    v_mfma_f32_32x32x16_bf16 v[100:115], v[48:51], v[56:59], v[100:115]
    v_exp_f32 v96, v96
    v_exp_f32 v97, v97
    v_cvt_pk_bf16_f32 v64, v92, v93
    v_exp_f32 v98, v98
    v_cvt_pk_bf16_f32 v65, v94, v95
    v_exp_f32 v99, v99
    v_cvt_pk_bf16_f32 v66, v96, v97
    v_cvt_pk_bf16_f32 v67, v98, v99
    v_mfma_f32_32x32x16_bf16 v[84:99], v[24:27], v[18:21], 0
    v_exp_f32 v68, v68
    v_exp_f32 v69, v69
    v_exp_f32 v70, v70
    v_exp_f32 v71, v71
    v_mfma_f32_32x32x16_bf16 v[116:131], v[44:47], v[60:63], v[116:131]
    v_exp_f32 v72, v72
    v_exp_f32 v73, v73
    v_cvt_pk_bf16_f32 v52, v68, v69
    v_exp_f32 v74, v74
    v_cvt_pk_bf16_f32 v53, v70, v71
    v_exp_f32 v75, v75
    v_mfma_f32_32x32x8_bf16 v[84:99], v[28:29], v[22:23], v[84:99]
    v_exp_f32 v76, v76
    v_cvt_pk_bf16_f32 v54, v72, v73
    v_exp_f32 v77, v77
    v_cvt_pk_bf16_f32 v55, v74, v75
    v_exp_f32 v78, v78
    v_exp_f32 v79, v79
    v_mfma_f32_32x32x16_bf16 v[116:131], v[48:51], v[64:67], v[116:131]
    v_exp_f32 v80, v80
    v_exp_f32 v81, v81
    v_cvt_pk_bf16_f32 v56, v76, v77
    v_exp_f32 v82, v82
    v_cvt_pk_bf16_f32 v57, v78, v79
    v_exp_f32 v83, v83
    v_cvt_pk_bf16_f32 v58, v80, v81
    v_cvt_pk_bf16_f32 v59, v82, v83
    s_waitcnt lgkmcnt(0)
    v_mfma_f32_32x32x16_bf16 v[68:83], v[30:33], v[12:15], 0
    ds_read_b128 v[24:27], v135 offset:40960
    ds_read_b32 v28, v136 offset:39168
    v_exp_f32 v84, v84
    v_exp_f32 v85, v85
    v_exp_f32 v86, v86
    v_exp_f32 v87, v87
    v_mfma_f32_32x32x16_bf16 v[100:115], v[36:39], v[52:55], v[100:115]
    ds_read_b128 v[44:47], v137 offset:40128
    ds_read_b128 v[48:51], v137 offset:40736
    v_exp_f32 v88, v88
    v_exp_f32 v89, v89
    v_cvt_pk_bf16_f32 v60, v84, v85
    v_exp_f32 v90, v90
    v_cvt_pk_bf16_f32 v61, v86, v87
    v_exp_f32 v91, v91
    v_mfma_f32_32x32x8_bf16 v[68:83], v[34:35], v[16:17], v[68:83]
    v_exp_f32 v92, v92
    v_cvt_pk_bf16_f32 v62, v88, v89
    v_exp_f32 v93, v93
    v_cvt_pk_bf16_f32 v63, v90, v91
    v_exp_f32 v94, v94
    v_exp_f32 v95, v95
    v_mfma_f32_32x32x16_bf16 v[100:115], v[40:43], v[56:59], v[100:115]
    v_exp_f32 v96, v96
    v_exp_f32 v97, v97
    v_cvt_pk_bf16_f32 v64, v92, v93
    v_exp_f32 v98, v98
    v_cvt_pk_bf16_f32 v65, v94, v95
    v_exp_f32 v99, v99
    v_cvt_pk_bf16_f32 v66, v96, v97
    v_cvt_pk_bf16_f32 v67, v98, v99
    v_mfma_f32_32x32x16_bf16 v[84:99], v[30:33], v[18:21], 0
    v_exp_f32 v68, v68
    v_exp_f32 v69, v69
    v_exp_f32 v70, v70
    v_exp_f32 v71, v71
    v_mfma_f32_32x32x16_bf16 v[116:131], v[36:39], v[60:63], v[116:131]
    v_exp_f32 v72, v72
    v_exp_f32 v73, v73
    v_cvt_pk_bf16_f32 v52, v68, v69
    v_exp_f32 v74, v74
    v_cvt_pk_bf16_f32 v53, v70, v71
    v_exp_f32 v75, v75
    v_mfma_f32_32x32x8_bf16 v[84:99], v[34:35], v[22:23], v[84:99]
    v_exp_f32 v76, v76
    v_cvt_pk_bf16_f32 v54, v72, v73
    v_exp_f32 v77, v77
    v_cvt_pk_bf16_f32 v55, v74, v75
    v_exp_f32 v78, v78
    v_exp_f32 v79, v79
    v_mfma_f32_32x32x16_bf16 v[116:131], v[40:43], v[64:67], v[116:131]
    v_exp_f32 v80, v80
    v_exp_f32 v81, v81
    v_cvt_pk_bf16_f32 v56, v76, v77
    v_exp_f32 v82, v82
    v_cvt_pk_bf16_f32 v57, v78, v79
    v_exp_f32 v83, v83
    v_cvt_pk_bf16_f32 v58, v80, v81
    v_cvt_pk_bf16_f32 v59, v82, v83
    s_waitcnt lgkmcnt(0)
    v_mfma_f32_32x32x16_bf16 v[68:83], v[24:27], v[12:15], 0
    ds_read_b128 v[30:33], v135 offset:41984
    ds_read_b32 v34, v136 offset:39296
    v_exp_f32 v84, v84
    v_exp_f32 v85, v85
    v_exp_f32 v86, v86
    v_exp_f32 v87, v87
    v_mfma_f32_32x32x16_bf16 v[100:115], v[44:47], v[52:55], v[100:115]
    ds_read_b128 v[36:39], v137 offset:41344
    ds_read_b128 v[40:43], v137 offset:41952
    v_exp_f32 v88, v88
    v_exp_f32 v89, v89
    v_cvt_pk_bf16_f32 v60, v84, v85
    v_exp_f32 v90, v90
    v_cvt_pk_bf16_f32 v61, v86, v87
    v_exp_f32 v91, v91
    v_mfma_f32_32x32x8_bf16 v[68:83], v[28:29], v[16:17], v[68:83]
    v_exp_f32 v92, v92
    v_cvt_pk_bf16_f32 v62, v88, v89
    v_exp_f32 v93, v93
    v_cvt_pk_bf16_f32 v63, v90, v91
    v_exp_f32 v94, v94
    v_exp_f32 v95, v95
    v_mfma_f32_32x32x16_bf16 v[100:115], v[48:51], v[56:59], v[100:115]
    v_exp_f32 v96, v96
    v_exp_f32 v97, v97
    v_cvt_pk_bf16_f32 v64, v92, v93
    v_exp_f32 v98, v98
    v_cvt_pk_bf16_f32 v65, v94, v95
    v_exp_f32 v99, v99
    v_cvt_pk_bf16_f32 v66, v96, v97
    v_cvt_pk_bf16_f32 v67, v98, v99
    v_mfma_f32_32x32x16_bf16 v[84:99], v[24:27], v[18:21], 0
    v_exp_f32 v68, v68
    v_exp_f32 v69, v69
    v_exp_f32 v70, v70
    v_exp_f32 v71, v71
    v_mfma_f32_32x32x16_bf16 v[116:131], v[44:47], v[60:63], v[116:131]
    v_exp_f32 v72, v72
    v_exp_f32 v73, v73
    v_cvt_pk_bf16_f32 v52, v68, v69
    v_exp_f32 v74, v74
    v_cvt_pk_bf16_f32 v53, v70, v71
    v_exp_f32 v75, v75
    v_mfma_f32_32x32x8_bf16 v[84:99], v[28:29], v[22:23], v[84:99]
    v_exp_f32 v76, v76
    v_cvt_pk_bf16_f32 v54, v72, v73
    v_exp_f32 v77, v77
    v_cvt_pk_bf16_f32 v55, v74, v75
    v_exp_f32 v78, v78
    v_exp_f32 v79, v79
    v_mfma_f32_32x32x16_bf16 v[116:131], v[48:51], v[64:67], v[116:131]
    v_exp_f32 v80, v80
    v_exp_f32 v81, v81
    v_cvt_pk_bf16_f32 v56, v76, v77
    v_exp_f32 v82, v82
    v_cvt_pk_bf16_f32 v57, v78, v79
    v_exp_f32 v83, v83
    v_cvt_pk_bf16_f32 v58, v80, v81
    v_cvt_pk_bf16_f32 v59, v82, v83
    s_waitcnt lgkmcnt(0)
    v_mfma_f32_32x32x16_bf16 v[68:83], v[30:33], v[12:15], 0
    ds_read_b128 v[24:27], v135 offset:43008
    ds_read_b32 v28, v136 offset:39424
    v_exp_f32 v84, v84
    v_exp_f32 v85, v85
    v_exp_f32 v86, v86
    v_exp_f32 v87, v87
    v_mfma_f32_32x32x16_bf16 v[100:115], v[36:39], v[52:55], v[100:115]
    ds_read_b128 v[44:47], v137 offset:42560
    ds_read_b128 v[48:51], v137 offset:43168
    v_exp_f32 v88, v88
    v_exp_f32 v89, v89
    v_cvt_pk_bf16_f32 v60, v84, v85
    v_exp_f32 v90, v90
    v_cvt_pk_bf16_f32 v61, v86, v87
    v_exp_f32 v91, v91
    v_mfma_f32_32x32x8_bf16 v[68:83], v[34:35], v[16:17], v[68:83]
    v_exp_f32 v92, v92
    v_cvt_pk_bf16_f32 v62, v88, v89
    v_exp_f32 v93, v93
    v_cvt_pk_bf16_f32 v63, v90, v91
    v_exp_f32 v94, v94
    v_exp_f32 v95, v95
    v_mfma_f32_32x32x16_bf16 v[100:115], v[40:43], v[56:59], v[100:115]
    v_exp_f32 v96, v96
    v_exp_f32 v97, v97
    v_cvt_pk_bf16_f32 v64, v92, v93
    v_exp_f32 v98, v98
    v_cvt_pk_bf16_f32 v65, v94, v95
    v_exp_f32 v99, v99
    v_cvt_pk_bf16_f32 v66, v96, v97
    v_cvt_pk_bf16_f32 v67, v98, v99
    v_mfma_f32_32x32x16_bf16 v[84:99], v[30:33], v[18:21], 0
    v_exp_f32 v68, v68
    v_exp_f32 v69, v69
    v_exp_f32 v70, v70
    v_exp_f32 v71, v71
    v_mfma_f32_32x32x16_bf16 v[116:131], v[36:39], v[60:63], v[116:131]
    v_exp_f32 v72, v72
    v_exp_f32 v73, v73
    v_cvt_pk_bf16_f32 v52, v68, v69
    v_exp_f32 v74, v74
    v_cvt_pk_bf16_f32 v53, v70, v71
    v_exp_f32 v75, v75
    v_mfma_f32_32x32x8_bf16 v[84:99], v[34:35], v[22:23], v[84:99]
    v_exp_f32 v76, v76
    v_cvt_pk_bf16_f32 v54, v72, v73
    v_exp_f32 v77, v77
    v_cvt_pk_bf16_f32 v55, v74, v75
    v_exp_f32 v78, v78
    v_exp_f32 v79, v79
    v_mfma_f32_32x32x16_bf16 v[116:131], v[40:43], v[64:67], v[116:131]
    v_exp_f32 v80, v80
    v_exp_f32 v81, v81
    v_cvt_pk_bf16_f32 v56, v76, v77
    v_exp_f32 v82, v82
    v_cvt_pk_bf16_f32 v57, v78, v79
    v_exp_f32 v83, v83
    v_cvt_pk_bf16_f32 v58, v80, v81
    v_cvt_pk_bf16_f32 v59, v82, v83
    s_waitcnt lgkmcnt(0)
    v_mfma_f32_32x32x16_bf16 v[68:83], v[24:27], v[12:15], 0
    ds_read_b128 v[30:33], v135 offset:44032
    ds_read_b32 v34, v136 offset:39552
    v_exp_f32 v84, v84
    v_exp_f32 v85, v85
    v_exp_f32 v86, v86
    v_exp_f32 v87, v87
    v_mfma_f32_32x32x16_bf16 v[100:115], v[44:47], v[52:55], v[100:115]
    ds_read_b128 v[36:39], v137 offset:43776
    ds_read_b128 v[40:43], v137 offset:44384
    v_exp_f32 v88, v88
    v_exp_f32 v89, v89
    v_cvt_pk_bf16_f32 v60, v84, v85
    v_exp_f32 v90, v90
    v_cvt_pk_bf16_f32 v61, v86, v87
    v_exp_f32 v91, v91
    v_mfma_f32_32x32x8_bf16 v[68:83], v[28:29], v[16:17], v[68:83]
    v_exp_f32 v92, v92
    v_cvt_pk_bf16_f32 v62, v88, v89
    v_exp_f32 v93, v93
    v_cvt_pk_bf16_f32 v63, v90, v91
    v_exp_f32 v94, v94
    v_exp_f32 v95, v95
    v_mfma_f32_32x32x16_bf16 v[100:115], v[48:51], v[56:59], v[100:115]
    v_exp_f32 v96, v96
    v_exp_f32 v97, v97
    v_cvt_pk_bf16_f32 v64, v92, v93
    v_exp_f32 v98, v98
    v_cvt_pk_bf16_f32 v65, v94, v95
    v_exp_f32 v99, v99
    v_cvt_pk_bf16_f32 v66, v96, v97
    v_cvt_pk_bf16_f32 v67, v98, v99
    v_mfma_f32_32x32x16_bf16 v[84:99], v[24:27], v[18:21], 0
    v_exp_f32 v68, v68
    v_exp_f32 v69, v69
    v_exp_f32 v70, v70
    v_exp_f32 v71, v71
    v_mfma_f32_32x32x16_bf16 v[116:131], v[44:47], v[60:63], v[116:131]
    v_exp_f32 v72, v72
    v_exp_f32 v73, v73
    v_cvt_pk_bf16_f32 v52, v68, v69
    v_exp_f32 v74, v74
    v_cvt_pk_bf16_f32 v53, v70, v71
    v_exp_f32 v75, v75
    v_mfma_f32_32x32x8_bf16 v[84:99], v[28:29], v[22:23], v[84:99]
    v_exp_f32 v76, v76
    v_cvt_pk_bf16_f32 v54, v72, v73
    v_exp_f32 v77, v77
    v_cvt_pk_bf16_f32 v55, v74, v75
    v_exp_f32 v78, v78
    v_exp_f32 v79, v79
    v_mfma_f32_32x32x16_bf16 v[116:131], v[48:51], v[64:67], v[116:131]
    v_exp_f32 v80, v80
    v_exp_f32 v81, v81
    v_cvt_pk_bf16_f32 v56, v76, v77
    v_exp_f32 v82, v82
    v_cvt_pk_bf16_f32 v57, v78, v79
    v_exp_f32 v83, v83
    v_cvt_pk_bf16_f32 v58, v80, v81
    v_cvt_pk_bf16_f32 v59, v82, v83
    s_waitcnt lgkmcnt(0)
    v_mfma_f32_32x32x16_bf16 v[68:83], v[30:33], v[12:15], 0
    ds_read_b128 v[24:27], v135 offset:45056
    ds_read_b32 v28, v136 offset:39680
    v_exp_f32 v84, v84
    v_exp_f32 v85, v85
    v_exp_f32 v86, v86
    v_exp_f32 v87, v87
    v_mfma_f32_32x32x16_bf16 v[100:115], v[36:39], v[52:55], v[100:115]
    ds_read_b128 v[44:47], v137 offset:44992
    ds_read_b128 v[48:51], v137 offset:45600
    v_exp_f32 v88, v88
    v_exp_f32 v89, v89
    v_cvt_pk_bf16_f32 v60, v84, v85
    v_exp_f32 v90, v90
    v_cvt_pk_bf16_f32 v61, v86, v87
    v_exp_f32 v91, v91
    v_mfma_f32_32x32x8_bf16 v[68:83], v[34:35], v[16:17], v[68:83]
    v_exp_f32 v92, v92
    v_cvt_pk_bf16_f32 v62, v88, v89
    v_exp_f32 v93, v93
    v_cvt_pk_bf16_f32 v63, v90, v91
    v_exp_f32 v94, v94
    v_exp_f32 v95, v95
    v_mfma_f32_32x32x16_bf16 v[100:115], v[40:43], v[56:59], v[100:115]
    v_exp_f32 v96, v96
    v_exp_f32 v97, v97
    v_cvt_pk_bf16_f32 v64, v92, v93
    v_exp_f32 v98, v98
    v_cvt_pk_bf16_f32 v65, v94, v95
    v_exp_f32 v99, v99
    v_cvt_pk_bf16_f32 v66, v96, v97
    v_cvt_pk_bf16_f32 v67, v98, v99
    v_mfma_f32_32x32x16_bf16 v[84:99], v[30:33], v[18:21], 0
    v_exp_f32 v68, v68
    v_exp_f32 v69, v69
    v_exp_f32 v70, v70
    v_exp_f32 v71, v71
    v_mfma_f32_32x32x16_bf16 v[116:131], v[36:39], v[60:63], v[116:131]
    v_exp_f32 v72, v72
    v_exp_f32 v73, v73
    v_cvt_pk_bf16_f32 v52, v68, v69
    v_exp_f32 v74, v74
    v_cvt_pk_bf16_f32 v53, v70, v71
    v_exp_f32 v75, v75
    v_mfma_f32_32x32x8_bf16 v[84:99], v[34:35], v[22:23], v[84:99]
    v_exp_f32 v76, v76
    v_cvt_pk_bf16_f32 v54, v72, v73
    v_exp_f32 v77, v77
    v_cvt_pk_bf16_f32 v55, v74, v75
    v_exp_f32 v78, v78
    v_exp_f32 v79, v79
    v_mfma_f32_32x32x16_bf16 v[116:131], v[40:43], v[64:67], v[116:131]
    v_exp_f32 v80, v80
    v_exp_f32 v81, v81
    v_cvt_pk_bf16_f32 v56, v76, v77
    v_exp_f32 v82, v82
    v_cvt_pk_bf16_f32 v57, v78, v79
    v_exp_f32 v83, v83
    v_cvt_pk_bf16_f32 v58, v80, v81
    v_cvt_pk_bf16_f32 v59, v82, v83
    s_waitcnt lgkmcnt(0)
    v_mfma_f32_32x32x16_bf16 v[68:83], v[24:27], v[12:15], 0
    ds_read_b128 v[30:33], v135 offset:46080
    ds_read_b32 v34, v136 offset:39808
    v_exp_f32 v84, v84
    v_exp_f32 v85, v85
    v_exp_f32 v86, v86
    v_exp_f32 v87, v87
    v_mfma_f32_32x32x16_bf16 v[100:115], v[44:47], v[52:55], v[100:115]
    ds_read_b128 v[36:39], v137 offset:46208
    ds_read_b128 v[40:43], v137 offset:46816
    ds_read_b32 v144, v145 offset:24
    v_exp_f32 v88, v88
    v_exp_f32 v89, v89
    v_cvt_pk_bf16_f32 v60, v84, v85
    v_exp_f32 v90, v90
    v_cvt_pk_bf16_f32 v61, v86, v87
    v_exp_f32 v91, v91
    v_mfma_f32_32x32x8_bf16 v[68:83], v[28:29], v[16:17], v[68:83]
    v_exp_f32 v92, v92
    v_cvt_pk_bf16_f32 v62, v88, v89
    v_exp_f32 v93, v93
    v_cvt_pk_bf16_f32 v63, v90, v91
    v_exp_f32 v94, v94
    v_exp_f32 v95, v95
    v_mfma_f32_32x32x16_bf16 v[100:115], v[48:51], v[56:59], v[100:115]
    v_exp_f32 v96, v96
    v_exp_f32 v97, v97
    v_cvt_pk_bf16_f32 v64, v92, v93
    v_exp_f32 v98, v98
    v_cvt_pk_bf16_f32 v65, v94, v95
    v_exp_f32 v99, v99
    v_cvt_pk_bf16_f32 v66, v96, v97
    v_cvt_pk_bf16_f32 v67, v98, v99
    v_mfma_f32_32x32x16_bf16 v[84:99], v[24:27], v[18:21], 0
    v_exp_f32 v68, v68
    v_exp_f32 v69, v69
    v_exp_f32 v70, v70
    v_exp_f32 v71, v71
    v_mfma_f32_32x32x16_bf16 v[116:131], v[44:47], v[60:63], v[116:131]
    v_exp_f32 v72, v72
    v_exp_f32 v73, v73
    v_cvt_pk_bf16_f32 v52, v68, v69
    v_exp_f32 v74, v74
    v_cvt_pk_bf16_f32 v53, v70, v71
    v_exp_f32 v75, v75
    v_mfma_f32_32x32x8_bf16 v[84:99], v[28:29], v[22:23], v[84:99]
    v_exp_f32 v76, v76
    v_cvt_pk_bf16_f32 v54, v72, v73
    v_exp_f32 v77, v77
    v_cvt_pk_bf16_f32 v55, v74, v75
    v_exp_f32 v78, v78
    v_exp_f32 v79, v79
    v_mfma_f32_32x32x16_bf16 v[116:131], v[48:51], v[64:67], v[116:131]
    v_exp_f32 v80, v80
    v_exp_f32 v81, v81
    v_cvt_pk_bf16_f32 v56, v76, v77
    v_exp_f32 v82, v82
    v_cvt_pk_bf16_f32 v57, v78, v79
    v_exp_f32 v83, v83
    v_cvt_pk_bf16_f32 v58, v80, v81
    v_cvt_pk_bf16_f32 v59, v82, v83
    s_waitcnt lgkmcnt(0)
    v_readfirstlane_b32 s33, v144
    s_nop 0
    s_cmp_eq_u32 s33, 0
    s_cbranch_scc1 L_at_fc5_spin
L_at_fc5_ok:
    v_mfma_f32_32x32x16_bf16 v[68:83], v[30:33], v[12:15], 0
    ds_read_b128 v[24:27], v132 offset:0
    ds_read_b32 v28, v133 offset:0
    v_exp_f32 v84, v84
    v_exp_f32 v85, v85
    v_exp_f32 v86, v86
    v_exp_f32 v87, v87
    v_mfma_f32_32x32x16_bf16 v[100:115], v[36:39], v[52:55], v[100:115]
    ds_read_b128 v[44:47], v137 offset:47424
    ds_read_b128 v[48:51], v137 offset:48032
    v_exp_f32 v88, v88
    v_exp_f32 v89, v89
    v_cvt_pk_bf16_f32 v60, v84, v85
    v_exp_f32 v90, v90
    v_cvt_pk_bf16_f32 v61, v86, v87
    v_exp_f32 v91, v91
    v_mfma_f32_32x32x8_bf16 v[68:83], v[34:35], v[16:17], v[68:83]
    v_exp_f32 v92, v92
    v_cvt_pk_bf16_f32 v62, v88, v89
    v_exp_f32 v93, v93
    v_cvt_pk_bf16_f32 v63, v90, v91
    v_exp_f32 v94, v94
    v_exp_f32 v95, v95
    v_mfma_f32_32x32x16_bf16 v[100:115], v[40:43], v[56:59], v[100:115]
    v_exp_f32 v96, v96
    v_exp_f32 v97, v97
    v_cvt_pk_bf16_f32 v64, v92, v93
    v_exp_f32 v98, v98
    v_cvt_pk_bf16_f32 v65, v94, v95
    v_exp_f32 v99, v99
    v_cvt_pk_bf16_f32 v66, v96, v97
    v_cvt_pk_bf16_f32 v67, v98, v99
    v_mfma_f32_32x32x16_bf16 v[84:99], v[30:33], v[18:21], 0
    v_exp_f32 v68, v68
    v_exp_f32 v69, v69
    v_exp_f32 v70, v70
    v_exp_f32 v71, v71
    v_mfma_f32_32x32x16_bf16 v[116:131], v[36:39], v[60:63], v[116:131]
    v_exp_f32 v72, v72
    v_exp_f32 v73, v73
    v_cvt_pk_bf16_f32 v52, v68, v69
    v_exp_f32 v74, v74
    v_cvt_pk_bf16_f32 v53, v70, v71
    v_exp_f32 v75, v75
    v_mfma_f32_32x32x8_bf16 v[84:99], v[34:35], v[22:23], v[84:99]
    v_exp_f32 v76, v76
    v_cvt_pk_bf16_f32 v54, v72, v73
    v_exp_f32 v77, v77
    v_cvt_pk_bf16_f32 v55, v74, v75
    v_exp_f32 v78, v78
    v_exp_f32 v79, v79
    v_mfma_f32_32x32x16_bf16 v[116:131], v[40:43], v[64:67], v[116:131]
    v_exp_f32 v80, v80
    v_exp_f32 v81, v81
    v_cvt_pk_bf16_f32 v56, v76, v77
    v_exp_f32 v82, v82
    v_cvt_pk_bf16_f32 v57, v78, v79
    v_exp_f32 v83, v83
    v_cvt_pk_bf16_f32 v58, v80, v81
    v_cvt_pk_bf16_f32 v59, v82, v83
    s_waitcnt lgkmcnt(0)
    v_mfma_f32_32x32x16_bf16 v[68:83], v[24:27], v[12:15], 0
    ds_read_b128 v[30:33], v132 offset:1024
    ds_read_b32 v34, v133 offset:128
    v_exp_f32 v84, v84
    v_exp_f32 v85, v85
    v_exp_f32 v86, v86
    v_exp_f32 v87, v87
    v_mfma_f32_32x32x16_bf16 v[100:115], v[44:47], v[52:55], v[100:115]
    ds_read_b128 v[36:39], v134 offset:0
    ds_read_b128 v[40:43], v134 offset:608
    v_exp_f32 v88, v88
    v_exp_f32 v89, v89
    v_cvt_pk_bf16_f32 v60, v84, v85
    v_exp_f32 v90, v90
    v_cvt_pk_bf16_f32 v61, v86, v87
    v_exp_f32 v91, v91
    v_mfma_f32_32x32x8_bf16 v[68:83], v[28:29], v[16:17], v[68:83]
    v_exp_f32 v92, v92
    v_cvt_pk_bf16_f32 v62, v88, v89
    v_exp_f32 v93, v93
    v_cvt_pk_bf16_f32 v63, v90, v91
    v_exp_f32 v94, v94
    v_exp_f32 v95, v95
    v_mfma_f32_32x32x16_bf16 v[100:115], v[48:51], v[56:59], v[100:115]
    v_exp_f32 v96, v96
    v_exp_f32 v97, v97
    v_cvt_pk_bf16_f32 v64, v92, v93
    v_exp_f32 v98, v98
    v_cvt_pk_bf16_f32 v65, v94, v95
    v_exp_f32 v99, v99
    v_cvt_pk_bf16_f32 v66, v96, v97
    v_cvt_pk_bf16_f32 v67, v98, v99
    v_mfma_f32_32x32x16_bf16 v[84:99], v[24:27], v[18:21], 0
    v_exp_f32 v68, v68
    v_exp_f32 v69, v69
    v_exp_f32 v70, v70
    v_exp_f32 v71, v71
    v_mfma_f32_32x32x16_bf16 v[116:131], v[44:47], v[60:63], v[116:131]
    v_exp_f32 v72, v72
    v_exp_f32 v73, v73
    v_cvt_pk_bf16_f32 v52, v68, v69
    v_exp_f32 v74, v74
    v_cvt_pk_bf16_f32 v53, v70, v71
    v_exp_f32 v75, v75
    v_mfma_f32_32x32x8_bf16 v[84:99], v[28:29], v[22:23], v[84:99]
    v_exp_f32 v76, v76
    v_cvt_pk_bf16_f32 v54, v72, v73
    v_exp_f32 v77, v77
    v_cvt_pk_bf16_f32 v55, v74, v75
    v_exp_f32 v78, v78
    v_exp_f32 v79, v79
    v_mfma_f32_32x32x16_bf16 v[116:131], v[48:51], v[64:67], v[116:131]
    v_exp_f32 v80, v80
    v_exp_f32 v81, v81
    v_cvt_pk_bf16_f32 v56, v76, v77
    v_exp_f32 v82, v82
    v_cvt_pk_bf16_f32 v57, v78, v79
    v_exp_f32 v83, v83
    v_cvt_pk_bf16_f32 v58, v80, v81
    v_cvt_pk_bf16_f32 v59, v82, v83
    s_waitcnt lgkmcnt(0)
    v_mfma_f32_32x32x16_bf16 v[68:83], v[30:33], v[12:15], 0
    ds_read_b128 v[24:27], v132 offset:2048
    ds_read_b32 v28, v133 offset:256
    v_exp_f32 v84, v84
    v_exp_f32 v85, v85
    v_exp_f32 v86, v86
    v_exp_f32 v87, v87
    v_mfma_f32_32x32x16_bf16 v[100:115], v[36:39], v[52:55], v[100:115]
    ds_read_b128 v[44:47], v134 offset:1216
    ds_read_b128 v[48:51], v134 offset:1824
    v_exp_f32 v88, v88
    v_exp_f32 v89, v89
    v_cvt_pk_bf16_f32 v60, v84, v85
    v_exp_f32 v90, v90
    v_cvt_pk_bf16_f32 v61, v86, v87
    v_exp_f32 v91, v91
    v_mfma_f32_32x32x8_bf16 v[68:83], v[34:35], v[16:17], v[68:83]
    v_exp_f32 v92, v92
    v_cvt_pk_bf16_f32 v62, v88, v89
    v_exp_f32 v93, v93
    v_cvt_pk_bf16_f32 v63, v90, v91
    v_exp_f32 v94, v94
    v_exp_f32 v95, v95
    v_mfma_f32_32x32x16_bf16 v[100:115], v[40:43], v[56:59], v[100:115]
    v_exp_f32 v96, v96
    v_exp_f32 v97, v97
    v_cvt_pk_bf16_f32 v64, v92, v93
    v_exp_f32 v98, v98
    v_cvt_pk_bf16_f32 v65, v94, v95
    v_exp_f32 v99, v99
    v_cvt_pk_bf16_f32 v66, v96, v97
    v_cvt_pk_bf16_f32 v67, v98, v99
    v_mfma_f32_32x32x16_bf16 v[84:99], v[30:33], v[18:21], 0
    v_exp_f32 v68, v68
    v_exp_f32 v69, v69
    v_exp_f32 v70, v70
    v_exp_f32 v71, v71
    v_mfma_f32_32x32x16_bf16 v[116:131], v[36:39], v[60:63], v[116:131]
    v_exp_f32 v72, v72
    v_exp_f32 v73, v73
    v_cvt_pk_bf16_f32 v52, v68, v69
    v_exp_f32 v74, v74
    v_cvt_pk_bf16_f32 v53, v70, v71
    v_exp_f32 v75, v75
    v_mfma_f32_32x32x8_bf16 v[84:99], v[34:35], v[22:23], v[84:99]
    v_exp_f32 v76, v76
    v_cvt_pk_bf16_f32 v54, v72, v73
    v_exp_f32 v77, v77
    v_cvt_pk_bf16_f32 v55, v74, v75
    v_exp_f32 v78, v78
    v_exp_f32 v79, v79
    v_mfma_f32_32x32x16_bf16 v[116:131], v[40:43], v[64:67], v[116:131]
    v_exp_f32 v80, v80
    v_exp_f32 v81, v81
    v_cvt_pk_bf16_f32 v56, v76, v77
    v_exp_f32 v82, v82
    v_cvt_pk_bf16_f32 v57, v78, v79
    v_exp_f32 v83, v83
    v_cvt_pk_bf16_f32 v58, v80, v81
    v_cvt_pk_bf16_f32 v59, v82, v83
    s_waitcnt lgkmcnt(0)
    v_mfma_f32_32x32x16_bf16 v[68:83], v[24:27], v[12:15], 0
    ds_read_b128 v[30:33], v132 offset:3072
    ds_read_b32 v34, v133 offset:384
    v_exp_f32 v84, v84
    v_exp_f32 v85, v85
    v_exp_f32 v86, v86
    v_exp_f32 v87, v87
    v_mfma_f32_32x32x16_bf16 v[100:115], v[44:47], v[52:55], v[100:115]
    ds_read_b128 v[36:39], v134 offset:2432
    ds_read_b128 v[40:43], v134 offset:3040
    v_exp_f32 v88, v88
    v_exp_f32 v89, v89
    v_cvt_pk_bf16_f32 v60, v84, v85
    v_exp_f32 v90, v90
    v_cvt_pk_bf16_f32 v61, v86, v87
    v_exp_f32 v91, v91
    v_mfma_f32_32x32x8_bf16 v[68:83], v[28:29], v[16:17], v[68:83]
    v_exp_f32 v92, v92
    v_cvt_pk_bf16_f32 v62, v88, v89
    v_exp_f32 v93, v93
    v_cvt_pk_bf16_f32 v63, v90, v91
    v_exp_f32 v94, v94
    v_exp_f32 v95, v95
    v_mfma_f32_32x32x16_bf16 v[100:115], v[48:51], v[56:59], v[100:115]
    v_exp_f32 v96, v96
    v_exp_f32 v97, v97
    v_cvt_pk_bf16_f32 v64, v92, v93
    v_exp_f32 v98, v98
    v_cvt_pk_bf16_f32 v65, v94, v95
    v_exp_f32 v99, v99
    v_cvt_pk_bf16_f32 v66, v96, v97
    v_cvt_pk_bf16_f32 v67, v98, v99
    v_mfma_f32_32x32x16_bf16 v[84:99], v[24:27], v[18:21], 0
    v_exp_f32 v68, v68
    v_exp_f32 v69, v69
    v_exp_f32 v70, v70
    v_exp_f32 v71, v71
    v_mfma_f32_32x32x16_bf16 v[116:131], v[44:47], v[60:63], v[116:131]
    v_exp_f32 v72, v72
    v_exp_f32 v73, v73
    v_cvt_pk_bf16_f32 v52, v68, v69
    v_exp_f32 v74, v74
    v_cvt_pk_bf16_f32 v53, v70, v71
    v_exp_f32 v75, v75
    v_mfma_f32_32x32x8_bf16 v[84:99], v[28:29], v[22:23], v[84:99]
    v_exp_f32 v76, v76
    v_cvt_pk_bf16_f32 v54, v72, v73
    v_exp_f32 v77, v77
    v_cvt_pk_bf16_f32 v55, v74, v75
    v_exp_f32 v78, v78
    v_exp_f32 v79, v79
    v_mfma_f32_32x32x16_bf16 v[116:131], v[48:51], v[64:67], v[116:131]
    v_exp_f32 v80, v80
    v_exp_f32 v81, v81
    v_cvt_pk_bf16_f32 v56, v76, v77
    v_exp_f32 v82, v82
    v_cvt_pk_bf16_f32 v57, v78, v79
    v_exp_f32 v83, v83
    v_cvt_pk_bf16_f32 v58, v80, v81
    v_cvt_pk_bf16_f32 v59, v82, v83
    s_waitcnt lgkmcnt(0)
    v_mfma_f32_32x32x16_bf16 v[68:83], v[30:33], v[12:15], 0
    ds_read_b128 v[24:27], v132 offset:4096
    ds_read_b32 v28, v133 offset:512
    v_exp_f32 v84, v84
    v_exp_f32 v85, v85
    v_exp_f32 v86, v86
    v_exp_f32 v87, v87
    v_mfma_f32_32x32x16_bf16 v[100:115], v[36:39], v[52:55], v[100:115]
    ds_read_b128 v[44:47], v134 offset:3648
    ds_read_b128 v[48:51], v134 offset:4256
    v_exp_f32 v88, v88
    v_exp_f32 v89, v89
    v_cvt_pk_bf16_f32 v60, v84, v85
    v_exp_f32 v90, v90
    v_cvt_pk_bf16_f32 v61, v86, v87
    v_exp_f32 v91, v91
    v_mfma_f32_32x32x8_bf16 v[68:83], v[34:35], v[16:17], v[68:83]
    v_exp_f32 v92, v92
    v_cvt_pk_bf16_f32 v62, v88, v89
    v_exp_f32 v93, v93
    v_cvt_pk_bf16_f32 v63, v90, v91
    v_exp_f32 v94, v94
    v_exp_f32 v95, v95
    v_mfma_f32_32x32x16_bf16 v[100:115], v[40:43], v[56:59], v[100:115]
    v_exp_f32 v96, v96
    v_exp_f32 v97, v97
    v_cvt_pk_bf16_f32 v64, v92, v93
    v_exp_f32 v98, v98
    v_cvt_pk_bf16_f32 v65, v94, v95
    v_exp_f32 v99, v99
    v_cvt_pk_bf16_f32 v66, v96, v97
    v_cvt_pk_bf16_f32 v67, v98, v99
    v_mfma_f32_32x32x16_bf16 v[84:99], v[30:33], v[18:21], 0
    v_exp_f32 v68, v68
    v_exp_f32 v69, v69
    v_exp_f32 v70, v70
    v_exp_f32 v71, v71
    v_mfma_f32_32x32x16_bf16 v[116:131], v[36:39], v[60:63], v[116:131]
    v_exp_f32 v72, v72
    v_exp_f32 v73, v73
    v_cvt_pk_bf16_f32 v52, v68, v69
    v_exp_f32 v74, v74
    v_cvt_pk_bf16_f32 v53, v70, v71
    v_exp_f32 v75, v75
    v_mfma_f32_32x32x8_bf16 v[84:99], v[34:35], v[22:23], v[84:99]
    v_exp_f32 v76, v76
    v_cvt_pk_bf16_f32 v54, v72, v73
    v_exp_f32 v77, v77
    v_cvt_pk_bf16_f32 v55, v74, v75
    v_exp_f32 v78, v78
    v_exp_f32 v79, v79
    v_mfma_f32_32x32x16_bf16 v[116:131], v[40:43], v[64:67], v[116:131]
    v_exp_f32 v80, v80
    v_exp_f32 v81, v81
    v_cvt_pk_bf16_f32 v56, v76, v77
    v_exp_f32 v82, v82
    v_cvt_pk_bf16_f32 v57, v78, v79
    v_exp_f32 v83, v83
    v_cvt_pk_bf16_f32 v58, v80, v81
    v_cvt_pk_bf16_f32 v59, v82, v83
    s_waitcnt lgkmcnt(0)
    v_mfma_f32_32x32x16_bf16 v[68:83], v[24:27], v[12:15], 0
    ds_read_b128 v[30:33], v132 offset:5120
    ds_read_b32 v34, v133 offset:640
    v_exp_f32 v84, v84
    v_exp_f32 v85, v85
    v_exp_f32 v86, v86
    v_exp_f32 v87, v87
    v_mfma_f32_32x32x16_bf16 v[100:115], v[44:47], v[52:55], v[100:115]
    ds_read_b128 v[36:39], v134 offset:4864
    ds_read_b128 v[40:43], v134 offset:5472
    v_exp_f32 v88, v88
    v_exp_f32 v89, v89
    v_cvt_pk_bf16_f32 v60, v84, v85
    v_exp_f32 v90, v90
    v_cvt_pk_bf16_f32 v61, v86, v87
    v_exp_f32 v91, v91
    v_mfma_f32_32x32x8_bf16 v[68:83], v[28:29], v[16:17], v[68:83]
    v_exp_f32 v92, v92
    v_cvt_pk_bf16_f32 v62, v88, v89
    v_exp_f32 v93, v93
    v_cvt_pk_bf16_f32 v63, v90, v91
    v_exp_f32 v94, v94
    v_exp_f32 v95, v95
    v_mfma_f32_32x32x16_bf16 v[100:115], v[48:51], v[56:59], v[100:115]
    v_exp_f32 v96, v96
    v_exp_f32 v97, v97
    v_cvt_pk_bf16_f32 v64, v92, v93
    v_exp_f32 v98, v98
    v_cvt_pk_bf16_f32 v65, v94, v95
    v_exp_f32 v99, v99
    v_cvt_pk_bf16_f32 v66, v96, v97
    v_cvt_pk_bf16_f32 v67, v98, v99
    v_mfma_f32_32x32x16_bf16 v[84:99], v[24:27], v[18:21], 0
    v_exp_f32 v68, v68
    v_exp_f32 v69, v69
    v_exp_f32 v70, v70
    v_exp_f32 v71, v71
    v_mfma_f32_32x32x16_bf16 v[116:131], v[44:47], v[60:63], v[116:131]
    v_exp_f32 v72, v72
    v_exp_f32 v73, v73
    v_cvt_pk_bf16_f32 v52, v68, v69
    v_exp_f32 v74, v74
    v_cvt_pk_bf16_f32 v53, v70, v71
    v_exp_f32 v75, v75
    v_mfma_f32_32x32x8_bf16 v[84:99], v[28:29], v[22:23], v[84:99]
    v_exp_f32 v76, v76
    v_cvt_pk_bf16_f32 v54, v72, v73
    v_exp_f32 v77, v77
    v_cvt_pk_bf16_f32 v55, v74, v75
    v_exp_f32 v78, v78
    v_exp_f32 v79, v79
    v_mfma_f32_32x32x16_bf16 v[116:131], v[48:51], v[64:67], v[116:131]
    v_exp_f32 v80, v80
    v_exp_f32 v81, v81
    v_cvt_pk_bf16_f32 v56, v76, v77
    v_exp_f32 v82, v82
    v_cvt_pk_bf16_f32 v57, v78, v79
    v_exp_f32 v83, v83
    v_cvt_pk_bf16_f32 v58, v80, v81
    v_cvt_pk_bf16_f32 v59, v82, v83
    s_waitcnt lgkmcnt(0)
    v_mfma_f32_32x32x16_bf16 v[68:83], v[30:33], v[12:15], 0
    ds_read_b128 v[24:27], v132 offset:6144
    ds_read_b32 v28, v133 offset:768
    v_exp_f32 v84, v84
    v_exp_f32 v85, v85
    v_exp_f32 v86, v86
    v_exp_f32 v87, v87
    v_mfma_f32_32x32x16_bf16 v[100:115], v[36:39], v[52:55], v[100:115]
    ds_read_b128 v[44:47], v134 offset:6080
    ds_read_b128 v[48:51], v134 offset:6688
    v_exp_f32 v88, v88
    v_exp_f32 v89, v89
    v_cvt_pk_bf16_f32 v60, v84, v85
    v_exp_f32 v90, v90
    v_cvt_pk_bf16_f32 v61, v86, v87
    v_exp_f32 v91, v91
    v_mfma_f32_32x32x8_bf16 v[68:83], v[34:35], v[16:17], v[68:83]
    v_exp_f32 v92, v92
    v_cvt_pk_bf16_f32 v62, v88, v89
    v_exp_f32 v93, v93
    v_cvt_pk_bf16_f32 v63, v90, v91
    v_exp_f32 v94, v94
    v_exp_f32 v95, v95
    v_mfma_f32_32x32x16_bf16 v[100:115], v[40:43], v[56:59], v[100:115]
    v_exp_f32 v96, v96
    v_exp_f32 v97, v97
    v_cvt_pk_bf16_f32 v64, v92, v93
    v_exp_f32 v98, v98
    v_cvt_pk_bf16_f32 v65, v94, v95
    v_exp_f32 v99, v99
    v_cvt_pk_bf16_f32 v66, v96, v97
    v_cvt_pk_bf16_f32 v67, v98, v99
    v_mfma_f32_32x32x16_bf16 v[84:99], v[30:33], v[18:21], 0
    v_exp_f32 v68, v68
    v_exp_f32 v69, v69
    v_exp_f32 v70, v70
    v_exp_f32 v71, v71
    v_mfma_f32_32x32x16_bf16 v[116:131], v[36:39], v[60:63], v[116:131]
    v_exp_f32 v72, v72
    v_exp_f32 v73, v73
    v_cvt_pk_bf16_f32 v52, v68, v69
    v_exp_f32 v74, v74
    v_cvt_pk_bf16_f32 v53, v70, v71
    v_exp_f32 v75, v75
    v_mfma_f32_32x32x8_bf16 v[84:99], v[34:35], v[22:23], v[84:99]
    v_exp_f32 v76, v76
    v_cvt_pk_bf16_f32 v54, v72, v73
    v_exp_f32 v77, v77
    v_cvt_pk_bf16_f32 v55, v74, v75
    v_exp_f32 v78, v78
    v_exp_f32 v79, v79
    v_mfma_f32_32x32x16_bf16 v[116:131], v[40:43], v[64:67], v[116:131]
    v_exp_f32 v80, v80
    v_exp_f32 v81, v81
    v_cvt_pk_bf16_f32 v56, v76, v77
    v_exp_f32 v82, v82
    v_cvt_pk_bf16_f32 v57, v78, v79
    v_exp_f32 v83, v83
    v_cvt_pk_bf16_f32 v58, v80, v81
    v_cvt_pk_bf16_f32 v59, v82, v83
    s_waitcnt lgkmcnt(0)
    v_mfma_f32_32x32x16_bf16 v[68:83], v[24:27], v[12:15], 0
    ds_read_b128 v[30:33], v132 offset:7168
    ds_read_b32 v34, v133 offset:896
    v_exp_f32 v84, v84
    v_exp_f32 v85, v85
    v_exp_f32 v86, v86
    v_exp_f32 v87, v87
    v_mfma_f32_32x32x16_bf16 v[100:115], v[44:47], v[52:55], v[100:115]
    ds_read_b128 v[36:39], v134 offset:7296
    ds_read_b128 v[40:43], v134 offset:7904
    ds_read_b32 v144, v145 offset:28
    v_exp_f32 v88, v88
    v_exp_f32 v89, v89
    v_cvt_pk_bf16_f32 v60, v84, v85
    v_exp_f32 v90, v90
    v_cvt_pk_bf16_f32 v61, v86, v87
    v_exp_f32 v91, v91
    v_mfma_f32_32x32x8_bf16 v[68:83], v[28:29], v[16:17], v[68:83]
    v_exp_f32 v92, v92
    v_cvt_pk_bf16_f32 v62, v88, v89
    v_exp_f32 v93, v93
    v_cvt_pk_bf16_f32 v63, v90, v91
    v_exp_f32 v94, v94
    v_exp_f32 v95, v95
    v_mfma_f32_32x32x16_bf16 v[100:115], v[48:51], v[56:59], v[100:115]
    v_exp_f32 v96, v96
    v_exp_f32 v97, v97
    v_cvt_pk_bf16_f32 v64, v92, v93
    v_exp_f32 v98, v98
    v_cvt_pk_bf16_f32 v65, v94, v95
    v_exp_f32 v99, v99
    v_cvt_pk_bf16_f32 v66, v96, v97
    v_cvt_pk_bf16_f32 v67, v98, v99
    v_mfma_f32_32x32x16_bf16 v[84:99], v[24:27], v[18:21], 0
    v_exp_f32 v68, v68
    v_exp_f32 v69, v69
    v_exp_f32 v70, v70
    v_exp_f32 v71, v71
    v_mfma_f32_32x32x16_bf16 v[116:131], v[44:47], v[60:63], v[116:131]
    v_exp_f32 v72, v72
    v_exp_f32 v73, v73
    v_cvt_pk_bf16_f32 v52, v68, v69
    v_exp_f32 v74, v74
    v_cvt_pk_bf16_f32 v53, v70, v71
    v_exp_f32 v75, v75
    v_mfma_f32_32x32x8_bf16 v[84:99], v[28:29], v[22:23], v[84:99]
    v_exp_f32 v76, v76
    v_cvt_pk_bf16_f32 v54, v72, v73
    v_exp_f32 v77, v77
    v_cvt_pk_bf16_f32 v55, v74, v75
    v_exp_f32 v78, v78
    v_exp_f32 v79, v79
    v_mfma_f32_32x32x16_bf16 v[116:131], v[48:51], v[64:67], v[116:131]
    v_exp_f32 v80, v80
    v_exp_f32 v81, v81
    v_cvt_pk_bf16_f32 v56, v76, v77
    v_exp_f32 v82, v82
    v_cvt_pk_bf16_f32 v57, v78, v79
    v_exp_f32 v83, v83
    v_cvt_pk_bf16_f32 v58, v80, v81
    v_cvt_pk_bf16_f32 v59, v82, v83
    s_waitcnt lgkmcnt(0)
    v_readfirstlane_b32 s33, v144
    s_nop 0
    s_cmp_eq_u32 s33, 0
    s_cbranch_scc1 L_at_fc6_spin
L_at_fc6_ok:
    v_mfma_f32_32x32x16_bf16 v[68:83], v[30:33], v[12:15], 0
    ds_read_b128 v[24:27], v132 offset:19456
    ds_read_b32 v28, v133 offset:19456
    v_exp_f32 v84, v84
    v_exp_f32 v85, v85
    v_exp_f32 v86, v86
    v_exp_f32 v87, v87
    v_mfma_f32_32x32x16_bf16 v[100:115], v[36:39], v[52:55], v[100:115]
    ds_read_b128 v[44:47], v134 offset:8512
    ds_read_b128 v[48:51], v134 offset:9120
    v_exp_f32 v88, v88
    v_exp_f32 v89, v89
    v_cvt_pk_bf16_f32 v60, v84, v85
    v_exp_f32 v90, v90
    v_cvt_pk_bf16_f32 v61, v86, v87
    v_exp_f32 v91, v91
    v_mfma_f32_32x32x8_bf16 v[68:83], v[34:35], v[16:17], v[68:83]
    v_exp_f32 v92, v92
    v_cvt_pk_bf16_f32 v62, v88, v89
    v_exp_f32 v93, v93
    v_cvt_pk_bf16_f32 v63, v90, v91
    v_exp_f32 v94, v94
    v_exp_f32 v95, v95
    v_mfma_f32_32x32x16_bf16 v[100:115], v[40:43], v[56:59], v[100:115]
    v_exp_f32 v96, v96
    v_exp_f32 v97, v97
    v_cvt_pk_bf16_f32 v64, v92, v93
    v_exp_f32 v98, v98
    v_cvt_pk_bf16_f32 v65, v94, v95
    v_exp_f32 v99, v99
    v_cvt_pk_bf16_f32 v66, v96, v97
    v_cvt_pk_bf16_f32 v67, v98, v99
    v_mfma_f32_32x32x16_bf16 v[84:99], v[30:33], v[18:21], 0
    v_exp_f32 v68, v68
    v_exp_f32 v69, v69
    v_exp_f32 v70, v70
    v_exp_f32 v71, v71
    v_mfma_f32_32x32x16_bf16 v[116:131], v[36:39], v[60:63], v[116:131]
    v_exp_f32 v72, v72
    v_exp_f32 v73, v73
    v_cvt_pk_bf16_f32 v52, v68, v69
    v_exp_f32 v74, v74
    v_cvt_pk_bf16_f32 v53, v70, v71
    v_exp_f32 v75, v75
    v_mfma_f32_32x32x8_bf16 v[84:99], v[34:35], v[22:23], v[84:99]
    v_exp_f32 v76, v76
    v_cvt_pk_bf16_f32 v54, v72, v73
    v_exp_f32 v77, v77
    v_cvt_pk_bf16_f32 v55, v74, v75
    v_exp_f32 v78, v78
    v_exp_f32 v79, v79
    v_mfma_f32_32x32x16_bf16 v[116:131], v[40:43], v[64:67], v[116:131]
    v_exp_f32 v80, v80
    v_exp_f32 v81, v81
    v_cvt_pk_bf16_f32 v56, v76, v77
    v_exp_f32 v82, v82
    v_cvt_pk_bf16_f32 v57, v78, v79
    v_exp_f32 v83, v83
    v_cvt_pk_bf16_f32 v58, v80, v81
    v_cvt_pk_bf16_f32 v59, v82, v83
    s_waitcnt lgkmcnt(0)
    v_mfma_f32_32x32x16_bf16 v[68:83], v[24:27], v[12:15], 0
    ds_read_b128 v[30:33], v132 offset:20480
    ds_read_b32 v34, v133 offset:19584
    v_exp_f32 v84, v84
    v_exp_f32 v85, v85
    v_exp_f32 v86, v86
    v_exp_f32 v87, v87
    v_mfma_f32_32x32x16_bf16 v[100:115], v[44:47], v[52:55], v[100:115]
    ds_read_b128 v[36:39], v134 offset:19456
    ds_read_b128 v[40:43], v134 offset:20064
    v_exp_f32 v88, v88
    v_exp_f32 v89, v89
    v_cvt_pk_bf16_f32 v60, v84, v85
    v_exp_f32 v90, v90
    v_cvt_pk_bf16_f32 v61, v86, v87
    v_exp_f32 v91, v91
    v_mfma_f32_32x32x8_bf16 v[68:83], v[28:29], v[16:17], v[68:83]
    v_exp_f32 v92, v92
    v_cvt_pk_bf16_f32 v62, v88, v89
    v_exp_f32 v93, v93
    v_cvt_pk_bf16_f32 v63, v90, v91
    v_exp_f32 v94, v94
    v_exp_f32 v95, v95
    v_mfma_f32_32x32x16_bf16 v[100:115], v[48:51], v[56:59], v[100:115]
    v_exp_f32 v96, v96
    v_exp_f32 v97, v97
    v_cvt_pk_bf16_f32 v64, v92, v93
    v_exp_f32 v98, v98
    v_cvt_pk_bf16_f32 v65, v94, v95
    v_exp_f32 v99, v99
    v_cvt_pk_bf16_f32 v66, v96, v97
    v_cvt_pk_bf16_f32 v67, v98, v99
    v_mfma_f32_32x32x16_bf16 v[84:99], v[24:27], v[18:21], 0
    v_exp_f32 v68, v68
    v_exp_f32 v69, v69
    v_exp_f32 v70, v70
    v_exp_f32 v71, v71
    v_mfma_f32_32x32x16_bf16 v[116:131], v[44:47], v[60:63], v[116:131]
    v_exp_f32 v72, v72
    v_exp_f32 v73, v73
    v_cvt_pk_bf16_f32 v52, v68, v69
    v_exp_f32 v74, v74
    v_cvt_pk_bf16_f32 v53, v70, v71
    v_exp_f32 v75, v75
    v_mfma_f32_32x32x8_bf16 v[84:99], v[28:29], v[22:23], v[84:99]
    v_exp_f32 v76, v76
    v_cvt_pk_bf16_f32 v54, v72, v73
    v_exp_f32 v77, v77
    v_cvt_pk_bf16_f32 v55, v74, v75
    v_exp_f32 v78, v78
    v_exp_f32 v79, v79
    v_mfma_f32_32x32x16_bf16 v[116:131], v[48:51], v[64:67], v[116:131]
    v_exp_f32 v80, v80
    v_exp_f32 v81, v81
    v_cvt_pk_bf16_f32 v56, v76, v77
    v_exp_f32 v82, v82
    v_cvt_pk_bf16_f32 v57, v78, v79
    v_exp_f32 v83, v83
    v_cvt_pk_bf16_f32 v58, v80, v81
    v_cvt_pk_bf16_f32 v59, v82, v83
    s_waitcnt lgkmcnt(0)
    v_mfma_f32_32x32x16_bf16 v[68:83], v[30:33], v[12:15], 0
    ds_read_b128 v[24:27], v132 offset:21504
    ds_read_b32 v28, v133 offset:19712
    v_exp_f32 v84, v84
    v_exp_f32 v85, v85
    v_exp_f32 v86, v86
    v_exp_f32 v87, v87
    v_mfma_f32_32x32x16_bf16 v[100:115], v[36:39], v[52:55], v[100:115]
    ds_read_b128 v[44:47], v134 offset:20672
    ds_read_b128 v[48:51], v134 offset:21280
    v_exp_f32 v88, v88
    v_exp_f32 v89, v89
    v_cvt_pk_bf16_f32 v60, v84, v85
    v_exp_f32 v90, v90
    v_cvt_pk_bf16_f32 v61, v86, v87
    v_exp_f32 v91, v91
    v_mfma_f32_32x32x8_bf16 v[68:83], v[34:35], v[16:17], v[68:83]
    v_exp_f32 v92, v92
    v_cvt_pk_bf16_f32 v62, v88, v89
    v_exp_f32 v93, v93
    v_cvt_pk_bf16_f32 v63, v90, v91
    v_exp_f32 v94, v94
    v_exp_f32 v95, v95
    v_mfma_f32_32x32x16_bf16 v[100:115], v[40:43], v[56:59], v[100:115]
    v_exp_f32 v96, v96
    v_exp_f32 v97, v97
    v_cvt_pk_bf16_f32 v64, v92, v93
    v_exp_f32 v98, v98
    v_cvt_pk_bf16_f32 v65, v94, v95
    v_exp_f32 v99, v99
    v_cvt_pk_bf16_f32 v66, v96, v97
    v_cvt_pk_bf16_f32 v67, v98, v99
    v_mfma_f32_32x32x16_bf16 v[84:99], v[30:33], v[18:21], 0
    v_exp_f32 v68, v68
    v_exp_f32 v69, v69
    v_exp_f32 v70, v70
    v_exp_f32 v71, v71
    v_mfma_f32_32x32x16_bf16 v[116:131], v[36:39], v[60:63], v[116:131]
    v_exp_f32 v72, v72
    v_exp_f32 v73, v73
    v_cvt_pk_bf16_f32 v52, v68, v69
    v_exp_f32 v74, v74
    v_cvt_pk_bf16_f32 v53, v70, v71
    v_exp_f32 v75, v75
    v_mfma_f32_32x32x8_bf16 v[84:99], v[34:35], v[22:23], v[84:99]
    v_exp_f32 v76, v76
    v_cvt_pk_bf16_f32 v54, v72, v73
    v_exp_f32 v77, v77
    v_cvt_pk_bf16_f32 v55, v74, v75
    v_exp_f32 v78, v78
    v_exp_f32 v79, v79
    v_mfma_f32_32x32x16_bf16 v[116:131], v[40:43], v[64:67], v[116:131]
    v_exp_f32 v80, v80
    v_exp_f32 v81, v81
    v_cvt_pk_bf16_f32 v56, v76, v77
    v_exp_f32 v82, v82
    v_cvt_pk_bf16_f32 v57, v78, v79
    v_exp_f32 v83, v83
    v_cvt_pk_bf16_f32 v58, v80, v81
    v_cvt_pk_bf16_f32 v59, v82, v83
    s_waitcnt lgkmcnt(0)
    v_mfma_f32_32x32x16_bf16 v[68:83], v[24:27], v[12:15], 0
    ds_read_b128 v[30:33], v132 offset:22528
    ds_read_b32 v34, v133 offset:19840
    v_exp_f32 v84, v84
    v_exp_f32 v85, v85
    v_exp_f32 v86, v86
    v_exp_f32 v87, v87
    v_mfma_f32_32x32x16_bf16 v[100:115], v[44:47], v[52:55], v[100:115]
    ds_read_b128 v[36:39], v134 offset:21888
    ds_read_b128 v[40:43], v134 offset:22496
    v_exp_f32 v88, v88
    v_exp_f32 v89, v89
    v_cvt_pk_bf16_f32 v60, v84, v85
    v_exp_f32 v90, v90
    v_cvt_pk_bf16_f32 v61, v86, v87
    v_exp_f32 v91, v91
    v_mfma_f32_32x32x8_bf16 v[68:83], v[28:29], v[16:17], v[68:83]
    v_exp_f32 v92, v92
    v_cvt_pk_bf16_f32 v62, v88, v89
    v_exp_f32 v93, v93
    v_cvt_pk_bf16_f32 v63, v90, v91
    v_exp_f32 v94, v94
    v_exp_f32 v95, v95
    v_mfma_f32_32x32x16_bf16 v[100:115], v[48:51], v[56:59], v[100:115]
    v_exp_f32 v96, v96
    v_exp_f32 v97, v97
    v_cvt_pk_bf16_f32 v64, v92, v93
    v_exp_f32 v98, v98
    v_cvt_pk_bf16_f32 v65, v94, v95
    v_exp_f32 v99, v99
    v_cvt_pk_bf16_f32 v66, v96, v97
    v_cvt_pk_bf16_f32 v67, v98, v99
    v_mfma_f32_32x32x16_bf16 v[84:99], v[24:27], v[18:21], 0
    v_exp_f32 v68, v68
    v_exp_f32 v69, v69
    v_exp_f32 v70, v70
    v_exp_f32 v71, v71
    v_mfma_f32_32x32x16_bf16 v[116:131], v[44:47], v[60:63], v[116:131]
    v_exp_f32 v72, v72
    v_exp_f32 v73, v73
    v_cvt_pk_bf16_f32 v52, v68, v69
    v_exp_f32 v74, v74
    v_cvt_pk_bf16_f32 v53, v70, v71
    v_exp_f32 v75, v75
    v_mfma_f32_32x32x8_bf16 v[84:99], v[28:29], v[22:23], v[84:99]
    v_exp_f32 v76, v76
    v_cvt_pk_bf16_f32 v54, v72, v73
    v_exp_f32 v77, v77
    v_cvt_pk_bf16_f32 v55, v74, v75
    v_exp_f32 v78, v78
    v_exp_f32 v79, v79
    v_mfma_f32_32x32x16_bf16 v[116:131], v[48:51], v[64:67], v[116:131]
    v_exp_f32 v80, v80
    v_exp_f32 v81, v81
    v_cvt_pk_bf16_f32 v56, v76, v77
    v_exp_f32 v82, v82
    v_cvt_pk_bf16_f32 v57, v78, v79
    v_exp_f32 v83, v83
    v_cvt_pk_bf16_f32 v58, v80, v81
    v_cvt_pk_bf16_f32 v59, v82, v83
    s_waitcnt lgkmcnt(0)
    v_mfma_f32_32x32x16_bf16 v[68:83], v[30:33], v[12:15], 0
    ds_read_b128 v[24:27], v132 offset:23552
    ds_read_b32 v28, v133 offset:19968
    v_exp_f32 v84, v84
    v_exp_f32 v85, v85
    v_exp_f32 v86, v86
    v_exp_f32 v87, v87
    v_mfma_f32_32x32x16_bf16 v[100:115], v[36:39], v[52:55], v[100:115]
    ds_read_b128 v[44:47], v134 offset:23104
    ds_read_b128 v[48:51], v134 offset:23712
    v_exp_f32 v88, v88
    v_exp_f32 v89, v89
    v_cvt_pk_bf16_f32 v60, v84, v85
    v_exp_f32 v90, v90
    v_cvt_pk_bf16_f32 v61, v86, v87
    v_exp_f32 v91, v91
    v_mfma_f32_32x32x8_bf16 v[68:83], v[34:35], v[16:17], v[68:83]
    v_exp_f32 v92, v92
    v_cvt_pk_bf16_f32 v62, v88, v89
    v_exp_f32 v93, v93
    v_cvt_pk_bf16_f32 v63, v90, v91
    v_exp_f32 v94, v94
    v_exp_f32 v95, v95
    v_mfma_f32_32x32x16_bf16 v[100:115], v[40:43], v[56:59], v[100:115]
    v_exp_f32 v96, v96
    v_exp_f32 v97, v97
    v_cvt_pk_bf16_f32 v64, v92, v93
    v_exp_f32 v98, v98
    v_cvt_pk_bf16_f32 v65, v94, v95
    v_exp_f32 v99, v99
    v_cvt_pk_bf16_f32 v66, v96, v97
    v_cvt_pk_bf16_f32 v67, v98, v99
    v_mfma_f32_32x32x16_bf16 v[84:99], v[30:33], v[18:21], 0
    v_exp_f32 v68, v68
    v_exp_f32 v69, v69
    v_exp_f32 v70, v70
    v_exp_f32 v71, v71
    v_mfma_f32_32x32x16_bf16 v[116:131], v[36:39], v[60:63], v[116:131]
    v_exp_f32 v72, v72
    v_exp_f32 v73, v73
    v_cvt_pk_bf16_f32 v52, v68, v69
    v_exp_f32 v74, v74
    v_cvt_pk_bf16_f32 v53, v70, v71
    v_exp_f32 v75, v75
    v_mfma_f32_32x32x8_bf16 v[84:99], v[34:35], v[22:23], v[84:99]
    v_exp_f32 v76, v76
    v_cvt_pk_bf16_f32 v54, v72, v73
    v_exp_f32 v77, v77
    v_cvt_pk_bf16_f32 v55, v74, v75
    v_exp_f32 v78, v78
    v_exp_f32 v79, v79
    v_mfma_f32_32x32x16_bf16 v[116:131], v[40:43], v[64:67], v[116:131]
    v_exp_f32 v80, v80
    v_exp_f32 v81, v81
    v_cvt_pk_bf16_f32 v56, v76, v77
    v_exp_f32 v82, v82
    v_cvt_pk_bf16_f32 v57, v78, v79
    v_exp_f32 v83, v83
    v_cvt_pk_bf16_f32 v58, v80, v81
    v_cvt_pk_bf16_f32 v59, v82, v83
    s_waitcnt lgkmcnt(0)
    v_mfma_f32_32x32x16_bf16 v[68:83], v[24:27], v[12:15], 0
    ds_read_b128 v[30:33], v132 offset:24576
    ds_read_b32 v34, v133 offset:20096
    v_exp_f32 v84, v84
    v_exp_f32 v85, v85
    v_exp_f32 v86, v86
    v_exp_f32 v87, v87
    v_mfma_f32_32x32x16_bf16 v[100:115], v[44:47], v[52:55], v[100:115]
    ds_read_b128 v[36:39], v134 offset:24320
    ds_read_b128 v[40:43], v134 offset:24928
    v_exp_f32 v88, v88
    v_exp_f32 v89, v89
    v_cvt_pk_bf16_f32 v60, v84, v85
    v_exp_f32 v90, v90
    v_cvt_pk_bf16_f32 v61, v86, v87
    v_exp_f32 v91, v91
    v_mfma_f32_32x32x8_bf16 v[68:83], v[28:29], v[16:17], v[68:83]
    v_exp_f32 v92, v92
    v_cvt_pk_bf16_f32 v62, v88, v89
    v_exp_f32 v93, v93
    v_cvt_pk_bf16_f32 v63, v90, v91
    v_exp_f32 v94, v94
    v_exp_f32 v95, v95
    v_mfma_f32_32x32x16_bf16 v[100:115], v[48:51], v[56:59], v[100:115]
    v_exp_f32 v96, v96
    v_exp_f32 v97, v97
    v_cvt_pk_bf16_f32 v64, v92, v93
    v_exp_f32 v98, v98
    v_cvt_pk_bf16_f32 v65, v94, v95
    v_exp_f32 v99, v99
    v_cvt_pk_bf16_f32 v66, v96, v97
    v_cvt_pk_bf16_f32 v67, v98, v99
    v_mfma_f32_32x32x16_bf16 v[84:99], v[24:27], v[18:21], 0
    v_exp_f32 v68, v68
    v_exp_f32 v69, v69
    v_exp_f32 v70, v70
    v_exp_f32 v71, v71
    v_mfma_f32_32x32x16_bf16 v[116:131], v[44:47], v[60:63], v[116:131]
    v_exp_f32 v72, v72
    v_exp_f32 v73, v73
    v_cvt_pk_bf16_f32 v52, v68, v69
    v_exp_f32 v74, v74
    v_cvt_pk_bf16_f32 v53, v70, v71
    v_exp_f32 v75, v75
    v_mfma_f32_32x32x8_bf16 v[84:99], v[28:29], v[22:23], v[84:99]
    v_exp_f32 v76, v76
    v_cvt_pk_bf16_f32 v54, v72, v73
    v_exp_f32 v77, v77
    v_cvt_pk_bf16_f32 v55, v74, v75
    v_exp_f32 v78, v78
    v_exp_f32 v79, v79
    v_mfma_f32_32x32x16_bf16 v[116:131], v[48:51], v[64:67], v[116:131]
    v_exp_f32 v80, v80
    v_exp_f32 v81, v81
    v_cvt_pk_bf16_f32 v56, v76, v77
    v_exp_f32 v82, v82
    v_cvt_pk_bf16_f32 v57, v78, v79
    v_exp_f32 v83, v83
    v_cvt_pk_bf16_f32 v58, v80, v81
    v_cvt_pk_bf16_f32 v59, v82, v83
    s_waitcnt lgkmcnt(0)
    v_mfma_f32_32x32x16_bf16 v[68:83], v[30:33], v[12:15], 0
    ds_read_b128 v[24:27], v132 offset:25600
    ds_read_b32 v28, v133 offset:20224
    v_exp_f32 v84, v84
    v_exp_f32 v85, v85
    v_exp_f32 v86, v86
    v_exp_f32 v87, v87
    v_mfma_f32_32x32x16_bf16 v[100:115], v[36:39], v[52:55], v[100:115]
    ds_read_b128 v[44:47], v134 offset:25536
    ds_read_b128 v[48:51], v134 offset:26144
    v_exp_f32 v88, v88
    v_exp_f32 v89, v89
    v_cvt_pk_bf16_f32 v60, v84, v85
    v_exp_f32 v90, v90
    v_cvt_pk_bf16_f32 v61, v86, v87
    v_exp_f32 v91, v91
    v_mfma_f32_32x32x8_bf16 v[68:83], v[34:35], v[16:17], v[68:83]
    v_exp_f32 v92, v92
    v_cvt_pk_bf16_f32 v62, v88, v89
    v_exp_f32 v93, v93
    v_cvt_pk_bf16_f32 v63, v90, v91
    v_exp_f32 v94, v94
    v_exp_f32 v95, v95
    v_mfma_f32_32x32x16_bf16 v[100:115], v[40:43], v[56:59], v[100:115]
    v_exp_f32 v96, v96
    v_exp_f32 v97, v97
    v_cvt_pk_bf16_f32 v64, v92, v93
    v_exp_f32 v98, v98
    v_cvt_pk_bf16_f32 v65, v94, v95
    v_exp_f32 v99, v99
    v_cvt_pk_bf16_f32 v66, v96, v97
    v_cvt_pk_bf16_f32 v67, v98, v99
    v_mfma_f32_32x32x16_bf16 v[84:99], v[30:33], v[18:21], 0
    v_exp_f32 v68, v68
    v_exp_f32 v69, v69
    v_exp_f32 v70, v70
    v_exp_f32 v71, v71
    v_mfma_f32_32x32x16_bf16 v[116:131], v[36:39], v[60:63], v[116:131]
    v_exp_f32 v72, v72
    v_exp_f32 v73, v73
    v_cvt_pk_bf16_f32 v52, v68, v69
    v_exp_f32 v74, v74
    v_cvt_pk_bf16_f32 v53, v70, v71
    v_exp_f32 v75, v75
    v_mfma_f32_32x32x8_bf16 v[84:99], v[34:35], v[22:23], v[84:99]
    v_exp_f32 v76, v76
    v_cvt_pk_bf16_f32 v54, v72, v73
    v_exp_f32 v77, v77
    v_cvt_pk_bf16_f32 v55, v74, v75
    v_exp_f32 v78, v78
    v_exp_f32 v79, v79
    v_mfma_f32_32x32x16_bf16 v[116:131], v[40:43], v[64:67], v[116:131]
    v_exp_f32 v80, v80
    v_exp_f32 v81, v81
    v_cvt_pk_bf16_f32 v56, v76, v77
    v_exp_f32 v82, v82
    v_cvt_pk_bf16_f32 v57, v78, v79
    v_exp_f32 v83, v83
    v_cvt_pk_bf16_f32 v58, v80, v81
    v_cvt_pk_bf16_f32 v59, v82, v83
    s_waitcnt lgkmcnt(0)
    v_mfma_f32_32x32x16_bf16 v[68:83], v[24:27], v[12:15], 0
    ds_read_b128 v[30:33], v132 offset:26624
    ds_read_b32 v34, v133 offset:20352
    v_exp_f32 v84, v84
    v_exp_f32 v85, v85
    v_exp_f32 v86, v86
    v_exp_f32 v87, v87
    v_mfma_f32_32x32x16_bf16 v[100:115], v[44:47], v[52:55], v[100:115]
    ds_read_b128 v[36:39], v134 offset:26752
    ds_read_b128 v[40:43], v134 offset:27360
    v_exp_f32 v88, v88
    v_exp_f32 v89, v89
    v_cvt_pk_bf16_f32 v60, v84, v85
    v_exp_f32 v90, v90
    v_cvt_pk_bf16_f32 v61, v86, v87
    v_exp_f32 v91, v91
    v_mfma_f32_32x32x8_bf16 v[68:83], v[28:29], v[16:17], v[68:83]
    v_exp_f32 v92, v92
    v_cvt_pk_bf16_f32 v62, v88, v89
    v_exp_f32 v93, v93
    v_cvt_pk_bf16_f32 v63, v90, v91
    v_exp_f32 v94, v94
    v_exp_f32 v95, v95
    v_mfma_f32_32x32x16_bf16 v[100:115], v[48:51], v[56:59], v[100:115]
    v_exp_f32 v96, v96
    v_exp_f32 v97, v97
    v_cvt_pk_bf16_f32 v64, v92, v93
    v_exp_f32 v98, v98
    v_cvt_pk_bf16_f32 v65, v94, v95
    v_exp_f32 v99, v99
    v_cvt_pk_bf16_f32 v66, v96, v97
    v_cvt_pk_bf16_f32 v67, v98, v99
    v_mfma_f32_32x32x16_bf16 v[84:99], v[24:27], v[18:21], 0
    v_exp_f32 v68, v68
    v_exp_f32 v69, v69
    v_exp_f32 v70, v70
    v_exp_f32 v71, v71
    v_mfma_f32_32x32x16_bf16 v[116:131], v[44:47], v[60:63], v[116:131]
    v_exp_f32 v72, v72
    v_exp_f32 v73, v73
    v_cvt_pk_bf16_f32 v52, v68, v69
    v_exp_f32 v74, v74
    v_cvt_pk_bf16_f32 v53, v70, v71
    v_exp_f32 v75, v75
    v_mfma_f32_32x32x8_bf16 v[84:99], v[28:29], v[22:23], v[84:99]
    v_exp_f32 v76, v76
    v_cvt_pk_bf16_f32 v54, v72, v73
    v_exp_f32 v77, v77
    v_cvt_pk_bf16_f32 v55, v74, v75
    v_exp_f32 v78, v78
    v_exp_f32 v79, v79
    v_mfma_f32_32x32x16_bf16 v[116:131], v[48:51], v[64:67], v[116:131]
    v_exp_f32 v80, v80
    v_exp_f32 v81, v81
    v_cvt_pk_bf16_f32 v56, v76, v77
    v_exp_f32 v82, v82
    v_cvt_pk_bf16_f32 v57, v78, v79
    v_exp_f32 v83, v83
    v_cvt_pk_bf16_f32 v58, v80, v81
    v_cvt_pk_bf16_f32 v59, v82, v83
    s_waitcnt lgkmcnt(0)
    v_mfma_f32_32x32x16_bf16 v[68:83], v[30:33], v[12:15], 0
    v_exp_f32 v84, v84
    v_exp_f32 v85, v85
    v_exp_f32 v86, v86
    v_exp_f32 v87, v87
    v_mfma_f32_32x32x16_bf16 v[100:115], v[36:39], v[52:55], v[100:115]
    ds_read_b128 v[44:47], v134 offset:27968
    ds_read_b128 v[48:51], v134 offset:28576
    v_exp_f32 v88, v88
    v_exp_f32 v89, v89
    v_cvt_pk_bf16_f32 v60, v84, v85
    v_exp_f32 v90, v90
    v_cvt_pk_bf16_f32 v61, v86, v87
    v_exp_f32 v91, v91
    v_mfma_f32_32x32x8_bf16 v[68:83], v[34:35], v[16:17], v[68:83]
    v_exp_f32 v92, v92
    v_cvt_pk_bf16_f32 v62, v88, v89
    v_exp_f32 v93, v93
    v_cvt_pk_bf16_f32 v63, v90, v91
    v_exp_f32 v94, v94
    v_exp_f32 v95, v95
    v_mfma_f32_32x32x16_bf16 v[100:115], v[40:43], v[56:59], v[100:115]
    v_exp_f32 v96, v96
    v_exp_f32 v97, v97
    v_cvt_pk_bf16_f32 v64, v92, v93
    v_exp_f32 v98, v98
    v_cvt_pk_bf16_f32 v65, v94, v95
    v_exp_f32 v99, v99
    v_cvt_pk_bf16_f32 v66, v96, v97
    v_cvt_pk_bf16_f32 v67, v98, v99
    v_mfma_f32_32x32x16_bf16 v[84:99], v[30:33], v[18:21], 0
    v_exp_f32 v68, v68
    v_exp_f32 v69, v69
    v_exp_f32 v70, v70
    v_exp_f32 v71, v71
    v_mfma_f32_32x32x16_bf16 v[116:131], v[36:39], v[60:63], v[116:131]
    v_exp_f32 v72, v72
    v_exp_f32 v73, v73
    v_cvt_pk_bf16_f32 v52, v68, v69
    v_exp_f32 v74, v74
    v_cvt_pk_bf16_f32 v53, v70, v71
    v_exp_f32 v75, v75
    v_mfma_f32_32x32x8_bf16 v[84:99], v[34:35], v[22:23], v[84:99]
    v_exp_f32 v76, v76
    v_cvt_pk_bf16_f32 v54, v72, v73
    v_exp_f32 v77, v77
    v_cvt_pk_bf16_f32 v55, v74, v75
    v_exp_f32 v78, v78
    v_exp_f32 v79, v79
    v_mfma_f32_32x32x16_bf16 v[116:131], v[40:43], v[64:67], v[116:131]
    v_exp_f32 v80, v80
    v_exp_f32 v81, v81
    v_cvt_pk_bf16_f32 v56, v76, v77
    v_exp_f32 v82, v82
    v_cvt_pk_bf16_f32 v57, v78, v79
    v_exp_f32 v83, v83
    v_cvt_pk_bf16_f32 v58, v80, v81
    v_cvt_pk_bf16_f32 v59, v82, v83
    s_waitcnt lgkmcnt(0)
    s_nop 0
    v_exp_f32 v84, v84
    v_exp_f32 v85, v85
    v_exp_f32 v86, v86
    v_exp_f32 v87, v87
    v_mfma_f32_32x32x16_bf16 v[100:115], v[44:47], v[52:55], v[100:115]
    v_exp_f32 v88, v88
    v_exp_f32 v89, v89
    v_cvt_pk_bf16_f32 v60, v84, v85
    v_exp_f32 v90, v90
    v_cvt_pk_bf16_f32 v61, v86, v87
    v_exp_f32 v91, v91
    s_nop 0
    v_exp_f32 v92, v92
    v_cvt_pk_bf16_f32 v62, v88, v89
    v_exp_f32 v93, v93
    v_cvt_pk_bf16_f32 v63, v90, v91
    v_exp_f32 v94, v94
    v_exp_f32 v95, v95
    v_mfma_f32_32x32x16_bf16 v[100:115], v[48:51], v[56:59], v[100:115]
    v_exp_f32 v96, v96
    v_exp_f32 v97, v97
    v_cvt_pk_bf16_f32 v64, v92, v93
    v_exp_f32 v98, v98
    v_cvt_pk_bf16_f32 v65, v94, v95
    v_exp_f32 v99, v99
    v_cvt_pk_bf16_f32 v66, v96, v97
    v_cvt_pk_bf16_f32 v67, v98, v99
    s_nop 1
    v_mfma_f32_32x32x16_bf16 v[116:131], v[44:47], v[60:63], v[116:131]
    v_mfma_f32_32x32x16_bf16 v[116:131], v[48:51], v[64:67], v[116:131]
    s_setprio 3
    s_add_u32 s36, s15, 1
    v_mov_b32 v5, v110
    v_mov_b32 v6, v110
    s_lshl_b32 s16, s12, 6
    s_add_u32 s16, s16, s15
    v_permlane32_swap_b32 v5, v6
    s_lshl_b32 s16, s16, 10
    s_add_u32 s16, s16, 16777216
    v_cmp_class_f32 s[26:27], v5, s23
    v_cmp_class_f32 vcc, v100, v141
    s_or_b64 s[26:27], s[26:27], vcc
    v_cmp_class_f32 vcc, v101, v141
    s_or_b64 s[26:27], s[26:27], vcc
    v_cmp_class_f32 vcc, v102, v141
    s_or_b64 s[26:27], s[26:27], vcc
    v_cmp_class_f32 vcc, v103, v141
    s_or_b64 s[26:27], s[26:27], vcc
    v_cmp_class_f32 vcc, v104, v141
    s_or_b64 s[26:27], s[26:27], vcc
    v_cmp_class_f32 vcc, v105, v141
    s_or_b64 s[26:27], s[26:27], vcc
    v_cmp_class_f32 vcc, v106, v141
    s_or_b64 s[26:27], s[26:27], vcc
    v_cmp_class_f32 vcc, v107, v141
    s_or_b64 s[26:27], s[26:27], vcc
    v_cmp_class_f32 vcc, v108, v141
    s_mov_b32 vcc_hi, 0
    s_or_b64 s[26:27], s[26:27], vcc
    v_cmp_class_f32 vcc, v109, v141
    s_mov_b32 vcc_hi, 0
    s_or_b64 s[26:27], s[26:27], vcc
    v_mov_b32 v138, v126
    v_mov_b32 v139, v126
    s_cmp_lg_u64 s[26:27], 0
    s_cbranch_scc1 L_at_slowa
L_at_slowa_ret:
    v_permlane32_swap_b32 v138, v139
    v_rcp_f32 v5, v5
    v_cmp_class_f32 s[26:27], v138, s23
    v_cmp_class_f32 vcc, v116, v141
    s_or_b64 s[26:27], s[26:27], vcc
    v_cmp_class_f32 vcc, v117, v141
    s_or_b64 s[26:27], s[26:27], vcc
    v_cmp_class_f32 vcc, v118, v141
    s_or_b64 s[26:27], s[26:27], vcc
    v_cmp_class_f32 vcc, v119, v141
    s_or_b64 s[26:27], s[26:27], vcc
    v_cmp_class_f32 vcc, v120, v141
    s_or_b64 s[26:27], s[26:27], vcc
    v_cmp_class_f32 vcc, v121, v141
    s_or_b64 s[26:27], s[26:27], vcc
    v_cmp_class_f32 vcc, v122, v141
    s_or_b64 s[26:27], s[26:27], vcc
    v_cmp_class_f32 vcc, v123, v141
    s_or_b64 s[26:27], s[26:27], vcc
    v_cmp_class_f32 vcc, v124, v141
    s_mov_b32 vcc_hi, 0
    s_or_b64 s[26:27], s[26:27], vcc
    v_cmp_class_f32 vcc, v125, v141
    s_mov_b32 vcc_hi, 0
    s_or_b64 s[26:27], s[26:27], vcc
    v_mul_f32 v100, v100, v5
    v_mul_f32 v101, v101, v5
    v_cvt_pk_bf16_f32 v52, v100, v101
    v_mul_f32 v102, v102, v5
    v_mul_f32 v103, v103, v5
    v_cvt_pk_bf16_f32 v53, v102, v103
    v_mul_f32 v104, v104, v5
    v_mul_f32 v105, v105, v5
    v_cvt_pk_bf16_f32 v54, v104, v105
    v_mul_f32 v106, v106, v5
    v_mul_f32 v107, v107, v5
    v_cvt_pk_bf16_f32 v55, v106, v107
    v_mul_f32 v108, v108, v5
    v_mul_f32 v109, v109, v5
    v_cvt_pk_bf16_f32 v56, v108, v109
    buffer_store_dwordx4 v[52:55], v2, s[8:11], s16 offen sc1
    s_lshr_b32 s19, s12, 3
    s_lshl_b32 s19, s19, 6
    s_add_u32 s19, s19, s15
    s_lshl_b32 s19, s19, 10
    s_bfe_u32 s17, s12, 0x10002
    s_lshl_b32 s17, s17, 9
    s_add_u32 s19, s19, s17
    s_and_b32 s17, s12, 3
    s_lshl_b32 s17, s17, 2
    s_add_u32 s19, s19, s17
    s_add_u32 s19, s19, 18874368
    buffer_store_dword v56, v140, s[8:11], s19 offen sc1
    s_mov_b32 s22, s16
    s_mov_b32 s36, s19
    s_cmp_lg_u64 s[26:27], 0
    s_cbranch_scc1 L_at_slowb
L_at_slowb_ret:
    v_rcp_f32 v138, v138
    s_nop 0
    v_mul_f32 v116, v116, v138
    v_mul_f32 v117, v117, v138
    v_cvt_pk_bf16_f32 v60, v116, v117
    v_mul_f32 v118, v118, v138
    v_mul_f32 v119, v119, v138
    v_cvt_pk_bf16_f32 v61, v118, v119
    v_mul_f32 v120, v120, v138
    v_mul_f32 v121, v121, v138
    v_cvt_pk_bf16_f32 v62, v120, v121
    v_mul_f32 v122, v122, v138
    v_mul_f32 v123, v123, v138
    v_cvt_pk_bf16_f32 v63, v122, v123
    v_mul_f32 v124, v124, v138
    v_mul_f32 v125, v125, v138
    v_cvt_pk_bf16_f32 v64, v124, v125
    buffer_store_dwordx4 v[60:63], v2, s[8:11], s22 offen offset:1024 sc1
    buffer_store_dword v64, v140, s[8:11], s36 offen offset:1024 sc1
    s_branch L_at_fin
L_at_A:
    s_setprio 3
    v_and_b32 v5, 31, v1
    v_lshrrev_b32 v6, 5, v1
    v_lshlrev_b32 v7, 2, v6
    v_sub_u32 v7, v5, v7
    v_cmp_le_i32 vcc, 0, v7
    v_cmp_le_i32 s[26:27], 1, v7
    s_nop 0
    v_cndmask_b32_e64 v112, v10, 0, vcc
    v_cndmask_b32_e64 v148, 0, v10, vcc
    v_cndmask_b32_e64 v113, v10, 0, s[26:27]
    v_cndmask_b32_e64 v149, 0, v10, s[26:27]
    v_cmp_le_i32 vcc, 2, v7
    v_cmp_le_i32 s[26:27], 3, v7
    s_nop 0
    v_cndmask_b32_e64 v114, v10, 0, vcc
    v_cndmask_b32_e64 v150, 0, v10, vcc
    v_cndmask_b32_e64 v115, v10, 0, s[26:27]
    v_cndmask_b32_e64 v151, 0, v10, s[26:27]
    v_cmp_le_i32 vcc, 8, v7
    v_cmp_le_i32 s[26:27], 9, v7
    s_nop 0
    v_cndmask_b32_e64 v116, v10, 0, vcc
    v_cndmask_b32_e64 v152, 0, v10, vcc
    v_cndmask_b32_e64 v117, v10, 0, s[26:27]
    v_cndmask_b32_e64 v153, 0, v10, s[26:27]
    v_cmp_le_i32 vcc, 10, v7
    v_cmp_le_i32 s[26:27], 11, v7
    s_nop 0
    v_cndmask_b32_e64 v118, v10, 0, vcc
    v_cndmask_b32_e64 v154, 0, v10, vcc
    v_cndmask_b32_e64 v119, v10, 0, s[26:27]
    v_cndmask_b32_e64 v155, 0, v10, s[26:27]
    v_cmp_le_i32 vcc, 16, v7
    v_cmp_le_i32 s[26:27], 17, v7
    s_nop 0
    v_cndmask_b32_e64 v120, v10, 0, vcc
    v_cndmask_b32_e64 v156, 0, v10, vcc
    v_cndmask_b32_e64 v121, v10, 0, s[26:27]
    v_cndmask_b32_e64 v157, 0, v10, s[26:27]
    v_cmp_le_i32 vcc, 18, v7
    v_cmp_le_i32 s[26:27], 19, v7
    s_nop 0
    v_cndmask_b32_e64 v122, v10, 0, vcc
    v_cndmask_b32_e64 v158, 0, v10, vcc
    v_cndmask_b32_e64 v123, v10, 0, s[26:27]
    v_cndmask_b32_e64 v159, 0, v10, s[26:27]
    v_cmp_le_i32 vcc, 24, v7
    v_cmp_le_i32 s[26:27], 25, v7
    s_nop 0
    v_cndmask_b32_e64 v124, v10, 0, vcc
    v_cndmask_b32_e64 v160, 0, v10, vcc
    v_cndmask_b32_e64 v125, v10, 0, s[26:27]
    v_cndmask_b32_e64 v161, 0, v10, s[26:27]
    v_cmp_le_i32 vcc, 26, v7
    v_cmp_le_i32 s[26:27], 27, v7
    s_nop 0
    v_cndmask_b32_e64 v126, v10, 0, vcc
    v_cndmask_b32_e64 v162, 0, v10, vcc
    v_cndmask_b32_e64 v127, v10, 0, s[26:27]
    v_cndmask_b32_e64 v163, 0, v10, s[26:27]
    ds_read_b32 v144, v145 offset:40
    s_mov_b32 s36, 0
    s_waitcnt vmcnt(0) lgkmcnt(0)
    s_mov_b32 s16, 0x3eae1a93
    v_lshlrev_b32 v5, 16, v12
    v_and_b32 v6, 0xffff0000, v12
    v_mul_f32 v5, s16, v5
    v_mul_f32 v6, s16, v6
    v_cvt_pk_bf16_f32 v12, v5, v6
    v_lshlrev_b32 v7, 16, v13
    v_and_b32 v8, 0xffff0000, v13
    v_mul_f32 v7, s16, v7
    v_mul_f32 v8, s16, v8
    v_cvt_pk_bf16_f32 v13, v7, v8
    v_lshlrev_b32 v5, 16, v14
    v_and_b32 v6, 0xffff0000, v14
    v_mul_f32 v5, s16, v5
    v_mul_f32 v6, s16, v6
    v_cvt_pk_bf16_f32 v14, v5, v6
    v_lshlrev_b32 v7, 16, v15
    v_and_b32 v8, 0xffff0000, v15
    v_mul_f32 v7, s16, v7
    v_mul_f32 v8, s16, v8
    v_cvt_pk_bf16_f32 v15, v7, v8
    v_lshlrev_b32 v5, 16, v16
    v_and_b32 v6, 0xffff0000, v16
    v_mul_f32 v5, s16, v5
    v_mul_f32 v6, s16, v6
    v_cvt_pk_bf16_f32 v16, v5, v6
    v_lshlrev_b32 v7, 16, v18
    v_and_b32 v8, 0xffff0000, v18
    v_mul_f32 v7, s16, v7
    v_mul_f32 v8, s16, v8
    v_cvt_pk_bf16_f32 v18, v7, v8
    v_lshlrev_b32 v5, 16, v19
    v_and_b32 v6, 0xffff0000, v19
    v_mul_f32 v5, s16, v5
    v_mul_f32 v6, s16, v6
    v_cvt_pk_bf16_f32 v19, v5, v6
    v_lshlrev_b32 v7, 16, v20
    v_and_b32 v8, 0xffff0000, v20
    v_mul_f32 v7, s16, v7
    v_mul_f32 v8, s16, v8
    v_cvt_pk_bf16_f32 v20, v7, v8
    v_lshlrev_b32 v5, 16, v21
    v_and_b32 v6, 0xffff0000, v21
    v_mul_f32 v5, s16, v5
    v_mul_f32 v6, s16, v6
    v_cvt_pk_bf16_f32 v21, v5, v6
    v_lshlrev_b32 v7, 16, v22
    v_and_b32 v8, 0xffff0000, v22
    v_mul_f32 v7, s16, v7
    v_mul_f32 v8, s16, v8
    v_cvt_pk_bf16_f32 v22, v7, v8
    s_nop 1
    v_readfirstlane_b32 s33, v144
    s_nop 0
    s_cmp_eq_u32 s33, 0
    s_cbranch_scc1 L_at_fa_spin
L_at_fa_ok:
L_at_Aloop:
    s_lshl_b32 s16, s21, 10
    s_add_u32 s16, s16, 116736
    v_add_u32 v132, s16, v2
    s_lshl_b32 s16, s21, 7
    s_add_u32 s16, s16, 124928
    v_add_u32 v133, s16, v3
    s_mul_i32 s16, s21, 1216
    s_add_u32 s16, s16, 125952
    v_add_u32 v134, s16, v4
    s_mov_b32 s35, 0
    v_and_b32 v17, 0xffff, v17
    s_cmp_ge_u32 s15, 1
    s_cselect_b32 s16, s31, s32
    v_mov_b32 v41, s16
    v_mov_b32 v47, s31
    ds_read_b128 v[36:39], v132 offset:7168
    ds_read_b32 v40, v133 offset:896
    ds_read_b128 v[42:45], v132 offset:8192
    ds_read_b32 v46, v133 offset:1024
    ds_read_b128 v[24:27], v132 offset:0
    ds_read_b32 v28, v133 offset:0
    ds_read_b128 v[30:33], v132 offset:1024
    ds_read_b32 v34, v133 offset:128
    s_waitcnt lgkmcnt(4)
    v_mfma_f32_32x32x16_bf16 v[64:79], v[36:39], v[12:15], 0
    v_mfma_f32_32x32x16_bf16 v[80:95], v[42:45], v[12:15], v[112:127]
    v_mfma_f32_32x32x8_bf16 v[64:79], v[40:41], v[16:17], v[64:79]
    v_mfma_f32_32x32x8_bf16 v[80:95], v[46:47], v[16:17], v[80:95]
    ds_read_b128 v[36:39], v134
    ds_read_b128 v[40:43], v134 offset:608
    s_cmp_ge_u32 s15, 8
    s_cselect_b32 s16, s31, s32
    v_mov_b32 v29, s16
    s_cmp_ge_u32 s15, 7
    s_cselect_b32 s16, s31, s32
    v_mov_b32 v35, s16
    v_mov_b64 v[96:97], 0
    v_mov_b64 v[98:99], 0
    v_mov_b64 v[100:101], 0
    v_mov_b64 v[102:103], 0
    v_mov_b64 v[104:105], 0
    v_mov_b64 v[106:107], 0
    v_mov_b64 v[108:109], 0
    v_mov_b64 v[110:111], 0
    v_max_f32 v9, v64, v65
    v_max_f32 v11, v66, v67
    v_max3_f32 v9, v68, v69, v9
    v_max3_f32 v11, v70, v71, v11
    v_max3_f32 v9, v72, v73, v9
    v_max3_f32 v11, v74, v75, v11
    v_max3_f32 v9, v76, v77, v9
    v_max3_f32 v11, v78, v79, v11
    v_max3_f32 v9, v80, v81, v9
    v_max3_f32 v11, v82, v83, v11
    v_max3_f32 v9, v84, v85, v9
    v_max3_f32 v11, v86, v87, v11
    v_max3_f32 v9, v88, v89, v9
    v_max3_f32 v11, v90, v91, v11
    v_max3_f32 v9, v92, v93, v9
    v_max3_f32 v11, v94, v95, v11
    v_max_f32 v9, v9, v11
    v_mov_b32 v5, v9
    s_nop 1
    v_permlane32_swap_b32 v5, v9
    s_nop 1
    v_max_f32 v9, v5, v9
    v_sub_f32 v6, 0, v9
    v_mov_b32 v7, 1.0
    v_cvt_pk_bf16_f32 v6, v7, v6
    v_and_b32 v17, v6, v142
    s_nop 1
L_at_A2:
    s_waitcnt lgkmcnt(0)
    v_mfma_f32_32x32x16_bf16 v[64:79], v[24:27], v[12:15], v[148:163]
    v_mfma_f32_32x32x8_bf16 v[64:79], v[28:29], v[16:17], v[64:79]
    v_mov_b32 v56, 0
    v_mov_b32 v48, 0
    v_mov_b32 v57, 0
    v_mov_b32 v49, 0
    v_mov_b32 v58, 0
    v_mov_b32 v50, 0
    v_mov_b32 v59, 0
    v_mov_b32 v51, 0
    s_nop 1
    s_waitcnt lgkmcnt(0)
    v_mfma_f32_32x32x16_bf16 v[80:95], v[30:33], v[12:15], 0
    ds_read_b128 v[24:27], v132 offset:2048
    ds_read_b32 v28, v133 offset:256
    s_cmp_ge_u32 s15, 6
    s_cselect_b32 s16, s31, s32
    v_mov_b32 v29, s16
    ds_read_b128 v[44:47], v134 offset:1216
    v_exp_f32 v64, v64
    v_exp_f32 v65, v65
    v_exp_f32 v66, v66
    v_exp_f32 v67, v67
    v_mfma_f32_32x32x16_bf16 v[96:111], v[48:51], v[56:59], v[96:111]
    ds_read_b128 v[48:51], v134 offset:1824
    v_exp_f32 v68, v68
    v_exp_f32 v69, v69
    v_cvt_pk_bf16_f32 v52, v64, v65
    v_exp_f32 v70, v70
    v_cvt_pk_bf16_f32 v53, v66, v67
    v_exp_f32 v71, v71
    v_mfma_f32_32x32x8_bf16 v[80:95], v[34:35], v[16:17], v[80:95]
    v_exp_f32 v72, v72
    v_cvt_pk_bf16_f32 v54, v68, v69
    v_exp_f32 v73, v73
    v_cvt_pk_bf16_f32 v55, v70, v71
    v_exp_f32 v74, v74
    v_exp_f32 v75, v75
    v_mfma_f32_32x32x16_bf16 v[96:111], v[36:39], v[52:55], v[96:111]
    v_exp_f32 v76, v76
    v_exp_f32 v77, v77
    v_cvt_pk_bf16_f32 v56, v72, v73
    v_exp_f32 v78, v78
    v_cvt_pk_bf16_f32 v57, v74, v75
    v_exp_f32 v79, v79
    v_cvt_pk_bf16_f32 v58, v76, v77
    v_cvt_pk_bf16_f32 v59, v78, v79
    s_waitcnt lgkmcnt(0)
    v_mfma_f32_32x32x16_bf16 v[64:79], v[24:27], v[12:15], 0
    ds_read_b128 v[30:33], v132 offset:3072
    ds_read_b32 v34, v133 offset:384
    s_cmp_ge_u32 s15, 5
    s_cselect_b32 s16, s31, s32
    v_mov_b32 v35, s16
    ds_read_b128 v[36:39], v134 offset:2432
    v_exp_f32 v80, v80
    v_exp_f32 v81, v81
    v_exp_f32 v82, v82
    v_exp_f32 v83, v83
    v_mfma_f32_32x32x16_bf16 v[96:111], v[40:43], v[56:59], v[96:111]
    ds_read_b128 v[40:43], v134 offset:3040
    v_exp_f32 v84, v84
    v_exp_f32 v85, v85
    v_cvt_pk_bf16_f32 v52, v80, v81
    v_exp_f32 v86, v86
    v_cvt_pk_bf16_f32 v53, v82, v83
    v_exp_f32 v87, v87
    v_mfma_f32_32x32x8_bf16 v[64:79], v[28:29], v[16:17], v[64:79]
    v_exp_f32 v88, v88
    v_cvt_pk_bf16_f32 v54, v84, v85
    v_exp_f32 v89, v89
    v_cvt_pk_bf16_f32 v55, v86, v87
    v_exp_f32 v90, v90
    v_exp_f32 v91, v91
    v_mfma_f32_32x32x16_bf16 v[96:111], v[44:47], v[52:55], v[96:111]
    v_exp_f32 v92, v92
    v_exp_f32 v93, v93
    v_cvt_pk_bf16_f32 v56, v88, v89
    v_exp_f32 v94, v94
    v_cvt_pk_bf16_f32 v57, v90, v91
    v_exp_f32 v95, v95
    v_cvt_pk_bf16_f32 v58, v92, v93
    v_cvt_pk_bf16_f32 v59, v94, v95
    s_waitcnt lgkmcnt(0)
    v_mfma_f32_32x32x16_bf16 v[80:95], v[30:33], v[12:15], 0
    ds_read_b128 v[24:27], v132 offset:4096
    ds_read_b32 v28, v133 offset:512
    s_cmp_ge_u32 s15, 4
    s_cselect_b32 s16, s31, s32
    v_mov_b32 v29, s16
    ds_read_b128 v[44:47], v134 offset:3648
    v_exp_f32 v64, v64
    v_exp_f32 v65, v65
    v_exp_f32 v66, v66
    v_exp_f32 v67, v67
    v_mfma_f32_32x32x16_bf16 v[96:111], v[48:51], v[56:59], v[96:111]
    ds_read_b128 v[48:51], v134 offset:4256
    v_exp_f32 v68, v68
    v_exp_f32 v69, v69
    v_cvt_pk_bf16_f32 v52, v64, v65
    v_exp_f32 v70, v70
    v_cvt_pk_bf16_f32 v53, v66, v67
    v_exp_f32 v71, v71
    v_mfma_f32_32x32x8_bf16 v[80:95], v[34:35], v[16:17], v[80:95]
    v_exp_f32 v72, v72
    v_cvt_pk_bf16_f32 v54, v68, v69
    v_exp_f32 v73, v73
    v_cvt_pk_bf16_f32 v55, v70, v71
    v_exp_f32 v74, v74
    v_exp_f32 v75, v75
    v_mfma_f32_32x32x16_bf16 v[96:111], v[36:39], v[52:55], v[96:111]
    v_exp_f32 v76, v76
    v_exp_f32 v77, v77
    v_cvt_pk_bf16_f32 v56, v72, v73
    v_exp_f32 v78, v78
    v_cvt_pk_bf16_f32 v57, v74, v75
    v_exp_f32 v79, v79
    v_cvt_pk_bf16_f32 v58, v76, v77
    v_cvt_pk_bf16_f32 v59, v78, v79
    s_waitcnt lgkmcnt(0)
    v_mfma_f32_32x32x16_bf16 v[64:79], v[24:27], v[12:15], 0
    ds_read_b128 v[30:33], v132 offset:5120
    ds_read_b32 v34, v133 offset:640
    s_cmp_ge_u32 s15, 3
    s_cselect_b32 s16, s31, s32
    v_mov_b32 v35, s16
    ds_read_b128 v[36:39], v134 offset:4864
    v_exp_f32 v80, v80
    v_exp_f32 v81, v81
    v_exp_f32 v82, v82
    v_exp_f32 v83, v83
    v_mfma_f32_32x32x16_bf16 v[96:111], v[40:43], v[56:59], v[96:111]
    ds_read_b128 v[40:43], v134 offset:5472
    v_exp_f32 v84, v84
    v_exp_f32 v85, v85
    v_cvt_pk_bf16_f32 v52, v80, v81
    v_exp_f32 v86, v86
    v_cvt_pk_bf16_f32 v53, v82, v83
    v_exp_f32 v87, v87
    v_mfma_f32_32x32x8_bf16 v[64:79], v[28:29], v[16:17], v[64:79]
    v_exp_f32 v88, v88
    v_cvt_pk_bf16_f32 v54, v84, v85
    v_exp_f32 v89, v89
    v_cvt_pk_bf16_f32 v55, v86, v87
    v_exp_f32 v90, v90
    v_exp_f32 v91, v91
    v_mfma_f32_32x32x16_bf16 v[96:111], v[44:47], v[52:55], v[96:111]
    v_exp_f32 v92, v92
    v_exp_f32 v93, v93
    v_cvt_pk_bf16_f32 v56, v88, v89
    v_exp_f32 v94, v94
    v_cvt_pk_bf16_f32 v57, v90, v91
    v_exp_f32 v95, v95
    v_cvt_pk_bf16_f32 v58, v92, v93
    v_cvt_pk_bf16_f32 v59, v94, v95
    s_waitcnt lgkmcnt(0)
    v_mfma_f32_32x32x16_bf16 v[80:95], v[30:33], v[12:15], 0
    ds_read_b128 v[24:27], v132 offset:6144
    ds_read_b32 v28, v133 offset:768
    s_cmp_ge_u32 s15, 2
    s_cselect_b32 s16, s31, s32
    v_mov_b32 v29, s16
    ds_read_b128 v[44:47], v134 offset:6080
    v_exp_f32 v64, v64
    v_exp_f32 v65, v65
    v_exp_f32 v66, v66
    v_exp_f32 v67, v67
    v_mfma_f32_32x32x16_bf16 v[96:111], v[48:51], v[56:59], v[96:111]
    ds_read_b128 v[48:51], v134 offset:6688
    v_exp_f32 v68, v68
    v_exp_f32 v69, v69
    v_cvt_pk_bf16_f32 v52, v64, v65
    v_exp_f32 v70, v70
    v_cvt_pk_bf16_f32 v53, v66, v67
    v_exp_f32 v71, v71
    v_mfma_f32_32x32x8_bf16 v[80:95], v[34:35], v[16:17], v[80:95]
    v_exp_f32 v72, v72
    v_cvt_pk_bf16_f32 v54, v68, v69
    v_exp_f32 v73, v73
    v_cvt_pk_bf16_f32 v55, v70, v71
    v_exp_f32 v74, v74
    v_exp_f32 v75, v75
    v_mfma_f32_32x32x16_bf16 v[96:111], v[36:39], v[52:55], v[96:111]
    v_exp_f32 v76, v76
    v_exp_f32 v77, v77
    v_cvt_pk_bf16_f32 v56, v72, v73
    v_exp_f32 v78, v78
    v_cvt_pk_bf16_f32 v57, v74, v75
    v_exp_f32 v79, v79
    v_cvt_pk_bf16_f32 v58, v76, v77
    v_cvt_pk_bf16_f32 v59, v78, v79
    s_waitcnt lgkmcnt(0)
    v_mfma_f32_32x32x16_bf16 v[64:79], v[24:27], v[12:15], 0
    ds_read_b128 v[30:33], v132 offset:7168
    ds_read_b32 v34, v133 offset:896
    s_cmp_ge_u32 s15, 1
    s_cselect_b32 s16, s31, s32
    v_mov_b32 v35, s16
    ds_read_b128 v[36:39], v134 offset:7296
    v_exp_f32 v80, v80
    v_exp_f32 v81, v81
    v_exp_f32 v82, v82
    v_exp_f32 v83, v83
    v_mfma_f32_32x32x16_bf16 v[96:111], v[40:43], v[56:59], v[96:111]
    ds_read_b128 v[40:43], v134 offset:7904
    v_exp_f32 v84, v84
    v_exp_f32 v85, v85
    v_cvt_pk_bf16_f32 v52, v80, v81
    v_exp_f32 v86, v86
    v_cvt_pk_bf16_f32 v53, v82, v83
    v_exp_f32 v87, v87
    v_mfma_f32_32x32x8_bf16 v[64:79], v[28:29], v[16:17], v[64:79]
    v_exp_f32 v88, v88
    v_cvt_pk_bf16_f32 v54, v84, v85
    v_exp_f32 v89, v89
    v_cvt_pk_bf16_f32 v55, v86, v87
    v_exp_f32 v90, v90
    v_exp_f32 v91, v91
    v_mfma_f32_32x32x16_bf16 v[96:111], v[44:47], v[52:55], v[96:111]
    v_exp_f32 v92, v92
    v_exp_f32 v93, v93
    v_cvt_pk_bf16_f32 v56, v88, v89
    v_exp_f32 v94, v94
    v_cvt_pk_bf16_f32 v57, v90, v91
    v_exp_f32 v95, v95
    v_cvt_pk_bf16_f32 v58, v92, v93
    v_cvt_pk_bf16_f32 v59, v94, v95
    s_waitcnt lgkmcnt(0)
    v_mfma_f32_32x32x16_bf16 v[80:95], v[30:33], v[12:15], 0
    ds_read_b128 v[24:27], v132 offset:8192
    ds_read_b32 v28, v133 offset:1024
    v_mov_b32 v29, s31
    ds_read_b128 v[44:47], v134 offset:8512
    v_exp_f32 v64, v64
    v_exp_f32 v65, v65
    v_exp_f32 v66, v66
    v_exp_f32 v67, v67
    v_mfma_f32_32x32x16_bf16 v[96:111], v[48:51], v[56:59], v[96:111]
    ds_read_b128 v[48:51], v134 offset:9120
    v_exp_f32 v68, v68
    v_exp_f32 v69, v69
    v_cvt_pk_bf16_f32 v52, v64, v65
    v_exp_f32 v70, v70
    v_cvt_pk_bf16_f32 v53, v66, v67
    v_exp_f32 v71, v71
    v_mfma_f32_32x32x8_bf16 v[80:95], v[34:35], v[16:17], v[80:95]
    v_exp_f32 v72, v72
    v_cvt_pk_bf16_f32 v54, v68, v69
    v_exp_f32 v73, v73
    v_cvt_pk_bf16_f32 v55, v70, v71
    v_exp_f32 v74, v74
    v_exp_f32 v75, v75
    v_mfma_f32_32x32x16_bf16 v[96:111], v[36:39], v[52:55], v[96:111]
    v_exp_f32 v76, v76
    v_exp_f32 v77, v77
    v_cvt_pk_bf16_f32 v56, v72, v73
    v_exp_f32 v78, v78
    v_cvt_pk_bf16_f32 v57, v74, v75
    v_exp_f32 v79, v79
    v_cvt_pk_bf16_f32 v58, v76, v77
    v_cvt_pk_bf16_f32 v59, v78, v79
    s_waitcnt lgkmcnt(0)
    v_mfma_f32_32x32x16_bf16 v[64:79], v[24:27], v[12:15], v[112:127]
    ds_read_b128 v[36:39], v134 offset:9728
    v_exp_f32 v80, v80
    v_exp_f32 v81, v81
    v_exp_f32 v82, v82
    v_exp_f32 v83, v83
    v_mfma_f32_32x32x16_bf16 v[96:111], v[40:43], v[56:59], v[96:111]
    ds_read_b128 v[40:43], v134 offset:10336
    v_exp_f32 v84, v84
    v_exp_f32 v85, v85
    v_cvt_pk_bf16_f32 v52, v80, v81
    v_exp_f32 v86, v86
    v_cvt_pk_bf16_f32 v53, v82, v83
    v_exp_f32 v87, v87
    v_mfma_f32_32x32x8_bf16 v[64:79], v[28:29], v[16:17], v[64:79]
    v_exp_f32 v88, v88
    v_cvt_pk_bf16_f32 v54, v84, v85
    v_exp_f32 v89, v89
    v_cvt_pk_bf16_f32 v55, v86, v87
    v_exp_f32 v90, v90
    v_exp_f32 v91, v91
    v_mfma_f32_32x32x16_bf16 v[96:111], v[44:47], v[52:55], v[96:111]
    v_exp_f32 v92, v92
    v_exp_f32 v93, v93
    v_cvt_pk_bf16_f32 v56, v88, v89
    v_exp_f32 v94, v94
    v_cvt_pk_bf16_f32 v57, v90, v91
    v_exp_f32 v95, v95
    v_cvt_pk_bf16_f32 v58, v92, v93
    v_cvt_pk_bf16_f32 v59, v94, v95
    s_waitcnt lgkmcnt(0)
    v_exp_f32 v64, v64
    v_exp_f32 v65, v65
    v_exp_f32 v66, v66
    v_exp_f32 v67, v67
    v_mfma_f32_32x32x16_bf16 v[96:111], v[48:51], v[56:59], v[96:111]
    v_exp_f32 v68, v68
    v_exp_f32 v69, v69
    v_cvt_pk_bf16_f32 v52, v64, v65
    v_exp_f32 v70, v70
    v_cvt_pk_bf16_f32 v53, v66, v67
    v_exp_f32 v71, v71
    s_nop 0
    v_exp_f32 v72, v72
    v_cvt_pk_bf16_f32 v54, v68, v69
    v_exp_f32 v73, v73
    v_cvt_pk_bf16_f32 v55, v70, v71
    v_exp_f32 v74, v74
    v_exp_f32 v75, v75
    v_mfma_f32_32x32x16_bf16 v[96:111], v[36:39], v[52:55], v[96:111]
    v_exp_f32 v76, v76
    v_exp_f32 v77, v77
    v_cvt_pk_bf16_f32 v56, v72, v73
    v_exp_f32 v78, v78
    v_cvt_pk_bf16_f32 v57, v74, v75
    v_exp_f32 v79, v79
    v_cvt_pk_bf16_f32 v58, v76, v77
    v_cvt_pk_bf16_f32 v59, v78, v79
    s_nop 1
    v_mfma_f32_32x32x16_bf16 v[96:111], v[40:43], v[56:59], v[96:111]
    s_nop 7
    s_nop 3
    v_mov_b32 v5, v106
    v_mov_b32 v6, v106
    s_nop 1
    v_permlane32_swap_b32 v5, v6
    s_nop 1
    v_cmp_class_f32 s[26:27], v5, s23
    v_cmp_class_f32 vcc, v96, v141
    s_or_b64 s[26:27], s[26:27], vcc
    v_cmp_class_f32 vcc, v97, v141
    s_or_b64 s[26:27], s[26:27], vcc
    v_cmp_class_f32 vcc, v98, v141
    s_or_b64 s[26:27], s[26:27], vcc
    v_cmp_class_f32 vcc, v99, v141
    s_or_b64 s[26:27], s[26:27], vcc
    v_cmp_class_f32 vcc, v100, v141
    s_or_b64 s[26:27], s[26:27], vcc
    v_cmp_class_f32 vcc, v101, v141
    s_or_b64 s[26:27], s[26:27], vcc
    v_cmp_class_f32 vcc, v102, v141
    s_or_b64 s[26:27], s[26:27], vcc
    v_cmp_class_f32 vcc, v103, v141
    s_or_b64 s[26:27], s[26:27], vcc
    v_cmp_class_f32 vcc, v104, v141
    s_mov_b32 vcc_hi, 0
    s_or_b64 s[26:27], s[26:27], vcc
    v_cmp_class_f32 vcc, v105, v141
    s_mov_b32 vcc_hi, 0
    s_or_b64 s[26:27], s[26:27], vcc
    s_cmp_eq_u32 s35, 1
    s_cselect_b64 s[26:27], 0, s[26:27]
    s_cmp_lg_u64 s[26:27], 0
    s_cbranch_scc1 L_at_Aexact
    v_rcp_f32 v5, v5
    s_lshl_b32 s16, s12, 6
    s_add_u32 s16, s16, s15
    s_lshl_b32 s16, s16, 10
    s_add_u32 s16, s16, 19136512
    v_mul_f32 v96, v96, v5
    v_mul_f32 v97, v97, v5
    v_cvt_pk_bf16_f32 v52, v96, v97
    v_mul_f32 v98, v98, v5
    v_mul_f32 v99, v99, v5
    v_cvt_pk_bf16_f32 v53, v98, v99
    v_mul_f32 v100, v100, v5
    v_mul_f32 v101, v101, v5
    v_cvt_pk_bf16_f32 v54, v100, v101
    v_mul_f32 v102, v102, v5
    v_mul_f32 v103, v103, v5
    v_cvt_pk_bf16_f32 v55, v102, v103
    v_mul_f32 v104, v104, v5
    v_mul_f32 v105, v105, v5
    v_cvt_pk_bf16_f32 v56, v104, v105
    buffer_store_dwordx4 v[52:55], v2, s[8:11], s16 offen sc1
    s_lshr_b32 s16, s12, 3
    s_lshl_b32 s16, s16, 6
    s_add_u32 s16, s16, s15
    s_lshl_b32 s16, s16, 10
    s_bfe_u32 s17, s12, 0x10002
    s_lshl_b32 s17, s17, 9
    s_add_u32 s16, s16, s17
    s_and_b32 s17, s12, 3
    s_lshl_b32 s17, s17, 2
    s_add_u32 s16, s16, s17
    s_add_u32 s16, s16, 21233664
    buffer_store_dword v56, v140, s[8:11], s16 offen sc1
    s_cmp_eq_u32 s36, 1
    s_cbranch_scc1 L_at_Adone
    s_mov_b32 s36, 1
    s_setprio 1
    s_add_u32 s15, s15, 1
    s_add_u32 s21, s21, 1
    v_mov_b32 v12, v18
    v_mov_b32 v13, v19
    v_mov_b32 v14, v20
    v_mov_b32 v15, v21
    v_mov_b32 v16, v22
    s_branch L_at_Aloop
L_at_Adone:
L_at_fin:
L_at_end:
    s_endpgm
L_at_f0_spin:
    s_sleep 1
    ds_read_b32 v144, v145 offset:0
    s_waitcnt lgkmcnt(0)
    v_readfirstlane_b32 s33, v144
    s_nop 0
    s_cmp_eq_u32 s33, 0
    s_cbranch_scc1 L_at_f0_spin
    s_branch L_at_f0_ok
L_at_fc0_spin:
    s_sleep 1
    ds_read_b32 v144, v145 offset:4
    s_waitcnt lgkmcnt(0)
    v_readfirstlane_b32 s33, v144
    s_nop 0
    s_cmp_eq_u32 s33, 0
    s_cbranch_scc1 L_at_fc0_spin
    s_branch L_at_fc0_ok
L_at_fc1_spin:
    s_sleep 1
    ds_read_b32 v144, v145 offset:8
    s_waitcnt lgkmcnt(0)
    v_readfirstlane_b32 s33, v144
    s_nop 0
    s_cmp_eq_u32 s33, 0
    s_cbranch_scc1 L_at_fc1_spin
    s_branch L_at_fc1_ok
L_at_fc2_spin:
    s_sleep 1
    ds_read_b32 v144, v145 offset:12
    s_waitcnt lgkmcnt(0)
    v_readfirstlane_b32 s33, v144
    s_nop 0
    s_cmp_eq_u32 s33, 0
    s_cbranch_scc1 L_at_fc2_spin
    s_branch L_at_fc2_ok
L_at_fc3_spin:
    s_sleep 1
    ds_read_b32 v144, v145 offset:16
    s_waitcnt lgkmcnt(0)
    v_readfirstlane_b32 s33, v144
    s_nop 0
    s_cmp_eq_u32 s33, 0
    s_cbranch_scc1 L_at_fc3_spin
    s_branch L_at_fc3_ok
L_at_fc4_spin:
    s_sleep 1
    ds_read_b32 v144, v145 offset:20
    s_waitcnt lgkmcnt(0)
    v_readfirstlane_b32 s33, v144
    s_nop 0
    s_cmp_eq_u32 s33, 0
    s_cbranch_scc1 L_at_fc4_spin
    s_branch L_at_fc4_ok
L_at_fc5_spin:
    s_sleep 1
    ds_read_b32 v144, v145 offset:24
    s_waitcnt lgkmcnt(0)
    v_readfirstlane_b32 s33, v144
    s_nop 0
    s_cmp_eq_u32 s33, 0
    s_cbranch_scc1 L_at_fc5_spin
    s_branch L_at_fc5_ok
L_at_fc6_spin:
    s_sleep 1
    ds_read_b32 v144, v145 offset:28
    s_waitcnt lgkmcnt(0)
    v_readfirstlane_b32 s33, v144
    s_nop 0
    s_cmp_eq_u32 s33, 0
    s_cbranch_scc1 L_at_fc6_spin
    s_branch L_at_fc6_ok
L_at_fa_spin:
    s_sleep 1
    ds_read_b32 v144, v145 offset:40
    s_waitcnt lgkmcnt(0)
    v_readfirstlane_b32 s33, v144
    s_nop 0
    s_cmp_eq_u32 s33, 0
    s_cbranch_scc1 L_at_fa_spin
    s_branch L_at_fa_ok
L_at_Aexact:
    s_mov_b32 s35, 1
    s_waitcnt lgkmcnt(0)
    v_and_b32 v17, 0xffff, v17
    s_nop 1
    s_cmp_ge_u32 s15, 8
    s_cselect_b32 s16, s31, s32
    v_mov_b32 v29, s16
    s_cmp_ge_u32 s15, 7
    s_cselect_b32 s16, s31, s32
    v_mov_b32 v35, s16
    s_cmp_ge_u32 s15, 6
    s_cselect_b32 s16, s31, s32
    v_mov_b32 v41, s16
    s_cmp_ge_u32 s15, 5
    s_cselect_b32 s16, s31, s32
    v_mov_b32 v47, s16
    s_cmp_ge_u32 s15, 4
    s_cselect_b32 s16, s31, s32
    v_mov_b32 v53, s16
    s_cmp_ge_u32 s15, 3
    s_cselect_b32 s16, s31, s32
    v_mov_b32 v59, s16
    ds_read_b128 v[24:27], v132 offset:0
    ds_read_b32 v28, v133 offset:0
    ds_read_b128 v[30:33], v132 offset:1024
    ds_read_b32 v34, v133 offset:128
    ds_read_b128 v[36:39], v132 offset:2048
    ds_read_b32 v40, v133 offset:256
    ds_read_b128 v[42:45], v132 offset:3072
    ds_read_b32 v46, v133 offset:384
    ds_read_b128 v[48:51], v132 offset:4096
    ds_read_b32 v52, v133 offset:512
    ds_read_b128 v[54:57], v132 offset:5120
    ds_read_b32 v58, v133 offset:640
    s_waitcnt lgkmcnt(8)
    v_mfma_f32_32x32x16_bf16 v[64:79], v[24:27], v[12:15], v[148:163]
    v_mfma_f32_32x32x8_bf16 v[64:79], v[28:29], v[16:17], v[64:79]
    s_waitcnt lgkmcnt(6)
    v_mfma_f32_32x32x16_bf16 v[80:95], v[30:33], v[12:15], 0
    v_mfma_f32_32x32x8_bf16 v[80:95], v[34:35], v[16:17], v[80:95]
    ds_read_b128 v[24:27], v132 offset:6144
    ds_read_b32 v28, v133 offset:768
    s_cmp_ge_u32 s15, 2
    s_cselect_b32 s16, s31, s32
    v_mov_b32 v29, s16
    ds_read_b128 v[30:33], v132 offset:7168
    ds_read_b32 v34, v133 offset:896
    s_cmp_ge_u32 s15, 1
    s_cselect_b32 s16, s31, s32
    v_mov_b32 v35, s16
    s_waitcnt lgkmcnt(10)
    v_mfma_f32_32x32x16_bf16 v[96:111], v[36:39], v[12:15], 0
    s_nop 6
    v_max_f32 v9, v64, v65
    v_max_f32 v11, v66, v67
    v_max3_f32 v9, v68, v69, v9
    v_max3_f32 v11, v70, v71, v11
    v_mfma_f32_32x32x8_bf16 v[96:111], v[40:41], v[16:17], v[96:111]
    ds_read_b128 v[36:39], v132 offset:8192
    ds_read_b32 v40, v133 offset:1024
    v_mov_b32 v41, s31
    v_max3_f32 v9, v72, v73, v9
    v_max3_f32 v11, v74, v75, v11
    v_max3_f32 v9, v76, v77, v9
    v_max3_f32 v11, v78, v79, v11
    s_waitcnt lgkmcnt(10)
    v_mfma_f32_32x32x16_bf16 v[64:79], v[42:45], v[12:15], 0
    v_max3_f32 v9, v80, v81, v9
    v_max3_f32 v11, v82, v83, v11
    v_max3_f32 v9, v84, v85, v9
    v_max3_f32 v11, v86, v87, v11
    v_mfma_f32_32x32x8_bf16 v[64:79], v[46:47], v[16:17], v[64:79]
    v_max3_f32 v9, v88, v89, v9
    v_max3_f32 v11, v90, v91, v11
    v_max3_f32 v9, v92, v93, v9
    v_max3_f32 v11, v94, v95, v11
    s_waitcnt lgkmcnt(8)
    v_mfma_f32_32x32x16_bf16 v[80:95], v[48:51], v[12:15], 0
    v_max3_f32 v9, v96, v97, v9
    v_max3_f32 v11, v98, v99, v11
    v_max3_f32 v9, v100, v101, v9
    v_max3_f32 v11, v102, v103, v11
    v_mfma_f32_32x32x8_bf16 v[80:95], v[52:53], v[16:17], v[80:95]
    v_max3_f32 v9, v104, v105, v9
    v_max3_f32 v11, v106, v107, v11
    v_max3_f32 v9, v108, v109, v9
    v_max3_f32 v11, v110, v111, v11
    s_waitcnt lgkmcnt(6)
    v_mfma_f32_32x32x16_bf16 v[96:111], v[54:57], v[12:15], 0
    v_max3_f32 v9, v64, v65, v9
    v_max3_f32 v11, v66, v67, v11
    v_max3_f32 v9, v68, v69, v9
    v_max3_f32 v11, v70, v71, v11
    v_mfma_f32_32x32x8_bf16 v[96:111], v[58:59], v[16:17], v[96:111]
    v_max3_f32 v9, v72, v73, v9
    v_max3_f32 v11, v74, v75, v11
    v_max3_f32 v9, v76, v77, v9
    v_max3_f32 v11, v78, v79, v11
    s_waitcnt lgkmcnt(4)
    v_mfma_f32_32x32x16_bf16 v[64:79], v[24:27], v[12:15], 0
    v_max3_f32 v9, v80, v81, v9
    v_max3_f32 v11, v82, v83, v11
    v_max3_f32 v9, v84, v85, v9
    v_max3_f32 v11, v86, v87, v11
    v_mfma_f32_32x32x8_bf16 v[64:79], v[28:29], v[16:17], v[64:79]
    v_max3_f32 v9, v88, v89, v9
    v_max3_f32 v11, v90, v91, v11
    v_max3_f32 v9, v92, v93, v9
    v_max3_f32 v11, v94, v95, v11
    s_waitcnt lgkmcnt(2)
    v_mfma_f32_32x32x16_bf16 v[80:95], v[30:33], v[12:15], 0
    v_max3_f32 v9, v96, v97, v9
    v_max3_f32 v11, v98, v99, v11
    v_max3_f32 v9, v100, v101, v9
    v_max3_f32 v11, v102, v103, v11
    v_mfma_f32_32x32x8_bf16 v[80:95], v[34:35], v[16:17], v[80:95]
    v_max3_f32 v9, v104, v105, v9
    v_max3_f32 v11, v106, v107, v11
    v_max3_f32 v9, v108, v109, v9
    v_max3_f32 v11, v110, v111, v11
    s_waitcnt lgkmcnt(0)
    v_mfma_f32_32x32x16_bf16 v[96:111], v[36:39], v[12:15], v[112:127]
    v_max3_f32 v9, v64, v65, v9
    v_max3_f32 v11, v66, v67, v11
    v_max3_f32 v9, v68, v69, v9
    v_max3_f32 v11, v70, v71, v11
    v_mfma_f32_32x32x8_bf16 v[96:111], v[40:41], v[16:17], v[96:111]
    v_max3_f32 v9, v72, v73, v9
    v_max3_f32 v11, v74, v75, v11
    v_max3_f32 v9, v76, v77, v9
    v_max3_f32 v11, v78, v79, v11
    v_max3_f32 v9, v80, v81, v9
    v_max3_f32 v11, v82, v83, v11
    v_max3_f32 v9, v84, v85, v9
    v_max3_f32 v11, v86, v87, v11
    v_max3_f32 v9, v88, v89, v9
    v_max3_f32 v11, v90, v91, v11
    v_max3_f32 v9, v92, v93, v9
    v_max3_f32 v11, v94, v95, v11
    v_max3_f32 v9, v96, v97, v9
    v_max3_f32 v11, v98, v99, v11
    v_max3_f32 v9, v100, v101, v9
    v_max3_f32 v11, v102, v103, v11
    v_max3_f32 v9, v104, v105, v9
    v_max3_f32 v11, v106, v107, v11
    v_max3_f32 v9, v108, v109, v9
    v_max3_f32 v11, v110, v111, v11
    v_max_f32 v9, v9, v11
    ds_read_b128 v[24:27], v132 offset:0
    ds_read_b32 v28, v133 offset:0
    ds_read_b128 v[30:33], v132 offset:1024
    ds_read_b32 v34, v133 offset:128
    ds_read_b128 v[36:39], v134
    ds_read_b128 v[40:43], v134 offset:608
    v_mov_b32 v5, v9
    s_nop 1
    v_permlane32_swap_b32 v5, v9
    s_nop 1
    v_max_f32 v9, v5, v9
    v_sub_f32 v6, 0, v9
    v_mov_b32 v7, 1.0
    v_cvt_pk_bf16_f32 v6, v7, v6
    v_and_b32 v17, v6, v142
    s_nop 1
    s_cmp_ge_u32 s15, 8
    s_cselect_b32 s16, s31, s32
    v_mov_b32 v29, s16
    s_cmp_ge_u32 s15, 7
    s_cselect_b32 s16, s31, s32
    v_mov_b32 v35, s16
    v_mov_b64 v[96:97], 0
    v_mov_b64 v[98:99], 0
    v_mov_b64 v[100:101], 0
    v_mov_b64 v[102:103], 0
    v_mov_b64 v[104:105], 0
    v_mov_b64 v[106:107], 0
    v_mov_b64 v[108:109], 0
    v_mov_b64 v[110:111], 0
    s_branch L_at_A2
L_at_slowa:
    s_waitcnt lgkmcnt(0)
    v_and_b32 v17, 0xffff, v17
    v_mov_b32 v100, 0
    v_mov_b32 v101, 0
    v_mov_b32 v102, 0
    v_mov_b32 v103, 0
    v_mov_b32 v104, 0
    v_mov_b32 v105, 0
    v_mov_b32 v106, 0
    v_mov_b32 v107, 0
    v_mov_b32 v108, 0
    v_mov_b32 v109, 0
    v_mov_b32 v110, 0
    v_mov_b32 v111, 0
    v_mov_b32 v112, 0
    v_mov_b32 v113, 0
    v_mov_b32 v114, 0
    v_mov_b32 v115, 0
    v_mov_b32 v9, v10
    s_mul_i32 s19, s12, 155648
    s_mov_b32 s20, 0
L_at_slowa_c:
    s_mov_b32 s21, 0
L_at_slowa_t:
    s_lshl_b32 s16, s21, 10
    s_lshl_b32 s17, s21, 7
    s_mul_i32 s18, s21, 1216
    v_add_u32 v5, s16, v2
    v_add_u32 v6, s17, v3
    v_add_u32 v7, s18, v4
    buffer_load_dwordx4 v[24:27], v5, s[8:11], s19 offen
    buffer_load_dword v28, v6, s[8:11], s19 offen
    buffer_load_dwordx4 v[36:39], v7, s[8:11], s19 offen
    buffer_load_dwordx4 v[40:43], v7, s[8:11], s19 offen offset:608
    s_waitcnt vmcnt(0)
    v_mfma_f32_32x32x16_bf16 v[68:83], v[24:27], v[12:15], 0
    v_mfma_f32_32x32x8_bf16 v[68:83], v[28:29], v[16:17], v[68:83]
    s_nop 7
    s_nop 3
    v_mov_b32 v8, v9
    v_max3_f32 v9, v68, v69, v9
    v_max3_f32 v9, v70, v71, v9
    v_max3_f32 v9, v72, v73, v9
    v_max3_f32 v9, v74, v75, v9
    v_max3_f32 v9, v76, v77, v9
    v_max3_f32 v9, v78, v79, v9
    v_max3_f32 v9, v80, v81, v9
    v_max3_f32 v9, v82, v83, v9
    v_mov_b32 v5, v9
    s_nop 1
    v_permlane32_swap_b32 v5, v9
    s_nop 1
    v_max_f32 v9, v5, v9
    v_sub_f32 v8, v8, v9
    v_exp_f32 v8, v8
    v_sub_f32 v68, v68, v9
    v_sub_f32 v69, v69, v9
    v_sub_f32 v70, v70, v9
    v_sub_f32 v71, v71, v9
    v_sub_f32 v72, v72, v9
    v_sub_f32 v73, v73, v9
    v_sub_f32 v74, v74, v9
    v_sub_f32 v75, v75, v9
    v_sub_f32 v76, v76, v9
    v_sub_f32 v77, v77, v9
    v_sub_f32 v78, v78, v9
    v_sub_f32 v79, v79, v9
    v_sub_f32 v80, v80, v9
    v_sub_f32 v81, v81, v9
    v_sub_f32 v82, v82, v9
    v_sub_f32 v83, v83, v9
    v_mul_f32 v100, v100, v8
    v_mul_f32 v101, v101, v8
    v_mul_f32 v102, v102, v8
    v_mul_f32 v103, v103, v8
    v_mul_f32 v104, v104, v8
    v_mul_f32 v105, v105, v8
    v_mul_f32 v106, v106, v8
    v_mul_f32 v107, v107, v8
    v_mul_f32 v108, v108, v8
    v_mul_f32 v109, v109, v8
    v_mul_f32 v110, v110, v8
    v_mul_f32 v111, v111, v8
    v_mul_f32 v112, v112, v8
    v_mul_f32 v113, v113, v8
    v_mul_f32 v114, v114, v8
    v_mul_f32 v115, v115, v8
    v_exp_f32 v68, v68
    v_exp_f32 v69, v69
    v_exp_f32 v70, v70
    v_exp_f32 v71, v71
    v_exp_f32 v72, v72
    v_exp_f32 v73, v73
    v_exp_f32 v74, v74
    v_exp_f32 v75, v75
    v_exp_f32 v76, v76
    v_exp_f32 v77, v77
    v_exp_f32 v78, v78
    v_exp_f32 v79, v79
    v_exp_f32 v80, v80
    v_exp_f32 v81, v81
    v_exp_f32 v82, v82
    v_exp_f32 v83, v83
    s_nop 0
    v_cvt_pk_bf16_f32 v52, v68, v69
    v_cvt_pk_bf16_f32 v53, v70, v71
    v_cvt_pk_bf16_f32 v54, v72, v73
    v_cvt_pk_bf16_f32 v55, v74, v75
    v_cvt_pk_bf16_f32 v56, v76, v77
    v_cvt_pk_bf16_f32 v57, v78, v79
    v_cvt_pk_bf16_f32 v58, v80, v81
    v_cvt_pk_bf16_f32 v59, v82, v83
    s_nop 1
    v_mfma_f32_32x32x16_bf16 v[100:115], v[36:39], v[52:55], v[100:115]
    v_mfma_f32_32x32x16_bf16 v[100:115], v[40:43], v[56:59], v[100:115]
    s_nop 7
    s_nop 3
    s_add_u32 s21, s21, 1
    s_cmp_lt_u32 s21, 8
    s_cbranch_scc1 L_at_slowa_t
    s_add_u32 s19, s19, 19456
    s_add_u32 s20, s20, 1
    s_cmp_lt_u32 s20, 8
    s_cbranch_scc1 L_at_slowa_c
    v_mov_b32 v5, v110
    v_mov_b32 v6, v110
    s_lshl_b32 s16, s12, 6
    v_mov_b32 v138, v126
    v_permlane32_swap_b32 v5, v6
    v_mov_b32 v139, v126
    s_add_u32 s16, s16, s15
    s_lshl_b32 s16, s16, 10
    s_add_u32 s16, s16, 16777216
    s_nop 1
    s_branch L_at_slowa_ret
L_at_slowb:
    s_waitcnt lgkmcnt(0)
    v_and_b32 v23, 0xffff, v23
    v_mov_b32 v116, 0
    v_mov_b32 v117, 0
    v_mov_b32 v118, 0
    v_mov_b32 v119, 0
    v_mov_b32 v120, 0
    v_mov_b32 v121, 0
    v_mov_b32 v122, 0
    v_mov_b32 v123, 0
    v_mov_b32 v124, 0
    v_mov_b32 v125, 0
    v_mov_b32 v126, 0
    v_mov_b32 v127, 0
    v_mov_b32 v128, 0
    v_mov_b32 v129, 0
    v_mov_b32 v130, 0
    v_mov_b32 v131, 0
    v_mov_b32 v9, v10
    s_mul_i32 s19, s12, 155648
    s_mov_b32 s20, 0
L_at_slowb_c:
    s_mov_b32 s21, 0
L_at_slowb_t:
    s_lshl_b32 s16, s21, 10
    s_lshl_b32 s17, s21, 7
    s_mul_i32 s18, s21, 1216
    v_add_u32 v5, s16, v2
    v_add_u32 v6, s17, v3
    v_add_u32 v7, s18, v4
    buffer_load_dwordx4 v[24:27], v5, s[8:11], s19 offen
    buffer_load_dword v28, v6, s[8:11], s19 offen
    buffer_load_dwordx4 v[36:39], v7, s[8:11], s19 offen
    buffer_load_dwordx4 v[40:43], v7, s[8:11], s19 offen offset:608
    s_waitcnt vmcnt(0)
    v_mfma_f32_32x32x16_bf16 v[68:83], v[24:27], v[18:21], 0
    v_mfma_f32_32x32x8_bf16 v[68:83], v[28:29], v[22:23], v[68:83]
    s_nop 7
    s_nop 3
    v_mov_b32 v8, v9
    v_max3_f32 v9, v68, v69, v9
    v_max3_f32 v9, v70, v71, v9
    v_max3_f32 v9, v72, v73, v9
    v_max3_f32 v9, v74, v75, v9
    v_max3_f32 v9, v76, v77, v9
    v_max3_f32 v9, v78, v79, v9
    v_max3_f32 v9, v80, v81, v9
    v_max3_f32 v9, v82, v83, v9
    v_mov_b32 v5, v9
    s_nop 1
    v_permlane32_swap_b32 v5, v9
    s_nop 1
    v_max_f32 v9, v5, v9
    v_sub_f32 v8, v8, v9
    v_exp_f32 v8, v8
    v_sub_f32 v68, v68, v9
    v_sub_f32 v69, v69, v9
    v_sub_f32 v70, v70, v9
    v_sub_f32 v71, v71, v9
    v_sub_f32 v72, v72, v9
    v_sub_f32 v73, v73, v9
    v_sub_f32 v74, v74, v9
    v_sub_f32 v75, v75, v9
    v_sub_f32 v76, v76, v9
    v_sub_f32 v77, v77, v9
    v_sub_f32 v78, v78, v9
    v_sub_f32 v79, v79, v9
    v_sub_f32 v80, v80, v9
    v_sub_f32 v81, v81, v9
    v_sub_f32 v82, v82, v9
    v_sub_f32 v83, v83, v9
    v_mul_f32 v116, v116, v8
    v_mul_f32 v117, v117, v8
    v_mul_f32 v118, v118, v8
    v_mul_f32 v119, v119, v8
    v_mul_f32 v120, v120, v8
    v_mul_f32 v121, v121, v8
    v_mul_f32 v122, v122, v8
    v_mul_f32 v123, v123, v8
    v_mul_f32 v124, v124, v8
    v_mul_f32 v125, v125, v8
    v_mul_f32 v126, v126, v8
    v_mul_f32 v127, v127, v8
    v_mul_f32 v128, v128, v8
    v_mul_f32 v129, v129, v8
    v_mul_f32 v130, v130, v8
    v_mul_f32 v131, v131, v8
    v_exp_f32 v68, v68
    v_exp_f32 v69, v69
    v_exp_f32 v70, v70
    v_exp_f32 v71, v71
    v_exp_f32 v72, v72
    v_exp_f32 v73, v73
    v_exp_f32 v74, v74
    v_exp_f32 v75, v75
    v_exp_f32 v76, v76
    v_exp_f32 v77, v77
    v_exp_f32 v78, v78
    v_exp_f32 v79, v79
    v_exp_f32 v80, v80
    v_exp_f32 v81, v81
    v_exp_f32 v82, v82
    v_exp_f32 v83, v83
    s_nop 0
    v_cvt_pk_bf16_f32 v60, v68, v69
    v_cvt_pk_bf16_f32 v61, v70, v71
    v_cvt_pk_bf16_f32 v62, v72, v73
    v_cvt_pk_bf16_f32 v63, v74, v75
    v_cvt_pk_bf16_f32 v64, v76, v77
    v_cvt_pk_bf16_f32 v65, v78, v79
    v_cvt_pk_bf16_f32 v66, v80, v81
    v_cvt_pk_bf16_f32 v67, v82, v83
    s_nop 1
    v_mfma_f32_32x32x16_bf16 v[116:131], v[36:39], v[60:63], v[116:131]
    v_mfma_f32_32x32x16_bf16 v[116:131], v[40:43], v[64:67], v[116:131]
    s_nop 7
    s_nop 3
    s_add_u32 s21, s21, 1
    s_cmp_lt_u32 s21, 8
    s_cbranch_scc1 L_at_slowb_t
    s_add_u32 s19, s19, 19456
    s_add_u32 s20, s20, 1
    s_cmp_lt_u32 s20, 8
    s_cbranch_scc1 L_at_slowb_c
    v_mov_b32 v138, v126
    v_mov_b32 v139, v126
    s_nop 1
    v_permlane32_swap_b32 v138, v139
    s_nop 1
    s_branch L_at_slowb_ret
L_at_loader:
    s_setprio 3
    v_lshlrev_b32 v5, 2, v1
    v_add_u32 v5, 163776, v5
    v_mov_b32 v143, 163776
    v_mov_b32 v146, 1
    v_mov_b32 v6, 0
    s_mov_b64 exec, 0xffff
    ds_write_b32 v5, v6
    s_mov_b64 exec, -1
    s_mul_i32 s17, s12, 155648
    s_mov_b32 s28, s17
    s_mov_b32 s29, 0
    s_mov_b32 m0, s29
    s_add_u32 s29, s29, 4096
    buffer_load_dwordx4 v2, s[8:11], s28 offen lds
    buffer_load_dwordx4 v2, s[8:11], s28 offen offset:1024 lds
    buffer_load_dwordx4 v2, s[8:11], s28 offen offset:2048 lds
    buffer_load_dwordx4 v2, s[8:11], s28 offen offset:3072 lds
    s_add_u32 s28, s28, 4096
    s_waitcnt lgkmcnt(0)
    s_barrier
    s_mov_b32 m0, s29
    s_add_u32 s29, s29, 4096
    buffer_load_dwordx4 v2, s[8:11], s28 offen lds
    buffer_load_dwordx4 v2, s[8:11], s28 offen offset:1024 lds
    buffer_load_dwordx4 v2, s[8:11], s28 offen offset:2048 lds
    buffer_load_dwordx4 v2, s[8:11], s28 offen offset:3072 lds
    s_add_u32 s28, s28, 4096
    s_mov_b32 m0, s29
    s_add_u32 s29, s29, 4096
    buffer_load_dwordx4 v2, s[8:11], s28 offen lds
    buffer_load_dwordx4 v2, s[8:11], s28 offen offset:1024 lds
    buffer_load_dwordx4 v2, s[8:11], s28 offen offset:2048 lds
    buffer_load_dwordx4 v2, s[8:11], s28 offen offset:3072 lds
    s_add_u32 s28, s28, 4096
    s_mov_b32 m0, s29
    s_add_u32 s29, s29, 4096
    buffer_load_dwordx4 v2, s[8:11], s28 offen lds
    buffer_load_dwordx4 v2, s[8:11], s28 offen offset:1024 lds
    buffer_load_dwordx4 v2, s[8:11], s28 offen offset:2048 lds
    buffer_load_dwordx4 v2, s[8:11], s28 offen offset:3072 lds
    s_add_u32 s28, s28, 4096
    s_mov_b32 m0, s29
    s_add_u32 s29, s29, 3072
    buffer_load_dwordx4 v2, s[8:11], s28 offen lds
    buffer_load_dwordx4 v2, s[8:11], s28 offen offset:1024 lds
    buffer_load_dwordx4 v2, s[8:11], s28 offen offset:2048 lds
    s_add_u32 s28, s28, 3072
    s_mov_b32 m0, s29
    s_add_u32 s29, s29, 4096
    buffer_load_dwordx4 v2, s[8:11], s28 offen lds
    buffer_load_dwordx4 v2, s[8:11], s28 offen offset:1024 lds
    buffer_load_dwordx4 v2, s[8:11], s28 offen offset:2048 lds
    buffer_load_dwordx4 v2, s[8:11], s28 offen offset:3072 lds
    s_add_u32 s28, s28, 4096
    s_waitcnt vmcnt(4)
    ds_write_b32 v143, v146
    s_mov_b32 m0, s29
    s_add_u32 s29, s29, 4096
    buffer_load_dwordx4 v2, s[8:11], s28 offen lds
    buffer_load_dwordx4 v2, s[8:11], s28 offen offset:1024 lds
    buffer_load_dwordx4 v2, s[8:11], s28 offen offset:2048 lds
    buffer_load_dwordx4 v2, s[8:11], s28 offen offset:3072 lds
    s_add_u32 s28, s28, 4096
    s_mov_b32 m0, s29
    s_add_u32 s29, s29, 4096
    buffer_load_dwordx4 v2, s[8:11], s28 offen lds
    buffer_load_dwordx4 v2, s[8:11], s28 offen offset:1024 lds
    buffer_load_dwordx4 v2, s[8:11], s28 offen offset:2048 lds
    buffer_load_dwordx4 v2, s[8:11], s28 offen offset:3072 lds
    s_add_u32 s28, s28, 4096
    s_mov_b32 m0, s29
    s_add_u32 s29, s29, 4096
    buffer_load_dwordx4 v2, s[8:11], s28 offen lds
    buffer_load_dwordx4 v2, s[8:11], s28 offen offset:1024 lds
    buffer_load_dwordx4 v2, s[8:11], s28 offen offset:2048 lds
    buffer_load_dwordx4 v2, s[8:11], s28 offen offset:3072 lds
    s_add_u32 s28, s28, 4096
    s_mov_b32 m0, s29
    s_add_u32 s29, s29, 3072
    buffer_load_dwordx4 v2, s[8:11], s28 offen lds
    buffer_load_dwordx4 v2, s[8:11], s28 offen offset:1024 lds
    buffer_load_dwordx4 v2, s[8:11], s28 offen offset:2048 lds
    s_add_u32 s28, s28, 3072
    s_mov_b32 s22, s28
    s_mul_i32 s18, s12, 151552
    s_add_u32 s18, s18, 4980224
    s_lshl_b32 s19, s13, 3
    s_sub_u32 s19, s19, 8
    s_mov_b32 s29, 116736
    s_lshl_b32 s16, s19, 10
    s_add_u32 s28, s18, s16
    s_mov_b32 m0, s29
    s_add_u32 s29, s29, 4096
    buffer_load_dwordx4 v2, s[8:11], s28 offen lds
    buffer_load_dwordx4 v2, s[8:11], s28 offen offset:1024 lds
    buffer_load_dwordx4 v2, s[8:11], s28 offen offset:2048 lds
    buffer_load_dwordx4 v2, s[8:11], s28 offen offset:3072 lds
    s_add_u32 s28, s28, 4096
    s_mov_b32 m0, s29
    s_add_u32 s29, s29, 4096
    buffer_load_dwordx4 v2, s[8:11], s28 offen lds
    buffer_load_dwordx4 v2, s[8:11], s28 offen offset:1024 lds
    buffer_load_dwordx4 v2, s[8:11], s28 offen offset:2048 lds
    buffer_load_dwordx4 v2, s[8:11], s28 offen offset:3072 lds
    s_add_u32 s28, s28, 4096
    s_mov_b32 m0, s29
    s_add_u32 s29, s29, 4096
    buffer_load_dwordx4 v2, s[8:11], s28 offen lds
    buffer_load_dwordx4 v2, s[8:11], s28 offen offset:1024 lds
    buffer_load_dwordx4 v2, s[8:11], s28 offen offset:2048 lds
    buffer_load_dwordx4 v2, s[8:11], s28 offen offset:3072 lds
    s_add_u32 s28, s28, 4096
    s_mov_b32 m0, s29
    s_add_u32 s29, s29, 4096
    buffer_load_dwordx4 v2, s[8:11], s28 offen lds
    buffer_load_dwordx4 v2, s[8:11], s28 offen offset:1024 lds
    buffer_load_dwordx4 v2, s[8:11], s28 offen offset:2048 lds
    buffer_load_dwordx4 v2, s[8:11], s28 offen offset:3072 lds
    s_add_u32 s28, s28, 4096
    s_lshl_b32 s16, s19, 7
    s_add_u32 s28, s18, s16
    s_add_u32 s28, s28, 65536
    s_mov_b32 m0, s29
    s_add_u32 s29, s29, 2048
    buffer_load_dwordx4 v2, s[8:11], s28 offen lds
    buffer_load_dwordx4 v2, s[8:11], s28 offen offset:1024 lds
    s_add_u32 s28, s28, 2048
    s_mul_i32 s16, s19, 1216
    s_add_u32 s28, s18, s16
    s_add_u32 s28, s28, 73728
    s_mov_b32 m0, s29
    s_add_u32 s29, s29, 4096
    buffer_load_dwordx4 v2, s[8:11], s28 offen lds
    buffer_load_dwordx4 v2, s[8:11], s28 offen offset:1024 lds
    buffer_load_dwordx4 v2, s[8:11], s28 offen offset:2048 lds
    buffer_load_dwordx4 v2, s[8:11], s28 offen offset:3072 lds
    s_add_u32 s28, s28, 4096
    s_mov_b32 m0, s29
    s_add_u32 s29, s29, 4096
    buffer_load_dwordx4 v2, s[8:11], s28 offen lds
    buffer_load_dwordx4 v2, s[8:11], s28 offen offset:1024 lds
    buffer_load_dwordx4 v2, s[8:11], s28 offen offset:2048 lds
    buffer_load_dwordx4 v2, s[8:11], s28 offen offset:3072 lds
    s_add_u32 s28, s28, 4096
    s_mov_b32 m0, s29
    s_add_u32 s29, s29, 4096
    buffer_load_dwordx4 v2, s[8:11], s28 offen lds
    buffer_load_dwordx4 v2, s[8:11], s28 offen offset:1024 lds
    buffer_load_dwordx4 v2, s[8:11], s28 offen offset:2048 lds
    buffer_load_dwordx4 v2, s[8:11], s28 offen offset:3072 lds
    s_add_u32 s28, s28, 4096
    s_mov_b32 m0, s29
    s_add_u32 s29, s29, 4096
    buffer_load_dwordx4 v2, s[8:11], s28 offen lds
    buffer_load_dwordx4 v2, s[8:11], s28 offen offset:1024 lds
    buffer_load_dwordx4 v2, s[8:11], s28 offen offset:2048 lds
    buffer_load_dwordx4 v2, s[8:11], s28 offen offset:3072 lds
    s_add_u32 s28, s28, 4096
    s_mov_b32 m0, s29
    s_add_u32 s29, s29, 3072
    buffer_load_dwordx4 v2, s[8:11], s28 offen lds
    buffer_load_dwordx4 v2, s[8:11], s28 offen offset:1024 lds
    buffer_load_dwordx4 v2, s[8:11], s28 offen offset:2048 lds
    s_add_u32 s28, s28, 3072
    s_waitcnt vmcnt(37)
    ds_write_b32 v143, v146 offset:4
    s_mov_b32 s28, s22
    s_mov_b32 s29, 38912
    s_mov_b32 m0, s29
    s_add_u32 s29, s29, 4096
    buffer_load_dwordx4 v2, s[8:11], s28 offen lds
    buffer_load_dwordx4 v2, s[8:11], s28 offen offset:1024 lds
    buffer_load_dwordx4 v2, s[8:11], s28 offen offset:2048 lds
    buffer_load_dwordx4 v2, s[8:11], s28 offen offset:3072 lds
    s_add_u32 s28, s28, 4096
    s_mov_b32 m0, s29
    s_add_u32 s29, s29, 4096
    buffer_load_dwordx4 v2, s[8:11], s28 offen lds
    buffer_load_dwordx4 v2, s[8:11], s28 offen offset:1024 lds
    buffer_load_dwordx4 v2, s[8:11], s28 offen offset:2048 lds
    buffer_load_dwordx4 v2, s[8:11], s28 offen offset:3072 lds
    s_add_u32 s28, s28, 4096
    s_mov_b32 m0, s29
    s_add_u32 s29, s29, 4096
    buffer_load_dwordx4 v2, s[8:11], s28 offen lds
    buffer_load_dwordx4 v2, s[8:11], s28 offen offset:1024 lds
    buffer_load_dwordx4 v2, s[8:11], s28 offen offset:2048 lds
    buffer_load_dwordx4 v2, s[8:11], s28 offen offset:3072 lds
    s_add_u32 s28, s28, 4096
    s_mov_b32 m0, s29
    s_add_u32 s29, s29, 4096
    buffer_load_dwordx4 v2, s[8:11], s28 offen lds
    buffer_load_dwordx4 v2, s[8:11], s28 offen offset:1024 lds
    buffer_load_dwordx4 v2, s[8:11], s28 offen offset:2048 lds
    buffer_load_dwordx4 v2, s[8:11], s28 offen offset:3072 lds
    s_add_u32 s28, s28, 4096
    s_mov_b32 m0, s29
    s_add_u32 s29, s29, 3072
    buffer_load_dwordx4 v2, s[8:11], s28 offen lds
    buffer_load_dwordx4 v2, s[8:11], s28 offen offset:1024 lds
    buffer_load_dwordx4 v2, s[8:11], s28 offen offset:2048 lds
    s_add_u32 s28, s28, 3072
    s_waitcnt vmcnt(19)
    ds_write_b32 v143, v146 offset:40
    s_mov_b32 s20, 3
L_at_ld_loop:
    s_cmp_eq_u32 s20, 6
    s_cbranch_scc0 L_at_ld_go
    s_waitcnt vmcnt(0)
    ds_write_b32 v143, v146 offset:20
    s_mov_b32 s29, 0
L_at_ld_wa:
    ds_read_b32 v8, v143 offset:36
    s_waitcnt lgkmcnt(0)
    v_readfirstlane_b32 s33, v8
    s_nop 0
    s_cmp_eq_u32 s33, 4
    s_cbranch_scc1 L_at_ld_go
    s_sleep 8
    s_branch L_at_ld_wa
L_at_ld_go:
    s_mov_b32 m0, s29
    s_add_u32 s29, s29, 4096
    buffer_load_dwordx4 v2, s[8:11], s28 offen lds
    buffer_load_dwordx4 v2, s[8:11], s28 offen offset:1024 lds
    buffer_load_dwordx4 v2, s[8:11], s28 offen offset:2048 lds
    buffer_load_dwordx4 v2, s[8:11], s28 offen offset:3072 lds
    s_add_u32 s28, s28, 4096
    s_mov_b32 m0, s29
    s_add_u32 s29, s29, 4096
    buffer_load_dwordx4 v2, s[8:11], s28 offen lds
    buffer_load_dwordx4 v2, s[8:11], s28 offen offset:1024 lds
    buffer_load_dwordx4 v2, s[8:11], s28 offen offset:2048 lds
    buffer_load_dwordx4 v2, s[8:11], s28 offen offset:3072 lds
    s_add_u32 s28, s28, 4096
    s_mov_b32 m0, s29
    s_add_u32 s29, s29, 4096
    buffer_load_dwordx4 v2, s[8:11], s28 offen lds
    buffer_load_dwordx4 v2, s[8:11], s28 offen offset:1024 lds
    buffer_load_dwordx4 v2, s[8:11], s28 offen offset:2048 lds
    buffer_load_dwordx4 v2, s[8:11], s28 offen offset:3072 lds
    s_add_u32 s28, s28, 4096
    s_mov_b32 m0, s29
    s_add_u32 s29, s29, 4096
    buffer_load_dwordx4 v2, s[8:11], s28 offen lds
    buffer_load_dwordx4 v2, s[8:11], s28 offen offset:1024 lds
    buffer_load_dwordx4 v2, s[8:11], s28 offen offset:2048 lds
    buffer_load_dwordx4 v2, s[8:11], s28 offen offset:3072 lds
    s_add_u32 s28, s28, 4096
    s_mov_b32 m0, s29
    s_add_u32 s29, s29, 3072
    buffer_load_dwordx4 v2, s[8:11], s28 offen lds
    buffer_load_dwordx4 v2, s[8:11], s28 offen offset:1024 lds
    buffer_load_dwordx4 v2, s[8:11], s28 offen offset:2048 lds
    s_add_u32 s28, s28, 3072
    s_waitcnt vmcnt(19)
    s_sub_u32 s16, s20, 1
    s_lshl_b32 s16, s16, 2
    v_add_u32 v7, s16, v143
    ds_write_b32 v7, v146
    s_add_u32 s20, s20, 1
    s_cmp_lt_u32 s20, 8
    s_cbranch_scc1 L_at_ld_loop
    s_waitcnt vmcnt(0)
    ds_write_b32 v143, v146 offset:28
    s_load_dwordx2 s[84:85], s[0:1], 16
    s_load_dwordx2 s[86:87], s[0:1], 40
    s_mul_i32 s16, s2, 21
    v_add_u32 v5, s16, v1
    v_lshlrev_b32 v5, 7, v5
    v_cmp_gt_u32 vcc, 21, v1
    v_mov_b32 v6, 0x80000000
    s_waitcnt lgkmcnt(0)
    v_cndmask_b32 v5, v6, v5, vcc
    s_mov_b32 s88, s84
    s_and_b32 s89, s85, 0xffff
    s_mov_b32 s90, 663552
    s_mov_b32 s91, 0x20000
    buffer_load_dword v20, v5, s[88:91], 0 offen
    s_mov_b32 s88, s86
    s_and_b32 s89, s87, 0xffff
    s_mov_b32 s90, 663552
    s_mov_b32 s91, 0x20000
    buffer_load_dword v20, v5, s[88:91], 0 offen
    s_load_dwordx2 s[88:89], s[0:1], 0
    s_load_dwordx2 s[90:91], s[0:1], 48
    s_lshl_b32 s16, s13, 5
    s_add_u32 s16, s16, s12
    s_lshl_b32 s16, s16, 3
    v_lshrrev_b32 v104, 3, v1
    v_add_u32 v104, s16, v104
    v_and_b32 v105, 7, v1
    v_lshlrev_b32 v105, 4, v105
    v_mul_u32_u24 v106, 1152, v104
    v_add_u32 v106, v106, v105
    s_waitcnt lgkmcnt(0)
    s_mov_b32 s92, s88
    s_and_b32 s93, s89, 0xffff
    s_mov_b32 s94, 2359296
    s_mov_b32 s95, 0x20000
    s_mov_b32 s84, s90
    s_and_b32 s85, s91, 0xffff
    s_mov_b32 s86, 1152
    s_mov_b32 s87, 0x20000
    buffer_load_dwordx4 v[24:27], v106, s[92:95], 0 offen offset:0
    buffer_load_dwordx4 v[64:67], v105, s[84:87], 0 offen offset:0
    buffer_load_dwordx4 v[28:31], v106, s[92:95], 0 offen offset:128
    buffer_load_dwordx4 v[68:71], v105, s[84:87], 0 offen offset:128
    buffer_load_dwordx4 v[32:35], v106, s[92:95], 0 offen offset:256
    buffer_load_dwordx4 v[72:75], v105, s[84:87], 0 offen offset:256
    buffer_load_dwordx4 v[36:39], v106, s[92:95], 0 offen offset:384
    buffer_load_dwordx4 v[76:79], v105, s[84:87], 0 offen offset:384
    buffer_load_dwordx4 v[40:43], v106, s[92:95], 0 offen offset:512
    buffer_load_dwordx4 v[80:83], v105, s[84:87], 0 offen offset:512
    buffer_load_dwordx4 v[44:47], v106, s[92:95], 0 offen offset:640
    buffer_load_dwordx4 v[84:87], v105, s[84:87], 0 offen offset:640
    buffer_load_dwordx4 v[48:51], v106, s[92:95], 0 offen offset:768
    buffer_load_dwordx4 v[88:91], v105, s[84:87], 0 offen offset:768
    buffer_load_dwordx4 v[52:55], v106, s[92:95], 0 offen offset:896
    buffer_load_dwordx4 v[92:95], v105, s[84:87], 0 offen offset:896
    buffer_load_dwordx4 v[56:59], v106, s[92:95], 0 offen offset:1024
    buffer_load_dwordx4 v[96:99], v105, s[84:87], 0 offen offset:1024
    v_mov_b32 v106, 0
    v_mov_b32 v107, 0
    s_waitcnt vmcnt(0)
    v_dot2c_f32_bf16 v106, v24, v64
    v_dot2c_f32_bf16 v107, v25, v65
    v_dot2c_f32_bf16 v106, v26, v66
    v_dot2c_f32_bf16 v107, v27, v67
    v_dot2c_f32_bf16 v106, v28, v68
    v_dot2c_f32_bf16 v107, v29, v69
    v_dot2c_f32_bf16 v106, v30, v70
    v_dot2c_f32_bf16 v107, v31, v71
    v_dot2c_f32_bf16 v106, v32, v72
    v_dot2c_f32_bf16 v107, v33, v73
    v_dot2c_f32_bf16 v106, v34, v74
    v_dot2c_f32_bf16 v107, v35, v75
    v_dot2c_f32_bf16 v106, v36, v76
    v_dot2c_f32_bf16 v107, v37, v77
    v_dot2c_f32_bf16 v106, v38, v78
    v_dot2c_f32_bf16 v107, v39, v79
    v_dot2c_f32_bf16 v106, v40, v80
    v_dot2c_f32_bf16 v107, v41, v81
    v_dot2c_f32_bf16 v106, v42, v82
    v_dot2c_f32_bf16 v107, v43, v83
    v_dot2c_f32_bf16 v106, v44, v84
    v_dot2c_f32_bf16 v107, v45, v85
    v_dot2c_f32_bf16 v106, v46, v86
    v_dot2c_f32_bf16 v107, v47, v87
    v_dot2c_f32_bf16 v106, v48, v88
    v_dot2c_f32_bf16 v107, v49, v89
    v_dot2c_f32_bf16 v106, v50, v90
    v_dot2c_f32_bf16 v107, v51, v91
    v_dot2c_f32_bf16 v106, v52, v92
    v_dot2c_f32_bf16 v107, v53, v93
    v_dot2c_f32_bf16 v106, v54, v94
    v_dot2c_f32_bf16 v107, v55, v95
    v_dot2c_f32_bf16 v106, v56, v96
    v_dot2c_f32_bf16 v107, v57, v97
    v_dot2c_f32_bf16 v106, v58, v98
    v_dot2c_f32_bf16 v107, v59, v99
    s_nop 3
    v_add_f32 v106, v106, v107
    s_nop 1
    v_add_f32_dpp v106, v106, v106 quad_perm:[1,0,3,2] row_mask:0xf bank_mask:0xf
    s_nop 1
    v_add_f32_dpp v106, v106, v106 quad_perm:[2,3,0,1] row_mask:0xf bank_mask:0xf
    s_nop 1
    v_add_f32_dpp v106, v106, v106 row_half_mirror row_mask:0xf bank_mask:0xf
    v_mul_f32 v106, 0xbfb8aa3b, v106
    v_exp_f32 v106, v106
    s_nop 0
    v_add_f32 v106, 1.0, v106
    v_rcp_f32 v106, v106
    v_lshlrev_b32 v104, 2, v104
    s_mov_b32 s16, 25165824
    buffer_store_dword v106, v104, s[8:11], s16 offen sc1
    s_endpgm
.globl oproj_kernel
.p2align 8
.type oproj_kernel,@function
oproj_kernel:
    s_cmp_ge_u32 s2, 256
    s_cbranch_scc1 L_op_end
    s_getpc_b64 s[94:95]
L_pc_39:
    s_sub_u32 s94, s94, L_pc_39-code_start
    s_subb_u32 s95, s95, 0
    v_lshlrev_b32 v160, 7, v0
    v_min_u32 v160, code_end-code_start-4, v160
    v_mov_b32 v161, s95
    v_add_co_u32 v160, vcc, s94, v160
    s_nop 1
    v_addc_co_u32 v161, vcc, 0, v161, vcc
    global_load_dword v162, v[160:161], off
    s_load_dwordx2 s[40:41], s[0:1], 16
    s_load_dwordx2 s[42:43], s[0:1], 40
    s_load_dwordx2 s[44:45], s[0:1], 56
    s_load_dwordx2 s[46:47], s[0:1], 72
    v_and_b32 v1, 63, v0
    v_lshrrev_b32 v2, 6, v0
    v_and_b32 v7, 15, v1
    v_readfirstlane_b32 s24, v2
    v_lshrrev_b32 v8, 4, v1
    s_and_b32 s29, s2, 1
    s_lshl_b32 s29, s29, 5
    s_lshr_b32 s30, s2, 3
    s_add_u32 s29, s29, s30
    s_cmp_ge_u32 s29, 63
    s_cbranch_scc1 L_op_end
    s_mul_i32 s25, s29, 7282
    s_lshr_b32 s25, s25, 16
    s_mul_i32 s30, s25, 9
    s_sub_u32 s26, s29, s30
    s_mul_i32 s27, s25, 5
    s_lshl_b32 s30, s25, 2
    s_add_u32 s30, s30, 4
    s_cmp_lt_u32 s25, 4
    s_cselect_b32 s27, s27, s30
    s_cselect_b32 s28, 5, 4
    s_bfe_u32 s30, s2, 0x20001
    s_lshl_b32 s30, s30, 5
    s_add_u32 s27, s27, s30
    s_waitcnt lgkmcnt(0)
    s_mov_b32 s12, s40
    s_and_b32 s13, s41, 0xffff
    s_mov_b32 s14, 663552
    s_mov_b32 s15, 0x20000
    s_mov_b32 s16, s42
    s_and_b32 s17, s43, 0xffff
    s_mov_b32 s18, 663552
    s_mov_b32 s19, 0x20000
    s_mov_b32 s20, s44
    s_and_b32 s21, s45, 0xffff
    s_mov_b32 s22, 2359296
    s_mov_b32 s23, 0x20000
    s_mov_b32 s8, s46
    s_and_b32 s9, s47, 0xffff
    s_mov_b32 s10, 268435456
    s_mov_b32 s11, 0x20000
    s_cmp_ge_u32 s24, 8
    s_cbranch_scc1 L_op_loader
    s_cmp_ge_u32 s24, 4
    s_cbranch_scc1 L_op_idle
    v_lshlrev_b32 v9, 4, v1
    v_lshrrev_b32 v2, 1, v8
    v_lshlrev_b32 v2, 4, v2
    v_and_b32 v3, 1, v8
    v_lshlrev_b32 v4, 2, v3
    v_add_u32 v2, v2, v4
    v_lshrrev_b32 v4, 2, v7
    v_add_u32 v2, v2, v4
    v_lshlrev_b32 v10, 7, v2
    v_lshlrev_b32 v3, 1, v3
    v_lshrrev_b32 v4, 3, v7
    v_add_u32 v3, v3, v4
    v_xor_b32 v3, s24, v3
    v_lshlrev_b32 v3, 5, v3
    v_add_u32 v10, v10, v3
    v_and_b32 v3, 3, v7
    v_lshlrev_b32 v3, 3, v3
    v_add_u32 v10, v10, v3
    v_add_u32 v10, 5120, v10
    v_mov_b32 v96, 0
    v_mov_b32 v97, 0
    v_mov_b32 v98, 0
    v_mov_b32 v99, 0
    v_mov_b32 v100, 0
    v_mov_b32 v101, 0
    v_mov_b32 v102, 0
    v_mov_b32 v103, 0
    v_mov_b32 v104, 0
    v_mov_b32 v105, 0
    v_mov_b32 v106, 0
    v_mov_b32 v107, 0
    v_mov_b32 v108, 0
    v_mov_b32 v109, 0
    v_mov_b32 v110, 0
    v_mov_b32 v111, 0
    v_mov_b32 v112, 0
    v_mov_b32 v113, 0
    v_mov_b32 v114, 0
    v_mov_b32 v115, 0
    v_mov_b32 v116, 0
    v_mov_b32 v117, 0
    v_mov_b32 v118, 0
    v_mov_b32 v119, 0
    v_mov_b32 v120, 0
    v_mov_b32 v121, 0
    v_mov_b32 v122, 0
    v_mov_b32 v123, 0
    v_mov_b32 v124, 0
    v_mov_b32 v125, 0
    v_mov_b32 v126, 0
    v_mov_b32 v127, 0
    v_mov_b32 v128, 0
    v_mov_b32 v129, 0
    v_mov_b32 v130, 0
    v_mov_b32 v131, 0
    v_mov_b32 v132, 0
    v_mov_b32 v133, 0
    v_mov_b32 v134, 0
    v_mov_b32 v135, 0
    s_barrier
    s_add_u32 s29, s27, 0
    s_min_u32 s29, s29, 127
    s_lshl_b32 s29, s29, 6
    s_add_u32 s29, s29, 25165824
    v_lshlrev_b32 v2, 2, v7
    buffer_load_dword v18, v2, s[8:11], s29 offen sc1
    s_add_u32 s29, s27, 1
    s_min_u32 s29, s29, 127
    s_lshl_b32 s29, s29, 6
    s_add_u32 s29, s29, 25165824
    v_lshlrev_b32 v2, 2, v7
    buffer_load_dword v19, v2, s[8:11], s29 offen sc1
    s_add_u32 s29, s27, 2
    s_min_u32 s29, s29, 127
    s_lshl_b32 s29, s29, 6
    s_add_u32 s29, s29, 25165824
    v_lshlrev_b32 v2, 2, v7
    buffer_load_dword v20, v2, s[8:11], s29 offen sc1
    s_add_u32 s29, s27, 3
    s_min_u32 s29, s29, 127
    s_lshl_b32 s29, s29, 6
    s_add_u32 s29, s29, 25165824
    v_lshlrev_b32 v2, 2, v7
    buffer_load_dword v21, v2, s[8:11], s29 offen sc1
    s_add_u32 s29, s27, 4
    s_min_u32 s29, s29, 127
    s_lshl_b32 s29, s29, 6
    s_add_u32 s29, s29, 25165824
    v_lshlrev_b32 v2, 2, v7
    buffer_load_dword v22, v2, s[8:11], s29 offen sc1
    v_add_u32 v11, 0, v9
    v_add_u32 v12, 0, v10
    v_add_u32 v138, 18432, v9
    v_add_u32 v139, 18432, v10
    ds_read_b64_tr_b16 v[84:85], v12 offset:0
    ds_read_b64_tr_b16 v[86:87], v12 offset:1024
    ds_read_b128 v[24:27], v11 offset:0
    ds_read_b128 v[28:31], v11 offset:1024
    ds_read_b128 v[32:35], v11 offset:2048
    ds_read_b128 v[36:39], v11 offset:3072
    ds_read_b128 v[40:43], v11 offset:4096
    ds_read_b64_tr_b16 v[88:89], v12 offset:9216
    ds_read_b64_tr_b16 v[90:91], v12 offset:10240
    ds_read_b128 v[44:47], v11 offset:9216
    ds_read_b128 v[48:51], v11 offset:10240
    ds_read_b128 v[52:55], v11 offset:11264
    ds_read_b128 v[56:59], v11 offset:12288
    ds_read_b128 v[60:63], v11 offset:13312
    v_add_u32 v138, 18432, v9
    v_add_u32 v139, 18432, v10
    ds_read_b64_tr_b16 v[92:93], v139 offset:0
    ds_read_b64_tr_b16 v[94:95], v139 offset:1024
    ds_read_b128 v[64:67], v138 offset:0
    ds_read_b128 v[68:71], v138 offset:1024
    ds_read_b128 v[72:75], v138 offset:2048
    ds_read_b128 v[76:79], v138 offset:3072
    ds_read_b128 v[80:83], v138 offset:4096
    s_waitcnt lgkmcnt(14)
    v_mfma_f32_16x16x32_bf16 v[96:99], v[84:87], v[24:27], v[96:99]
    v_mfma_f32_16x16x32_bf16 v[100:103], v[84:87], v[28:31], v[100:103]
    v_mfma_f32_16x16x32_bf16 v[104:107], v[84:87], v[32:35], v[104:107]
    v_mfma_f32_16x16x32_bf16 v[108:111], v[84:87], v[36:39], v[108:111]
    v_mfma_f32_16x16x32_bf16 v[112:115], v[84:87], v[40:43], v[112:115]
    ds_read_b64_tr_b16 v[84:85], v139 offset:9216
    ds_read_b64_tr_b16 v[86:87], v139 offset:10240
    ds_read_b128 v[24:27], v138 offset:9216
    ds_read_b128 v[28:31], v138 offset:10240
    ds_read_b128 v[32:35], v138 offset:11264
    ds_read_b128 v[36:39], v138 offset:12288
    ds_read_b128 v[40:43], v138 offset:13312
    s_waitcnt lgkmcnt(14)
    v_mfma_f32_16x16x32_bf16 v[96:99], v[88:91], v[44:47], v[96:99]
    v_mfma_f32_16x16x32_bf16 v[100:103], v[88:91], v[48:51], v[100:103]
    v_mfma_f32_16x16x32_bf16 v[104:107], v[88:91], v[52:55], v[104:107]
    v_mfma_f32_16x16x32_bf16 v[108:111], v[88:91], v[56:59], v[108:111]
    v_mfma_f32_16x16x32_bf16 v[112:115], v[88:91], v[60:63], v[112:115]
    v_add_u32 v11, 36864, v9
    v_add_u32 v12, 36864, v10
    ds_read_b64_tr_b16 v[88:89], v12 offset:0
    ds_read_b64_tr_b16 v[90:91], v12 offset:1024
    ds_read_b128 v[44:47], v11 offset:0
    ds_read_b128 v[48:51], v11 offset:1024
    ds_read_b128 v[52:55], v11 offset:2048
    ds_read_b128 v[56:59], v11 offset:3072
    ds_read_b128 v[60:63], v11 offset:4096
    s_waitcnt lgkmcnt(14)
    v_mfma_f32_16x16x32_bf16 v[96:99], v[92:95], v[64:67], v[96:99]
    v_mfma_f32_16x16x32_bf16 v[100:103], v[92:95], v[68:71], v[100:103]
    v_mfma_f32_16x16x32_bf16 v[104:107], v[92:95], v[72:75], v[104:107]
    v_mfma_f32_16x16x32_bf16 v[108:111], v[92:95], v[76:79], v[108:111]
    v_mfma_f32_16x16x32_bf16 v[112:115], v[92:95], v[80:83], v[112:115]
    ds_read_b64_tr_b16 v[92:93], v12 offset:9216
    ds_read_b64_tr_b16 v[94:95], v12 offset:10240
    ds_read_b128 v[64:67], v11 offset:9216
    ds_read_b128 v[68:71], v11 offset:10240
    ds_read_b128 v[72:75], v11 offset:11264
    ds_read_b128 v[76:79], v11 offset:12288
    ds_read_b128 v[80:83], v11 offset:13312
    s_waitcnt lgkmcnt(14)
    v_mfma_f32_16x16x32_bf16 v[96:99], v[84:87], v[24:27], v[96:99]
    v_mfma_f32_16x16x32_bf16 v[100:103], v[84:87], v[28:31], v[100:103]
    v_mfma_f32_16x16x32_bf16 v[104:107], v[84:87], v[32:35], v[104:107]
    v_mfma_f32_16x16x32_bf16 v[108:111], v[84:87], v[36:39], v[108:111]
    v_mfma_f32_16x16x32_bf16 v[112:115], v[84:87], v[40:43], v[112:115]
    s_barrier
    v_add_u32 v138, 55296, v9
    v_add_u32 v139, 55296, v10
    ds_read_b64_tr_b16 v[84:85], v139 offset:0
    ds_read_b64_tr_b16 v[86:87], v139 offset:1024
    ds_read_b128 v[24:27], v138 offset:0
    ds_read_b128 v[28:31], v138 offset:1024
    ds_read_b128 v[32:35], v138 offset:2048
    ds_read_b128 v[36:39], v138 offset:3072
    ds_read_b128 v[40:43], v138 offset:4096
    s_waitcnt lgkmcnt(14)
    v_mfma_f32_16x16x32_bf16 v[96:99], v[88:91], v[44:47], v[96:99]
    v_mfma_f32_16x16x32_bf16 v[100:103], v[88:91], v[48:51], v[100:103]
    v_mfma_f32_16x16x32_bf16 v[104:107], v[88:91], v[52:55], v[104:107]
    v_mfma_f32_16x16x32_bf16 v[108:111], v[88:91], v[56:59], v[108:111]
    v_mfma_f32_16x16x32_bf16 v[112:115], v[88:91], v[60:63], v[112:115]
    ds_read_b64_tr_b16 v[88:89], v139 offset:9216
    ds_read_b64_tr_b16 v[90:91], v139 offset:10240
    ds_read_b128 v[44:47], v138 offset:9216
    ds_read_b128 v[48:51], v138 offset:10240
    ds_read_b128 v[52:55], v138 offset:11264
    ds_read_b128 v[56:59], v138 offset:12288
    ds_read_b128 v[60:63], v138 offset:13312
    s_waitcnt lgkmcnt(14)
    v_mfma_f32_16x16x32_bf16 v[96:99], v[92:95], v[64:67], v[96:99]
    v_mfma_f32_16x16x32_bf16 v[100:103], v[92:95], v[68:71], v[100:103]
    v_mfma_f32_16x16x32_bf16 v[104:107], v[92:95], v[72:75], v[104:107]
    v_mfma_f32_16x16x32_bf16 v[108:111], v[92:95], v[76:79], v[108:111]
    v_mfma_f32_16x16x32_bf16 v[112:115], v[92:95], v[80:83], v[112:115]
    v_add_u32 v11, 73728, v9
    v_add_u32 v12, 73728, v10
    ds_read_b64_tr_b16 v[92:93], v12 offset:0
    ds_read_b64_tr_b16 v[94:95], v12 offset:1024
    ds_read_b128 v[64:67], v11 offset:0
    ds_read_b128 v[68:71], v11 offset:1024
    ds_read_b128 v[72:75], v11 offset:2048
    ds_read_b128 v[76:79], v11 offset:3072
    ds_read_b128 v[80:83], v11 offset:4096
    s_waitcnt lgkmcnt(14)
    v_mfma_f32_16x16x32_bf16 v[96:99], v[84:87], v[24:27], v[96:99]
    v_mfma_f32_16x16x32_bf16 v[100:103], v[84:87], v[28:31], v[100:103]
    v_mfma_f32_16x16x32_bf16 v[104:107], v[84:87], v[32:35], v[104:107]
    v_mfma_f32_16x16x32_bf16 v[108:111], v[84:87], v[36:39], v[108:111]
    v_mfma_f32_16x16x32_bf16 v[112:115], v[84:87], v[40:43], v[112:115]
    ds_read_b64_tr_b16 v[84:85], v12 offset:9216
    ds_read_b64_tr_b16 v[86:87], v12 offset:10240
    ds_read_b128 v[24:27], v11 offset:9216
    ds_read_b128 v[28:31], v11 offset:10240
    ds_read_b128 v[32:35], v11 offset:11264
    ds_read_b128 v[36:39], v11 offset:12288
    ds_read_b128 v[40:43], v11 offset:13312
    s_waitcnt lgkmcnt(14)
    v_mfma_f32_16x16x32_bf16 v[96:99], v[88:91], v[44:47], v[96:99]
    v_mfma_f32_16x16x32_bf16 v[100:103], v[88:91], v[48:51], v[100:103]
    v_mfma_f32_16x16x32_bf16 v[104:107], v[88:91], v[52:55], v[104:107]
    v_mfma_f32_16x16x32_bf16 v[108:111], v[88:91], v[56:59], v[108:111]
    v_mfma_f32_16x16x32_bf16 v[112:115], v[88:91], v[60:63], v[112:115]
    s_barrier
    v_add_u32 v138, 92160, v9
    v_add_u32 v139, 92160, v10
    ds_read_b64_tr_b16 v[88:89], v139 offset:0
    ds_read_b64_tr_b16 v[90:91], v139 offset:1024
    ds_read_b128 v[44:47], v138 offset:0
    ds_read_b128 v[48:51], v138 offset:1024
    ds_read_b128 v[52:55], v138 offset:2048
    ds_read_b128 v[56:59], v138 offset:3072
    ds_read_b128 v[60:63], v138 offset:4096
    s_waitcnt lgkmcnt(14)
    v_mfma_f32_16x16x32_bf16 v[96:99], v[92:95], v[64:67], v[96:99]
    v_mfma_f32_16x16x32_bf16 v[100:103], v[92:95], v[68:71], v[100:103]
    v_mfma_f32_16x16x32_bf16 v[104:107], v[92:95], v[72:75], v[104:107]
    v_mfma_f32_16x16x32_bf16 v[108:111], v[92:95], v[76:79], v[108:111]
    v_mfma_f32_16x16x32_bf16 v[112:115], v[92:95], v[80:83], v[112:115]
    ds_read_b64_tr_b16 v[92:93], v139 offset:9216
    ds_read_b64_tr_b16 v[94:95], v139 offset:10240
    ds_read_b128 v[64:67], v138 offset:9216
    ds_read_b128 v[68:71], v138 offset:10240
    ds_read_b128 v[72:75], v138 offset:11264
    ds_read_b128 v[76:79], v138 offset:12288
    ds_read_b128 v[80:83], v138 offset:13312
    s_waitcnt lgkmcnt(14)
    v_mfma_f32_16x16x32_bf16 v[96:99], v[84:87], v[24:27], v[96:99]
    v_mfma_f32_16x16x32_bf16 v[100:103], v[84:87], v[28:31], v[100:103]
    v_mfma_f32_16x16x32_bf16 v[104:107], v[84:87], v[32:35], v[104:107]
    v_mfma_f32_16x16x32_bf16 v[108:111], v[84:87], v[36:39], v[108:111]
    v_mfma_f32_16x16x32_bf16 v[112:115], v[84:87], v[40:43], v[112:115]
    v_add_u32 v11, 110592, v9
    v_add_u32 v12, 110592, v10
    ds_read_b64_tr_b16 v[84:85], v12 offset:0
    ds_read_b64_tr_b16 v[86:87], v12 offset:1024
    ds_read_b128 v[24:27], v11 offset:0
    ds_read_b128 v[28:31], v11 offset:1024
    ds_read_b128 v[32:35], v11 offset:2048
    ds_read_b128 v[36:39], v11 offset:3072
    ds_read_b128 v[40:43], v11 offset:4096
    s_waitcnt lgkmcnt(14)
    v_mfma_f32_16x16x32_bf16 v[96:99], v[88:91], v[44:47], v[96:99]
    v_mfma_f32_16x16x32_bf16 v[100:103], v[88:91], v[48:51], v[100:103]
    v_mfma_f32_16x16x32_bf16 v[104:107], v[88:91], v[52:55], v[104:107]
    v_mfma_f32_16x16x32_bf16 v[108:111], v[88:91], v[56:59], v[108:111]
    v_mfma_f32_16x16x32_bf16 v[112:115], v[88:91], v[60:63], v[112:115]
    ds_read_b64_tr_b16 v[88:89], v12 offset:9216
    ds_read_b64_tr_b16 v[90:91], v12 offset:10240
    ds_read_b128 v[44:47], v11 offset:9216
    ds_read_b128 v[48:51], v11 offset:10240
    ds_read_b128 v[52:55], v11 offset:11264
    ds_read_b128 v[56:59], v11 offset:12288
    ds_read_b128 v[60:63], v11 offset:13312
    s_waitcnt lgkmcnt(14)
    v_mfma_f32_16x16x32_bf16 v[96:99], v[92:95], v[64:67], v[96:99]
    v_mfma_f32_16x16x32_bf16 v[100:103], v[92:95], v[68:71], v[100:103]
    v_mfma_f32_16x16x32_bf16 v[104:107], v[92:95], v[72:75], v[104:107]
    v_mfma_f32_16x16x32_bf16 v[108:111], v[92:95], v[76:79], v[108:111]
    v_mfma_f32_16x16x32_bf16 v[112:115], v[92:95], v[80:83], v[112:115]
    s_barrier
    v_add_u32 v138, 129024, v9
    v_add_u32 v139, 129024, v10
    ds_read_b64_tr_b16 v[92:93], v139 offset:0
    ds_read_b64_tr_b16 v[94:95], v139 offset:1024
    ds_read_b128 v[64:67], v138 offset:0
    ds_read_b128 v[68:71], v138 offset:1024
    ds_read_b128 v[72:75], v138 offset:2048
    ds_read_b128 v[76:79], v138 offset:3072
    ds_read_b128 v[80:83], v138 offset:4096
    s_waitcnt lgkmcnt(14)
    v_mfma_f32_16x16x32_bf16 v[96:99], v[84:87], v[24:27], v[96:99]
    v_mfma_f32_16x16x32_bf16 v[100:103], v[84:87], v[28:31], v[100:103]
    v_mfma_f32_16x16x32_bf16 v[104:107], v[84:87], v[32:35], v[104:107]
    v_mfma_f32_16x16x32_bf16 v[108:111], v[84:87], v[36:39], v[108:111]
    v_mfma_f32_16x16x32_bf16 v[112:115], v[84:87], v[40:43], v[112:115]
    ds_read_b64_tr_b16 v[84:85], v139 offset:9216
    ds_read_b64_tr_b16 v[86:87], v139 offset:10240
    ds_read_b128 v[24:27], v138 offset:9216
    ds_read_b128 v[28:31], v138 offset:10240
    ds_read_b128 v[32:35], v138 offset:11264
    ds_read_b128 v[36:39], v138 offset:12288
    ds_read_b128 v[40:43], v138 offset:13312
    s_waitcnt lgkmcnt(14)
    v_mfma_f32_16x16x32_bf16 v[96:99], v[88:91], v[44:47], v[96:99]
    v_mfma_f32_16x16x32_bf16 v[100:103], v[88:91], v[48:51], v[100:103]
    v_mfma_f32_16x16x32_bf16 v[104:107], v[88:91], v[52:55], v[104:107]
    v_mfma_f32_16x16x32_bf16 v[108:111], v[88:91], v[56:59], v[108:111]
    v_mfma_f32_16x16x32_bf16 v[112:115], v[88:91], v[60:63], v[112:115]
    v_add_u32 v11, 0, v9
    v_add_u32 v12, 0, v10
    ds_read_b64_tr_b16 v[88:89], v12 offset:0
    ds_read_b64_tr_b16 v[90:91], v12 offset:1024
    ds_read_b128 v[44:47], v11 offset:0
    ds_read_b128 v[48:51], v11 offset:1024
    ds_read_b128 v[52:55], v11 offset:2048
    ds_read_b128 v[56:59], v11 offset:3072
    ds_read_b128 v[60:63], v11 offset:4096
    s_waitcnt lgkmcnt(14)
    v_mfma_f32_16x16x32_bf16 v[96:99], v[92:95], v[64:67], v[96:99]
    v_mfma_f32_16x16x32_bf16 v[100:103], v[92:95], v[68:71], v[100:103]
    v_mfma_f32_16x16x32_bf16 v[104:107], v[92:95], v[72:75], v[104:107]
    v_mfma_f32_16x16x32_bf16 v[108:111], v[92:95], v[76:79], v[108:111]
    v_mfma_f32_16x16x32_bf16 v[112:115], v[92:95], v[80:83], v[112:115]
    ds_read_b64_tr_b16 v[92:93], v12 offset:9216
    ds_read_b64_tr_b16 v[94:95], v12 offset:10240
    ds_read_b128 v[64:67], v11 offset:9216
    ds_read_b128 v[68:71], v11 offset:10240
    ds_read_b128 v[72:75], v11 offset:11264
    ds_read_b128 v[76:79], v11 offset:12288
    ds_read_b128 v[80:83], v11 offset:13312
    s_waitcnt lgkmcnt(14)
    v_mfma_f32_16x16x32_bf16 v[96:99], v[84:87], v[24:27], v[96:99]
    v_mfma_f32_16x16x32_bf16 v[100:103], v[84:87], v[28:31], v[100:103]
    v_mfma_f32_16x16x32_bf16 v[104:107], v[84:87], v[32:35], v[104:107]
    v_mfma_f32_16x16x32_bf16 v[108:111], v[84:87], v[36:39], v[108:111]
    v_mfma_f32_16x16x32_bf16 v[112:115], v[84:87], v[40:43], v[112:115]
    s_barrier
    v_add_u32 v138, 18432, v9
    v_add_u32 v139, 18432, v10
    ds_read_b64_tr_b16 v[84:85], v139 offset:0
    ds_read_b64_tr_b16 v[86:87], v139 offset:1024
    ds_read_b128 v[24:27], v138 offset:0
    ds_read_b128 v[28:31], v138 offset:1024
    ds_read_b128 v[32:35], v138 offset:2048
    ds_read_b128 v[36:39], v138 offset:3072
    ds_read_b128 v[40:43], v138 offset:4096
    s_waitcnt lgkmcnt(14)
    v_mfma_f32_16x16x32_bf16 v[96:99], v[88:91], v[44:47], v[96:99]
    v_mfma_f32_16x16x32_bf16 v[100:103], v[88:91], v[48:51], v[100:103]
    v_mfma_f32_16x16x32_bf16 v[104:107], v[88:91], v[52:55], v[104:107]
    v_mfma_f32_16x16x32_bf16 v[108:111], v[88:91], v[56:59], v[108:111]
    v_mfma_f32_16x16x32_bf16 v[112:115], v[88:91], v[60:63], v[112:115]
    ds_read_b64_tr_b16 v[88:89], v139 offset:9216
    ds_read_b64_tr_b16 v[90:91], v139 offset:10240
    ds_read_b128 v[44:47], v138 offset:9216
    ds_read_b128 v[48:51], v138 offset:10240
    ds_read_b128 v[52:55], v138 offset:11264
    ds_read_b128 v[56:59], v138 offset:12288
    ds_read_b128 v[60:63], v138 offset:13312
    s_waitcnt lgkmcnt(14)
    v_mfma_f32_16x16x32_bf16 v[96:99], v[92:95], v[64:67], v[96:99]
    v_mfma_f32_16x16x32_bf16 v[100:103], v[92:95], v[68:71], v[100:103]
    v_mfma_f32_16x16x32_bf16 v[104:107], v[92:95], v[72:75], v[104:107]
    v_mfma_f32_16x16x32_bf16 v[108:111], v[92:95], v[76:79], v[108:111]
    v_mfma_f32_16x16x32_bf16 v[112:115], v[92:95], v[80:83], v[112:115]
    v_add_u32 v11, 36864, v9
    v_add_u32 v12, 36864, v10
    ds_read_b64_tr_b16 v[92:93], v12 offset:0
    ds_read_b64_tr_b16 v[94:95], v12 offset:1024
    ds_read_b128 v[64:67], v11 offset:0
    ds_read_b128 v[68:71], v11 offset:1024
    ds_read_b128 v[72:75], v11 offset:2048
    ds_read_b128 v[76:79], v11 offset:3072
    ds_read_b128 v[80:83], v11 offset:4096
    s_waitcnt lgkmcnt(14)
    v_mfma_f32_16x16x32_bf16 v[116:119], v[84:87], v[24:27], v[116:119]
    v_mfma_f32_16x16x32_bf16 v[120:123], v[84:87], v[28:31], v[120:123]
    v_mfma_f32_16x16x32_bf16 v[124:127], v[84:87], v[32:35], v[124:127]
    v_mfma_f32_16x16x32_bf16 v[128:131], v[84:87], v[36:39], v[128:131]
    v_mfma_f32_16x16x32_bf16 v[132:135], v[84:87], v[40:43], v[132:135]
    ds_read_b64_tr_b16 v[84:85], v12 offset:9216
    ds_read_b64_tr_b16 v[86:87], v12 offset:10240
    ds_read_b128 v[24:27], v11 offset:9216
    ds_read_b128 v[28:31], v11 offset:10240
    ds_read_b128 v[32:35], v11 offset:11264
    ds_read_b128 v[36:39], v11 offset:12288
    ds_read_b128 v[40:43], v11 offset:13312
    s_waitcnt lgkmcnt(14)
    v_mfma_f32_16x16x32_bf16 v[116:119], v[88:91], v[44:47], v[116:119]
    v_mfma_f32_16x16x32_bf16 v[120:123], v[88:91], v[48:51], v[120:123]
    v_mfma_f32_16x16x32_bf16 v[124:127], v[88:91], v[52:55], v[124:127]
    v_mfma_f32_16x16x32_bf16 v[128:131], v[88:91], v[56:59], v[128:131]
    v_mfma_f32_16x16x32_bf16 v[132:135], v[88:91], v[60:63], v[132:135]
    s_barrier
    v_add_u32 v138, 55296, v9
    v_add_u32 v139, 55296, v10
    ds_read_b64_tr_b16 v[88:89], v139 offset:0
    ds_read_b64_tr_b16 v[90:91], v139 offset:1024
    ds_read_b128 v[44:47], v138 offset:0
    ds_read_b128 v[48:51], v138 offset:1024
    ds_read_b128 v[52:55], v138 offset:2048
    ds_read_b128 v[56:59], v138 offset:3072
    ds_read_b128 v[60:63], v138 offset:4096
    s_waitcnt lgkmcnt(14)
    v_mfma_f32_16x16x32_bf16 v[116:119], v[92:95], v[64:67], v[116:119]
    v_mfma_f32_16x16x32_bf16 v[120:123], v[92:95], v[68:71], v[120:123]
    v_mfma_f32_16x16x32_bf16 v[124:127], v[92:95], v[72:75], v[124:127]
    v_mfma_f32_16x16x32_bf16 v[128:131], v[92:95], v[76:79], v[128:131]
    v_mfma_f32_16x16x32_bf16 v[132:135], v[92:95], v[80:83], v[132:135]
    ds_read_b64_tr_b16 v[92:93], v139 offset:9216
    ds_read_b64_tr_b16 v[94:95], v139 offset:10240
    ds_read_b128 v[64:67], v138 offset:9216
    ds_read_b128 v[68:71], v138 offset:10240
    ds_read_b128 v[72:75], v138 offset:11264
    ds_read_b128 v[76:79], v138 offset:12288
    ds_read_b128 v[80:83], v138 offset:13312
    s_waitcnt lgkmcnt(14)
    v_mfma_f32_16x16x32_bf16 v[116:119], v[84:87], v[24:27], v[116:119]
    v_mfma_f32_16x16x32_bf16 v[120:123], v[84:87], v[28:31], v[120:123]
    v_mfma_f32_16x16x32_bf16 v[124:127], v[84:87], v[32:35], v[124:127]
    v_mfma_f32_16x16x32_bf16 v[128:131], v[84:87], v[36:39], v[128:131]
    v_mfma_f32_16x16x32_bf16 v[132:135], v[84:87], v[40:43], v[132:135]
    v_add_u32 v11, 73728, v9
    v_add_u32 v12, 73728, v10
    ds_read_b64_tr_b16 v[84:85], v12 offset:0
    ds_read_b64_tr_b16 v[86:87], v12 offset:1024
    ds_read_b128 v[24:27], v11 offset:0
    ds_read_b128 v[28:31], v11 offset:1024
    ds_read_b128 v[32:35], v11 offset:2048
    ds_read_b128 v[36:39], v11 offset:3072
    ds_read_b128 v[40:43], v11 offset:4096
    s_waitcnt lgkmcnt(14)
    v_mfma_f32_16x16x32_bf16 v[116:119], v[88:91], v[44:47], v[116:119]
    v_mfma_f32_16x16x32_bf16 v[120:123], v[88:91], v[48:51], v[120:123]
    v_mfma_f32_16x16x32_bf16 v[124:127], v[88:91], v[52:55], v[124:127]
    v_mfma_f32_16x16x32_bf16 v[128:131], v[88:91], v[56:59], v[128:131]
    v_mfma_f32_16x16x32_bf16 v[132:135], v[88:91], v[60:63], v[132:135]
    ds_read_b64_tr_b16 v[88:89], v12 offset:9216
    ds_read_b64_tr_b16 v[90:91], v12 offset:10240
    ds_read_b128 v[44:47], v11 offset:9216
    ds_read_b128 v[48:51], v11 offset:10240
    ds_read_b128 v[52:55], v11 offset:11264
    ds_read_b128 v[56:59], v11 offset:12288
    ds_read_b128 v[60:63], v11 offset:13312
    s_waitcnt lgkmcnt(14)
    v_mfma_f32_16x16x32_bf16 v[116:119], v[92:95], v[64:67], v[116:119]
    v_mfma_f32_16x16x32_bf16 v[120:123], v[92:95], v[68:71], v[120:123]
    v_mfma_f32_16x16x32_bf16 v[124:127], v[92:95], v[72:75], v[124:127]
    v_mfma_f32_16x16x32_bf16 v[128:131], v[92:95], v[76:79], v[128:131]
    v_mfma_f32_16x16x32_bf16 v[132:135], v[92:95], v[80:83], v[132:135]
    s_barrier
    v_add_u32 v138, 92160, v9
    v_add_u32 v139, 92160, v10
    ds_read_b64_tr_b16 v[92:93], v139 offset:0
    ds_read_b64_tr_b16 v[94:95], v139 offset:1024
    ds_read_b128 v[64:67], v138 offset:0
    ds_read_b128 v[68:71], v138 offset:1024
    ds_read_b128 v[72:75], v138 offset:2048
    ds_read_b128 v[76:79], v138 offset:3072
    ds_read_b128 v[80:83], v138 offset:4096
    s_waitcnt lgkmcnt(14)
    v_mfma_f32_16x16x32_bf16 v[116:119], v[84:87], v[24:27], v[116:119]
    v_mfma_f32_16x16x32_bf16 v[120:123], v[84:87], v[28:31], v[120:123]
    v_mfma_f32_16x16x32_bf16 v[124:127], v[84:87], v[32:35], v[124:127]
    v_mfma_f32_16x16x32_bf16 v[128:131], v[84:87], v[36:39], v[128:131]
    v_mfma_f32_16x16x32_bf16 v[132:135], v[84:87], v[40:43], v[132:135]
    ds_read_b64_tr_b16 v[84:85], v139 offset:9216
    ds_read_b64_tr_b16 v[86:87], v139 offset:10240
    ds_read_b128 v[24:27], v138 offset:9216
    ds_read_b128 v[28:31], v138 offset:10240
    ds_read_b128 v[32:35], v138 offset:11264
    ds_read_b128 v[36:39], v138 offset:12288
    ds_read_b128 v[40:43], v138 offset:13312
    s_waitcnt lgkmcnt(14)
    v_mfma_f32_16x16x32_bf16 v[116:119], v[88:91], v[44:47], v[116:119]
    v_mfma_f32_16x16x32_bf16 v[120:123], v[88:91], v[48:51], v[120:123]
    v_mfma_f32_16x16x32_bf16 v[124:127], v[88:91], v[52:55], v[124:127]
    v_mfma_f32_16x16x32_bf16 v[128:131], v[88:91], v[56:59], v[128:131]
    v_mfma_f32_16x16x32_bf16 v[132:135], v[88:91], v[60:63], v[132:135]
    v_add_u32 v11, 110592, v9
    v_add_u32 v12, 110592, v10
    ds_read_b64_tr_b16 v[88:89], v12 offset:0
    ds_read_b64_tr_b16 v[90:91], v12 offset:1024
    ds_read_b128 v[44:47], v11 offset:0
    ds_read_b128 v[48:51], v11 offset:1024
    ds_read_b128 v[52:55], v11 offset:2048
    ds_read_b128 v[56:59], v11 offset:3072
    ds_read_b128 v[60:63], v11 offset:4096
    s_waitcnt lgkmcnt(14)
    v_mfma_f32_16x16x32_bf16 v[116:119], v[92:95], v[64:67], v[116:119]
    v_mfma_f32_16x16x32_bf16 v[120:123], v[92:95], v[68:71], v[120:123]
    v_mfma_f32_16x16x32_bf16 v[124:127], v[92:95], v[72:75], v[124:127]
    v_mfma_f32_16x16x32_bf16 v[128:131], v[92:95], v[76:79], v[128:131]
    v_mfma_f32_16x16x32_bf16 v[132:135], v[92:95], v[80:83], v[132:135]
    ds_read_b64_tr_b16 v[92:93], v12 offset:9216
    ds_read_b64_tr_b16 v[94:95], v12 offset:10240
    ds_read_b128 v[64:67], v11 offset:9216
    ds_read_b128 v[68:71], v11 offset:10240
    ds_read_b128 v[72:75], v11 offset:11264
    ds_read_b128 v[76:79], v11 offset:12288
    ds_read_b128 v[80:83], v11 offset:13312
    s_waitcnt lgkmcnt(14)
    v_mfma_f32_16x16x32_bf16 v[116:119], v[84:87], v[24:27], v[116:119]
    v_mfma_f32_16x16x32_bf16 v[120:123], v[84:87], v[28:31], v[120:123]
    v_mfma_f32_16x16x32_bf16 v[124:127], v[84:87], v[32:35], v[124:127]
    v_mfma_f32_16x16x32_bf16 v[128:131], v[84:87], v[36:39], v[128:131]
    v_mfma_f32_16x16x32_bf16 v[132:135], v[84:87], v[40:43], v[132:135]
    s_barrier
    v_add_u32 v138, 129024, v9
    v_add_u32 v139, 129024, v10
    ds_read_b64_tr_b16 v[84:85], v139 offset:0
    ds_read_b64_tr_b16 v[86:87], v139 offset:1024
    ds_read_b128 v[24:27], v138 offset:0
    ds_read_b128 v[28:31], v138 offset:1024
    ds_read_b128 v[32:35], v138 offset:2048
    ds_read_b128 v[36:39], v138 offset:3072
    ds_read_b128 v[40:43], v138 offset:4096
    s_waitcnt lgkmcnt(14)
    v_mfma_f32_16x16x32_bf16 v[116:119], v[88:91], v[44:47], v[116:119]
    v_mfma_f32_16x16x32_bf16 v[120:123], v[88:91], v[48:51], v[120:123]
    v_mfma_f32_16x16x32_bf16 v[124:127], v[88:91], v[52:55], v[124:127]
    v_mfma_f32_16x16x32_bf16 v[128:131], v[88:91], v[56:59], v[128:131]
    v_mfma_f32_16x16x32_bf16 v[132:135], v[88:91], v[60:63], v[132:135]
    ds_read_b64_tr_b16 v[88:89], v139 offset:9216
    ds_read_b64_tr_b16 v[90:91], v139 offset:10240
    ds_read_b128 v[44:47], v138 offset:9216
    ds_read_b128 v[48:51], v138 offset:10240
    ds_read_b128 v[52:55], v138 offset:11264
    ds_read_b128 v[56:59], v138 offset:12288
    ds_read_b128 v[60:63], v138 offset:13312
    s_waitcnt lgkmcnt(14)
    v_mfma_f32_16x16x32_bf16 v[116:119], v[92:95], v[64:67], v[116:119]
    v_mfma_f32_16x16x32_bf16 v[120:123], v[92:95], v[68:71], v[120:123]
    v_mfma_f32_16x16x32_bf16 v[124:127], v[92:95], v[72:75], v[124:127]
    v_mfma_f32_16x16x32_bf16 v[128:131], v[92:95], v[76:79], v[128:131]
    v_mfma_f32_16x16x32_bf16 v[132:135], v[92:95], v[80:83], v[132:135]
    v_add_u32 v11, 0, v9
    v_add_u32 v12, 0, v10
    ds_read_b64_tr_b16 v[92:93], v12 offset:0
    ds_read_b64_tr_b16 v[94:95], v12 offset:1024
    ds_read_b128 v[64:67], v11 offset:0
    ds_read_b128 v[68:71], v11 offset:1024
    ds_read_b128 v[72:75], v11 offset:2048
    ds_read_b128 v[76:79], v11 offset:3072
    ds_read_b128 v[80:83], v11 offset:4096
    s_waitcnt lgkmcnt(14)
    v_mfma_f32_16x16x32_bf16 v[116:119], v[84:87], v[24:27], v[116:119]
    v_mfma_f32_16x16x32_bf16 v[120:123], v[84:87], v[28:31], v[120:123]
    v_mfma_f32_16x16x32_bf16 v[124:127], v[84:87], v[32:35], v[124:127]
    v_mfma_f32_16x16x32_bf16 v[128:131], v[84:87], v[36:39], v[128:131]
    v_mfma_f32_16x16x32_bf16 v[132:135], v[84:87], v[40:43], v[132:135]
    ds_read_b64_tr_b16 v[84:85], v12 offset:9216
    ds_read_b64_tr_b16 v[86:87], v12 offset:10240
    ds_read_b128 v[24:27], v11 offset:9216
    ds_read_b128 v[28:31], v11 offset:10240
    ds_read_b128 v[32:35], v11 offset:11264
    ds_read_b128 v[36:39], v11 offset:12288
    ds_read_b128 v[40:43], v11 offset:13312
    s_waitcnt lgkmcnt(14)
    v_mfma_f32_16x16x32_bf16 v[116:119], v[88:91], v[44:47], v[116:119]
    v_mfma_f32_16x16x32_bf16 v[120:123], v[88:91], v[48:51], v[120:123]
    v_mfma_f32_16x16x32_bf16 v[124:127], v[88:91], v[52:55], v[124:127]
    v_mfma_f32_16x16x32_bf16 v[128:131], v[88:91], v[56:59], v[128:131]
    v_mfma_f32_16x16x32_bf16 v[132:135], v[88:91], v[60:63], v[132:135]
    s_barrier
    v_add_u32 v138, 18432, v9
    v_add_u32 v139, 18432, v10
    ds_read_b64_tr_b16 v[88:89], v139 offset:0
    ds_read_b64_tr_b16 v[90:91], v139 offset:1024
    ds_read_b128 v[44:47], v138 offset:0
    ds_read_b128 v[48:51], v138 offset:1024
    ds_read_b128 v[52:55], v138 offset:2048
    ds_read_b128 v[56:59], v138 offset:3072
    ds_read_b128 v[60:63], v138 offset:4096
    s_waitcnt lgkmcnt(14)
    v_mfma_f32_16x16x32_bf16 v[116:119], v[92:95], v[64:67], v[116:119]
    v_mfma_f32_16x16x32_bf16 v[120:123], v[92:95], v[68:71], v[120:123]
    v_mfma_f32_16x16x32_bf16 v[124:127], v[92:95], v[72:75], v[124:127]
    v_mfma_f32_16x16x32_bf16 v[128:131], v[92:95], v[76:79], v[128:131]
    v_mfma_f32_16x16x32_bf16 v[132:135], v[92:95], v[80:83], v[132:135]
    ds_read_b64_tr_b16 v[92:93], v139 offset:9216
    ds_read_b64_tr_b16 v[94:95], v139 offset:10240
    ds_read_b128 v[64:67], v138 offset:9216
    ds_read_b128 v[68:71], v138 offset:10240
    ds_read_b128 v[72:75], v138 offset:11264
    ds_read_b128 v[76:79], v138 offset:12288
    ds_read_b128 v[80:83], v138 offset:13312
    s_waitcnt lgkmcnt(14)
    v_mfma_f32_16x16x32_bf16 v[116:119], v[84:87], v[24:27], v[116:119]
    v_mfma_f32_16x16x32_bf16 v[120:123], v[84:87], v[28:31], v[120:123]
    v_mfma_f32_16x16x32_bf16 v[124:127], v[84:87], v[32:35], v[124:127]
    v_mfma_f32_16x16x32_bf16 v[128:131], v[84:87], v[36:39], v[128:131]
    v_mfma_f32_16x16x32_bf16 v[132:135], v[84:87], v[40:43], v[132:135]
    s_waitcnt lgkmcnt(7)
    v_mfma_f32_16x16x32_bf16 v[116:119], v[88:91], v[44:47], v[116:119]
    v_mfma_f32_16x16x32_bf16 v[120:123], v[88:91], v[48:51], v[120:123]
    v_mfma_f32_16x16x32_bf16 v[124:127], v[88:91], v[52:55], v[124:127]
    v_mfma_f32_16x16x32_bf16 v[128:131], v[88:91], v[56:59], v[128:131]
    v_mfma_f32_16x16x32_bf16 v[132:135], v[88:91], v[60:63], v[132:135]
    s_waitcnt lgkmcnt(0)
    v_mfma_f32_16x16x32_bf16 v[116:119], v[92:95], v[64:67], v[116:119]
    v_mfma_f32_16x16x32_bf16 v[120:123], v[92:95], v[68:71], v[120:123]
    v_mfma_f32_16x16x32_bf16 v[124:127], v[92:95], v[72:75], v[124:127]
    v_mfma_f32_16x16x32_bf16 v[128:131], v[92:95], v[76:79], v[128:131]
    v_mfma_f32_16x16x32_bf16 v[132:135], v[92:95], v[80:83], v[132:135]
    s_barrier
    s_waitcnt vmcnt(0)
    s_nop 7
    v_lshlrev_b32 v2, 7, v7
    v_lshrrev_b32 v3, 1, v8
    s_lshl_b32 s29, s24, 1
    v_add_u32 v3, s29, v3
    v_and_b32 v4, 7, v7
    v_xor_b32 v3, v3, v4
    v_lshlrev_b32 v3, 4, v3
    v_add_u32 v2, v2, v3
    v_and_b32 v3, 1, v8
    v_lshlrev_b32 v3, 3, v3
    v_add_u32 v2, v2, v3
    v_sub_f32 v116, v116, v96
    v_sub_f32 v117, v117, v97
    v_sub_f32 v118, v118, v98
    v_sub_f32 v119, v119, v99
    v_fmac_f32 v96, v18, v116
    v_fmac_f32 v97, v18, v117
    v_fmac_f32 v98, v18, v118
    v_fmac_f32 v99, v18, v119
    v_cvt_pk_bf16_f32 v136, v96, v97
    v_cvt_pk_bf16_f32 v137, v98, v99
    ds_write_b64 v2, v[136:137] offset:0
    v_sub_f32 v120, v120, v100
    v_sub_f32 v121, v121, v101
    v_sub_f32 v122, v122, v102
    v_sub_f32 v123, v123, v103
    v_fmac_f32 v100, v19, v120
    v_fmac_f32 v101, v19, v121
    v_fmac_f32 v102, v19, v122
    v_fmac_f32 v103, v19, v123
    v_cvt_pk_bf16_f32 v136, v100, v101
    v_cvt_pk_bf16_f32 v137, v102, v103
    ds_write_b64 v2, v[136:137] offset:2048
    v_sub_f32 v124, v124, v104
    v_sub_f32 v125, v125, v105
    v_sub_f32 v126, v126, v106
    v_sub_f32 v127, v127, v107
    v_fmac_f32 v104, v20, v124
    v_fmac_f32 v105, v20, v125
    v_fmac_f32 v106, v20, v126
    v_fmac_f32 v107, v20, v127
    v_cvt_pk_bf16_f32 v136, v104, v105
    v_cvt_pk_bf16_f32 v137, v106, v107
    ds_write_b64 v2, v[136:137] offset:4096
    v_sub_f32 v128, v128, v108
    v_sub_f32 v129, v129, v109
    v_sub_f32 v130, v130, v110
    v_sub_f32 v131, v131, v111
    v_fmac_f32 v108, v21, v128
    v_fmac_f32 v109, v21, v129
    v_fmac_f32 v110, v21, v130
    v_fmac_f32 v111, v21, v131
    v_cvt_pk_bf16_f32 v136, v108, v109
    v_cvt_pk_bf16_f32 v137, v110, v111
    ds_write_b64 v2, v[136:137] offset:6144
    v_sub_f32 v132, v132, v112
    v_sub_f32 v133, v133, v113
    v_sub_f32 v134, v134, v114
    v_sub_f32 v135, v135, v115
    v_fmac_f32 v112, v22, v132
    v_fmac_f32 v113, v22, v133
    v_fmac_f32 v114, v22, v134
    v_fmac_f32 v115, v22, v135
    v_cvt_pk_bf16_f32 v136, v112, v113
    v_cvt_pk_bf16_f32 v137, v114, v115
    ds_write_b64 v2, v[136:137] offset:8192
    s_waitcnt lgkmcnt(0)
    s_barrier
    s_branch L_op_store
L_op_idle:
    s_barrier
    s_barrier
    s_barrier
    s_barrier
    s_barrier
    s_barrier
    s_barrier
    s_barrier
    s_barrier
    s_barrier
    s_barrier
    s_branch L_op_store
L_op_loader:
    s_sub_u32 s24, s24, 8
    v_lshrrev_b32 v2, 1, v8
    v_lshlrev_b32 v13, 16, v2
    v_and_b32 v2, 1, v8
    v_lshlrev_b32 v2, 9, v2
    v_add_u32 v13, v13, v2
    v_lshlrev_b32 v2, 4, v7
    v_add_u32 v13, v13, v2
    s_lshl_b32 s29, s24, 6
    v_add_u32 v2, s29, v1
    v_lshrrev_b32 v3, 3, v2
    v_and_b32 v4, 7, v2
    v_lshrrev_b32 v5, 1, v4
    v_bfe_u32 v6, v3, 1, 2
    v_xor_b32 v5, v5, v6
    v_lshlrev_b32 v5, 1, v5
    v_and_b32 v4, 1, v4
    v_add_u32 v5, v5, v4
    v_lshlrev_b32 v5, 4, v5
    s_lshl_b32 s29, s26, 7
    v_add_u32 v5, s29, v5
    v_lshrrev_b32 v4, 4, v3
    v_mul_u32_u24 v4, 18, v4
    v_and_b32 v6, 15, v3
    v_add_u32 v4, v4, v6
    v_mul_u32_u24 v4, 1152, v4
    v_add_u32 v14, v4, v5
    v_lshrrev_b32 v4, 4, v3
    v_lshlrev_b32 v4, 3, v4
    v_bfe_u32 v6, v3, 2, 1
    v_lshlrev_b32 v6, 2, v6
    v_add_u32 v4, v4, v6
    v_bfe_u32 v6, v3, 3, 1
    v_lshlrev_b32 v6, 1, v6
    v_add_u32 v4, v4, v6
    v_bfe_u32 v6, v3, 1, 1
    v_add_u32 v4, v4, v6
    v_mul_u32_u24 v4, 18, v4
    v_and_b32 v6, 1, v3
    v_add_u32 v4, v4, v6
    v_add_u32 v4, 16, v4
    v_mul_u32_u24 v4, 1152, v4
    v_add_u32 v15, v4, v5
    s_add_u32 s29, s27, 0
    s_min_u32 s29, s29, 127
    s_lshr_b32 s30, s29, 1
    s_lshl_b32 s30, s30, 10
    s_and_b32 s29, s29, 1
    s_lshl_b32 s29, s29, 8
    s_add_u32 s48, s29, s30
    s_add_u32 s29, s27, 1
    s_min_u32 s29, s29, 127
    s_lshr_b32 s30, s29, 1
    s_lshl_b32 s30, s30, 10
    s_and_b32 s29, s29, 1
    s_lshl_b32 s29, s29, 8
    s_add_u32 s49, s29, s30
    s_add_u32 s29, s27, 2
    s_min_u32 s29, s29, 127
    s_lshr_b32 s30, s29, 1
    s_lshl_b32 s30, s30, 10
    s_and_b32 s29, s29, 1
    s_lshl_b32 s29, s29, 8
    s_add_u32 s50, s29, s30
    s_add_u32 s29, s27, 3
    s_min_u32 s29, s29, 127
    s_lshr_b32 s30, s29, 1
    s_lshl_b32 s30, s30, 10
    s_and_b32 s29, s29, 1
    s_lshl_b32 s29, s29, 8
    s_add_u32 s51, s29, s30
    s_add_u32 s29, s27, 4
    s_min_u32 s29, s29, 127
    s_lshr_b32 s30, s29, 1
    s_lshl_b32 s30, s30, 10
    s_and_b32 s29, s29, 1
    s_lshl_b32 s29, s29, 8
    s_add_u32 s52, s29, s30
    s_cmp_eq_u32 s24, 0
    s_cbranch_scc0 L_op_ld1_entry
    s_mov_b32 m0, 5120
    s_mov_b32 s29, 0
    buffer_load_dwordx4 v14, s[16:19], s29 offen lds
    s_mov_b32 m0, 0
    s_add_u32 s29, s48, 16777216
    buffer_load_dwordx4 v13, s[8:11], s29 offen sc1 lds
    s_mov_b32 m0, 4096
    s_add_u32 s29, s52, 16777216
    buffer_load_dwordx4 v13, s[8:11], s29 offen sc1 lds
    s_mov_b32 m0, 14336
    s_mov_b32 s29, 41472
    buffer_load_dwordx4 v14, s[16:19], s29 offen lds
    s_mov_b32 m0, 9216
    s_add_u32 s29, s48, 16908288
    buffer_load_dwordx4 v13, s[8:11], s29 offen sc1 lds
    s_mov_b32 m0, 23552
    s_mov_b32 s29, 82944
    buffer_load_dwordx4 v14, s[16:19], s29 offen lds
    s_mov_b32 m0, 18432
    s_add_u32 s29, s48, 17039360
    buffer_load_dwordx4 v13, s[8:11], s29 offen sc1 lds
    s_mov_b32 m0, 32768
    s_mov_b32 s29, 124416
    buffer_load_dwordx4 v14, s[16:19], s29 offen lds
    s_mov_b32 m0, 27648
    s_add_u32 s29, s48, 17170432
    buffer_load_dwordx4 v13, s[8:11], s29 offen sc1 lds
    s_mov_b32 m0, 41984
    s_mov_b32 s29, 165888
    buffer_load_dwordx4 v14, s[16:19], s29 offen lds
    s_mov_b32 m0, 36864
    s_add_u32 s29, s48, 17301504
    buffer_load_dwordx4 v13, s[8:11], s29 offen sc1 lds
    s_mov_b32 m0, 40960
    s_add_u32 s29, s52, 17301504
    buffer_load_dwordx4 v13, s[8:11], s29 offen sc1 lds
    s_mov_b32 m0, 51200
    s_mov_b32 s29, 207360
    buffer_load_dwordx4 v14, s[16:19], s29 offen lds
    s_mov_b32 m0, 46080
    s_add_u32 s29, s48, 17432576
    buffer_load_dwordx4 v13, s[8:11], s29 offen sc1 lds
    s_mov_b32 m0, 60416
    s_mov_b32 s29, 248832
    buffer_load_dwordx4 v14, s[16:19], s29 offen lds
    s_mov_b32 m0, 55296
    s_add_u32 s29, s48, 17563648
    buffer_load_dwordx4 v13, s[8:11], s29 offen sc1 lds
    s_mov_b32 m0, 69632
    s_mov_b32 s29, 290304
    buffer_load_dwordx4 v14, s[16:19], s29 offen lds
    s_mov_b32 m0, 64512
    s_add_u32 s29, s48, 17694720
    buffer_load_dwordx4 v13, s[8:11], s29 offen sc1 lds
    s_mov_b32 m0, 78848
    s_mov_b32 s29, 331776
    buffer_load_dwordx4 v14, s[16:19], s29 offen lds
    s_mov_b32 m0, 73728
    s_add_u32 s29, s48, 17825792
    buffer_load_dwordx4 v13, s[8:11], s29 offen sc1 lds
    s_mov_b32 m0, 77824
    s_add_u32 s29, s52, 17825792
    buffer_load_dwordx4 v13, s[8:11], s29 offen sc1 lds
    s_mov_b32 m0, 88064
    s_mov_b32 s29, 373248
    buffer_load_dwordx4 v14, s[16:19], s29 offen lds
    s_mov_b32 m0, 82944
    s_add_u32 s29, s48, 17956864
    buffer_load_dwordx4 v13, s[8:11], s29 offen sc1 lds
    s_mov_b32 m0, 97280
    s_mov_b32 s29, 414720
    buffer_load_dwordx4 v14, s[16:19], s29 offen lds
    s_mov_b32 m0, 92160
    s_add_u32 s29, s48, 18087936
    buffer_load_dwordx4 v13, s[8:11], s29 offen sc1 lds
    s_mov_b32 m0, 106496
    s_mov_b32 s29, 456192
    buffer_load_dwordx4 v14, s[16:19], s29 offen lds
    s_mov_b32 m0, 101376
    s_add_u32 s29, s48, 18219008
    buffer_load_dwordx4 v13, s[8:11], s29 offen sc1 lds
    s_waitcnt vmcnt(13)
    s_barrier
    s_mov_b32 m0, 115712
    s_mov_b32 s29, 497664
    buffer_load_dwordx4 v14, s[16:19], s29 offen lds
    s_mov_b32 m0, 110592
    s_add_u32 s29, s48, 18350080
    buffer_load_dwordx4 v13, s[8:11], s29 offen sc1 lds
    s_mov_b32 m0, 114688
    s_add_u32 s29, s52, 18350080
    buffer_load_dwordx4 v13, s[8:11], s29 offen sc1 lds
    s_mov_b32 m0, 124928
    s_mov_b32 s29, 539136
    buffer_load_dwordx4 v14, s[16:19], s29 offen lds
    s_mov_b32 m0, 119808
    s_add_u32 s29, s48, 18481152
    buffer_load_dwordx4 v13, s[8:11], s29 offen sc1 lds
    s_mov_b32 m0, 134144
    s_mov_b32 s29, 580608
    buffer_load_dwordx4 v14, s[16:19], s29 offen lds
    s_mov_b32 m0, 129024
    s_add_u32 s29, s48, 18612224
    buffer_load_dwordx4 v13, s[8:11], s29 offen sc1 lds
    s_mov_b32 m0, 143360
    s_mov_b32 s29, 622080
    buffer_load_dwordx4 v14, s[16:19], s29 offen lds
    s_mov_b32 m0, 138240
    s_add_u32 s29, s48, 18743296
    buffer_load_dwordx4 v13, s[8:11], s29 offen sc1 lds
    s_waitcnt vmcnt(13)
    s_barrier
    s_mov_b32 m0, 5120
    s_mov_b32 s29, 0
    buffer_load_dwordx4 v15, s[16:19], s29 offen lds
    s_mov_b32 m0, 0
    s_add_u32 s29, s48, 18874368
    buffer_load_dwordx4 v13, s[8:11], s29 offen sc1 lds
    s_mov_b32 m0, 4096
    s_add_u32 s29, s52, 18874368
    buffer_load_dwordx4 v13, s[8:11], s29 offen sc1 lds
    s_mov_b32 m0, 14336
    s_mov_b32 s29, 331776
    buffer_load_dwordx4 v15, s[16:19], s29 offen lds
    s_mov_b32 m0, 9216
    s_add_u32 s29, s48, 19005440
    buffer_load_dwordx4 v13, s[8:11], s29 offen sc1 lds
    s_mov_b32 m0, 23552
    s_mov_b32 s29, 0
    buffer_load_dwordx4 v14, s[12:15], s29 offen lds
    s_mov_b32 m0, 18432
    s_add_u32 s29, s48, 19136512
    buffer_load_dwordx4 v13, s[8:11], s29 offen sc1 lds
    s_mov_b32 m0, 32768
    s_mov_b32 s29, 41472
    buffer_load_dwordx4 v14, s[12:15], s29 offen lds
    s_mov_b32 m0, 27648
    s_add_u32 s29, s48, 19267584
    buffer_load_dwordx4 v13, s[8:11], s29 offen sc1 lds
    s_waitcnt vmcnt(13)
    s_barrier
    s_mov_b32 m0, 41984
    s_mov_b32 s29, 82944
    buffer_load_dwordx4 v14, s[12:15], s29 offen lds
    s_mov_b32 m0, 36864
    s_add_u32 s29, s48, 19398656
    buffer_load_dwordx4 v13, s[8:11], s29 offen sc1 lds
    s_mov_b32 m0, 40960
    s_add_u32 s29, s52, 19398656
    buffer_load_dwordx4 v13, s[8:11], s29 offen sc1 lds
    s_mov_b32 m0, 51200
    s_mov_b32 s29, 124416
    buffer_load_dwordx4 v14, s[12:15], s29 offen lds
    s_mov_b32 m0, 46080
    s_add_u32 s29, s48, 19529728
    buffer_load_dwordx4 v13, s[8:11], s29 offen sc1 lds
    s_mov_b32 m0, 60416
    s_mov_b32 s29, 165888
    buffer_load_dwordx4 v14, s[12:15], s29 offen lds
    s_mov_b32 m0, 55296
    s_add_u32 s29, s48, 19660800
    buffer_load_dwordx4 v13, s[8:11], s29 offen sc1 lds
    s_mov_b32 m0, 69632
    s_mov_b32 s29, 207360
    buffer_load_dwordx4 v14, s[12:15], s29 offen lds
    s_mov_b32 m0, 64512
    s_add_u32 s29, s48, 19791872
    buffer_load_dwordx4 v13, s[8:11], s29 offen sc1 lds
    s_waitcnt vmcnt(13)
    s_barrier
    s_mov_b32 m0, 78848
    s_mov_b32 s29, 248832
    buffer_load_dwordx4 v14, s[12:15], s29 offen lds
    s_mov_b32 m0, 73728
    s_add_u32 s29, s48, 19922944
    buffer_load_dwordx4 v13, s[8:11], s29 offen sc1 lds
    s_mov_b32 m0, 77824
    s_add_u32 s29, s52, 19922944
    buffer_load_dwordx4 v13, s[8:11], s29 offen sc1 lds
    s_mov_b32 m0, 88064
    s_mov_b32 s29, 290304
    buffer_load_dwordx4 v14, s[12:15], s29 offen lds
    s_mov_b32 m0, 82944
    s_add_u32 s29, s48, 20054016
    buffer_load_dwordx4 v13, s[8:11], s29 offen sc1 lds
    s_mov_b32 m0, 97280
    s_mov_b32 s29, 331776
    buffer_load_dwordx4 v14, s[12:15], s29 offen lds
    s_mov_b32 m0, 92160
    s_add_u32 s29, s48, 20185088
    buffer_load_dwordx4 v13, s[8:11], s29 offen sc1 lds
    s_mov_b32 m0, 106496
    s_mov_b32 s29, 373248
    buffer_load_dwordx4 v14, s[12:15], s29 offen lds
    s_mov_b32 m0, 101376
    s_add_u32 s29, s48, 20316160
    buffer_load_dwordx4 v13, s[8:11], s29 offen sc1 lds
    s_waitcnt vmcnt(13)
    s_barrier
    s_mov_b32 m0, 115712
    s_mov_b32 s29, 414720
    buffer_load_dwordx4 v14, s[12:15], s29 offen lds
    s_mov_b32 m0, 110592
    s_add_u32 s29, s48, 20447232
    buffer_load_dwordx4 v13, s[8:11], s29 offen sc1 lds
    s_mov_b32 m0, 114688
    s_add_u32 s29, s52, 20447232
    buffer_load_dwordx4 v13, s[8:11], s29 offen sc1 lds
    s_mov_b32 m0, 124928
    s_mov_b32 s29, 456192
    buffer_load_dwordx4 v14, s[12:15], s29 offen lds
    s_mov_b32 m0, 119808
    s_add_u32 s29, s48, 20578304
    buffer_load_dwordx4 v13, s[8:11], s29 offen sc1 lds
    s_mov_b32 m0, 134144
    s_mov_b32 s29, 497664
    buffer_load_dwordx4 v14, s[12:15], s29 offen lds
    s_mov_b32 m0, 129024
    s_add_u32 s29, s48, 20709376
    buffer_load_dwordx4 v13, s[8:11], s29 offen sc1 lds
    s_mov_b32 m0, 143360
    s_mov_b32 s29, 539136
    buffer_load_dwordx4 v14, s[12:15], s29 offen lds
    s_mov_b32 m0, 138240
    s_add_u32 s29, s48, 20840448
    buffer_load_dwordx4 v13, s[8:11], s29 offen sc1 lds
    s_waitcnt vmcnt(13)
    s_barrier
    s_mov_b32 m0, 5120
    s_mov_b32 s29, 580608
    buffer_load_dwordx4 v14, s[12:15], s29 offen lds
    s_mov_b32 m0, 0
    s_add_u32 s29, s48, 20971520
    buffer_load_dwordx4 v13, s[8:11], s29 offen sc1 lds
    s_mov_b32 m0, 4096
    s_add_u32 s29, s52, 20971520
    buffer_load_dwordx4 v13, s[8:11], s29 offen sc1 lds
    s_mov_b32 m0, 14336
    s_mov_b32 s29, 622080
    buffer_load_dwordx4 v14, s[12:15], s29 offen lds
    s_mov_b32 m0, 9216
    s_add_u32 s29, s48, 21102592
    buffer_load_dwordx4 v13, s[8:11], s29 offen sc1 lds
    s_mov_b32 m0, 23552
    s_mov_b32 s29, 0
    buffer_load_dwordx4 v15, s[12:15], s29 offen lds
    s_mov_b32 m0, 18432
    s_add_u32 s29, s48, 21233664
    buffer_load_dwordx4 v13, s[8:11], s29 offen sc1 lds
    s_mov_b32 m0, 32768
    s_mov_b32 s29, 331776
    buffer_load_dwordx4 v15, s[12:15], s29 offen lds
    s_mov_b32 m0, 27648
    s_add_u32 s29, s48, 21364736
    buffer_load_dwordx4 v13, s[8:11], s29 offen sc1 lds
    s_waitcnt vmcnt(13)
    s_barrier
    s_waitcnt vmcnt(4)
    s_barrier
    s_waitcnt vmcnt(0)
    s_barrier
    s_barrier
    s_barrier
    s_branch L_op_store_ld
L_op_ld1_entry:
    s_cmp_eq_u32 s24, 1
    s_cbranch_scc0 L_op_ld2_entry
    s_mov_b32 m0, 6144
    s_mov_b32 s29, 0
    buffer_load_dwordx4 v14, s[16:19], s29 offen lds
    s_mov_b32 m0, 1024
    s_add_u32 s29, s49, 16777216
    buffer_load_dwordx4 v13, s[8:11], s29 offen sc1 lds
    s_mov_b32 m0, 15360
    s_mov_b32 s29, 41472
    buffer_load_dwordx4 v14, s[16:19], s29 offen lds
    s_mov_b32 m0, 10240
    s_add_u32 s29, s49, 16908288
    buffer_load_dwordx4 v13, s[8:11], s29 offen sc1 lds
    s_mov_b32 m0, 13312
    s_add_u32 s29, s52, 16908288
    buffer_load_dwordx4 v13, s[8:11], s29 offen sc1 lds
    s_mov_b32 m0, 24576
    s_mov_b32 s29, 82944
    buffer_load_dwordx4 v14, s[16:19], s29 offen lds
    s_mov_b32 m0, 19456
    s_add_u32 s29, s49, 17039360
    buffer_load_dwordx4 v13, s[8:11], s29 offen sc1 lds
    s_mov_b32 m0, 33792
    s_mov_b32 s29, 124416
    buffer_load_dwordx4 v14, s[16:19], s29 offen lds
    s_mov_b32 m0, 28672
    s_add_u32 s29, s49, 17170432
    buffer_load_dwordx4 v13, s[8:11], s29 offen sc1 lds
    s_mov_b32 m0, 43008
    s_mov_b32 s29, 165888
    buffer_load_dwordx4 v14, s[16:19], s29 offen lds
    s_mov_b32 m0, 37888
    s_add_u32 s29, s49, 17301504
    buffer_load_dwordx4 v13, s[8:11], s29 offen sc1 lds
    s_mov_b32 m0, 52224
    s_mov_b32 s29, 207360
    buffer_load_dwordx4 v14, s[16:19], s29 offen lds
    s_mov_b32 m0, 47104
    s_add_u32 s29, s49, 17432576
    buffer_load_dwordx4 v13, s[8:11], s29 offen sc1 lds
    s_mov_b32 m0, 50176
    s_add_u32 s29, s52, 17432576
    buffer_load_dwordx4 v13, s[8:11], s29 offen sc1 lds
    s_mov_b32 m0, 61440
    s_mov_b32 s29, 248832
    buffer_load_dwordx4 v14, s[16:19], s29 offen lds
    s_mov_b32 m0, 56320
    s_add_u32 s29, s49, 17563648
    buffer_load_dwordx4 v13, s[8:11], s29 offen sc1 lds
    s_mov_b32 m0, 70656
    s_mov_b32 s29, 290304
    buffer_load_dwordx4 v14, s[16:19], s29 offen lds
    s_mov_b32 m0, 65536
    s_add_u32 s29, s49, 17694720
    buffer_load_dwordx4 v13, s[8:11], s29 offen sc1 lds
    s_mov_b32 m0, 79872
    s_mov_b32 s29, 331776
    buffer_load_dwordx4 v14, s[16:19], s29 offen lds
    s_mov_b32 m0, 74752
    s_add_u32 s29, s49, 17825792
    buffer_load_dwordx4 v13, s[8:11], s29 offen sc1 lds
    s_mov_b32 m0, 89088
    s_mov_b32 s29, 373248
    buffer_load_dwordx4 v14, s[16:19], s29 offen lds
    s_mov_b32 m0, 83968
    s_add_u32 s29, s49, 17956864
    buffer_load_dwordx4 v13, s[8:11], s29 offen sc1 lds
    s_mov_b32 m0, 87040
    s_add_u32 s29, s52, 17956864
    buffer_load_dwordx4 v13, s[8:11], s29 offen sc1 lds
    s_mov_b32 m0, 98304
    s_mov_b32 s29, 414720
    buffer_load_dwordx4 v14, s[16:19], s29 offen lds
    s_mov_b32 m0, 93184
    s_add_u32 s29, s49, 18087936
    buffer_load_dwordx4 v13, s[8:11], s29 offen sc1 lds
    s_mov_b32 m0, 107520
    s_mov_b32 s29, 456192
    buffer_load_dwordx4 v14, s[16:19], s29 offen lds
    s_mov_b32 m0, 102400
    s_add_u32 s29, s49, 18219008
    buffer_load_dwordx4 v13, s[8:11], s29 offen sc1 lds
    s_waitcnt vmcnt(13)
    s_barrier
    s_mov_b32 m0, 116736
    s_mov_b32 s29, 497664
    buffer_load_dwordx4 v14, s[16:19], s29 offen lds
    s_mov_b32 m0, 111616
    s_add_u32 s29, s49, 18350080
    buffer_load_dwordx4 v13, s[8:11], s29 offen sc1 lds
    s_mov_b32 m0, 125952
    s_mov_b32 s29, 539136
    buffer_load_dwordx4 v14, s[16:19], s29 offen lds
    s_mov_b32 m0, 120832
    s_add_u32 s29, s49, 18481152
    buffer_load_dwordx4 v13, s[8:11], s29 offen sc1 lds
    s_mov_b32 m0, 123904
    s_add_u32 s29, s52, 18481152
    buffer_load_dwordx4 v13, s[8:11], s29 offen sc1 lds
    s_mov_b32 m0, 135168
    s_mov_b32 s29, 580608
    buffer_load_dwordx4 v14, s[16:19], s29 offen lds
    s_mov_b32 m0, 130048
    s_add_u32 s29, s49, 18612224
    buffer_load_dwordx4 v13, s[8:11], s29 offen sc1 lds
    s_mov_b32 m0, 144384
    s_mov_b32 s29, 622080
    buffer_load_dwordx4 v14, s[16:19], s29 offen lds
    s_mov_b32 m0, 139264
    s_add_u32 s29, s49, 18743296
    buffer_load_dwordx4 v13, s[8:11], s29 offen sc1 lds
    s_waitcnt vmcnt(13)
    s_barrier
    s_mov_b32 m0, 6144
    s_mov_b32 s29, 0
    buffer_load_dwordx4 v15, s[16:19], s29 offen lds
    s_mov_b32 m0, 1024
    s_add_u32 s29, s49, 18874368
    buffer_load_dwordx4 v13, s[8:11], s29 offen sc1 lds
    s_mov_b32 m0, 15360
    s_mov_b32 s29, 331776
    buffer_load_dwordx4 v15, s[16:19], s29 offen lds
    s_mov_b32 m0, 10240
    s_add_u32 s29, s49, 19005440
    buffer_load_dwordx4 v13, s[8:11], s29 offen sc1 lds
    s_mov_b32 m0, 13312
    s_add_u32 s29, s52, 19005440
    buffer_load_dwordx4 v13, s[8:11], s29 offen sc1 lds
    s_mov_b32 m0, 24576
    s_mov_b32 s29, 0
    buffer_load_dwordx4 v14, s[12:15], s29 offen lds
    s_mov_b32 m0, 19456
    s_add_u32 s29, s49, 19136512
    buffer_load_dwordx4 v13, s[8:11], s29 offen sc1 lds
    s_mov_b32 m0, 33792
    s_mov_b32 s29, 41472
    buffer_load_dwordx4 v14, s[12:15], s29 offen lds
    s_mov_b32 m0, 28672
    s_add_u32 s29, s49, 19267584
    buffer_load_dwordx4 v13, s[8:11], s29 offen sc1 lds
    s_waitcnt vmcnt(13)
    s_barrier
    s_mov_b32 m0, 43008
    s_mov_b32 s29, 82944
    buffer_load_dwordx4 v14, s[12:15], s29 offen lds
    s_mov_b32 m0, 37888
    s_add_u32 s29, s49, 19398656
    buffer_load_dwordx4 v13, s[8:11], s29 offen sc1 lds
    s_mov_b32 m0, 52224
    s_mov_b32 s29, 124416
    buffer_load_dwordx4 v14, s[12:15], s29 offen lds
    s_mov_b32 m0, 47104
    s_add_u32 s29, s49, 19529728
    buffer_load_dwordx4 v13, s[8:11], s29 offen sc1 lds
    s_mov_b32 m0, 50176
    s_add_u32 s29, s52, 19529728
    buffer_load_dwordx4 v13, s[8:11], s29 offen sc1 lds
    s_mov_b32 m0, 61440
    s_mov_b32 s29, 165888
    buffer_load_dwordx4 v14, s[12:15], s29 offen lds
    s_mov_b32 m0, 56320
    s_add_u32 s29, s49, 19660800
    buffer_load_dwordx4 v13, s[8:11], s29 offen sc1 lds
    s_mov_b32 m0, 70656
    s_mov_b32 s29, 207360
    buffer_load_dwordx4 v14, s[12:15], s29 offen lds
    s_mov_b32 m0, 65536
    s_add_u32 s29, s49, 19791872
    buffer_load_dwordx4 v13, s[8:11], s29 offen sc1 lds
    s_waitcnt vmcnt(13)
    s_barrier
    s_mov_b32 m0, 79872
    s_mov_b32 s29, 248832
    buffer_load_dwordx4 v14, s[12:15], s29 offen lds
    s_mov_b32 m0, 74752
    s_add_u32 s29, s49, 19922944
    buffer_load_dwordx4 v13, s[8:11], s29 offen sc1 lds
    s_mov_b32 m0, 89088
    s_mov_b32 s29, 290304
    buffer_load_dwordx4 v14, s[12:15], s29 offen lds
    s_mov_b32 m0, 83968
    s_add_u32 s29, s49, 20054016
    buffer_load_dwordx4 v13, s[8:11], s29 offen sc1 lds
    s_mov_b32 m0, 87040
    s_add_u32 s29, s52, 20054016
    buffer_load_dwordx4 v13, s[8:11], s29 offen sc1 lds
    s_mov_b32 m0, 98304
    s_mov_b32 s29, 331776
    buffer_load_dwordx4 v14, s[12:15], s29 offen lds
    s_mov_b32 m0, 93184
    s_add_u32 s29, s49, 20185088
    buffer_load_dwordx4 v13, s[8:11], s29 offen sc1 lds
    s_mov_b32 m0, 107520
    s_mov_b32 s29, 373248
    buffer_load_dwordx4 v14, s[12:15], s29 offen lds
    s_mov_b32 m0, 102400
    s_add_u32 s29, s49, 20316160
    buffer_load_dwordx4 v13, s[8:11], s29 offen sc1 lds
    s_waitcnt vmcnt(13)
    s_barrier
    s_mov_b32 m0, 116736
    s_mov_b32 s29, 414720
    buffer_load_dwordx4 v14, s[12:15], s29 offen lds
    s_mov_b32 m0, 111616
    s_add_u32 s29, s49, 20447232
    buffer_load_dwordx4 v13, s[8:11], s29 offen sc1 lds
    s_mov_b32 m0, 125952
    s_mov_b32 s29, 456192
    buffer_load_dwordx4 v14, s[12:15], s29 offen lds
    s_mov_b32 m0, 120832
    s_add_u32 s29, s49, 20578304
    buffer_load_dwordx4 v13, s[8:11], s29 offen sc1 lds
    s_mov_b32 m0, 123904
    s_add_u32 s29, s52, 20578304
    buffer_load_dwordx4 v13, s[8:11], s29 offen sc1 lds
    s_mov_b32 m0, 135168
    s_mov_b32 s29, 497664
    buffer_load_dwordx4 v14, s[12:15], s29 offen lds
    s_mov_b32 m0, 130048
    s_add_u32 s29, s49, 20709376
    buffer_load_dwordx4 v13, s[8:11], s29 offen sc1 lds
    s_mov_b32 m0, 144384
    s_mov_b32 s29, 539136
    buffer_load_dwordx4 v14, s[12:15], s29 offen lds
    s_mov_b32 m0, 139264
    s_add_u32 s29, s49, 20840448
    buffer_load_dwordx4 v13, s[8:11], s29 offen sc1 lds
    s_waitcnt vmcnt(13)
    s_barrier
    s_mov_b32 m0, 6144
    s_mov_b32 s29, 580608
    buffer_load_dwordx4 v14, s[12:15], s29 offen lds
    s_mov_b32 m0, 1024
    s_add_u32 s29, s49, 20971520
    buffer_load_dwordx4 v13, s[8:11], s29 offen sc1 lds
    s_mov_b32 m0, 15360
    s_mov_b32 s29, 622080
    buffer_load_dwordx4 v14, s[12:15], s29 offen lds
    s_mov_b32 m0, 10240
    s_add_u32 s29, s49, 21102592
    buffer_load_dwordx4 v13, s[8:11], s29 offen sc1 lds
    s_mov_b32 m0, 13312
    s_add_u32 s29, s52, 21102592
    buffer_load_dwordx4 v13, s[8:11], s29 offen sc1 lds
    s_mov_b32 m0, 24576
    s_mov_b32 s29, 0
    buffer_load_dwordx4 v15, s[12:15], s29 offen lds
    s_mov_b32 m0, 19456
    s_add_u32 s29, s49, 21233664
    buffer_load_dwordx4 v13, s[8:11], s29 offen sc1 lds
    s_mov_b32 m0, 33792
    s_mov_b32 s29, 331776
    buffer_load_dwordx4 v15, s[12:15], s29 offen lds
    s_mov_b32 m0, 28672
    s_add_u32 s29, s49, 21364736
    buffer_load_dwordx4 v13, s[8:11], s29 offen sc1 lds
    s_waitcnt vmcnt(13)
    s_barrier
    s_waitcnt vmcnt(4)
    s_barrier
    s_waitcnt vmcnt(0)
    s_barrier
    s_barrier
    s_barrier
    s_branch L_op_store_ld
L_op_ld2_entry:
    s_cmp_eq_u32 s24, 2
    s_cbranch_scc0 L_op_ld3_entry
    s_mov_b32 m0, 7168
    s_mov_b32 s29, 0
    buffer_load_dwordx4 v14, s[16:19], s29 offen lds
    s_mov_b32 m0, 2048
    s_add_u32 s29, s50, 16777216
    buffer_load_dwordx4 v13, s[8:11], s29 offen sc1 lds
    s_mov_b32 m0, 16384
    s_mov_b32 s29, 41472
    buffer_load_dwordx4 v14, s[16:19], s29 offen lds
    s_mov_b32 m0, 11264
    s_add_u32 s29, s50, 16908288
    buffer_load_dwordx4 v13, s[8:11], s29 offen sc1 lds
    s_mov_b32 m0, 25600
    s_mov_b32 s29, 82944
    buffer_load_dwordx4 v14, s[16:19], s29 offen lds
    s_mov_b32 m0, 20480
    s_add_u32 s29, s50, 17039360
    buffer_load_dwordx4 v13, s[8:11], s29 offen sc1 lds
    s_mov_b32 m0, 22528
    s_add_u32 s29, s52, 17039360
    buffer_load_dwordx4 v13, s[8:11], s29 offen sc1 lds
    s_mov_b32 m0, 34816
    s_mov_b32 s29, 124416
    buffer_load_dwordx4 v14, s[16:19], s29 offen lds
    s_mov_b32 m0, 29696
    s_add_u32 s29, s50, 17170432
    buffer_load_dwordx4 v13, s[8:11], s29 offen sc1 lds
    s_mov_b32 m0, 44032
    s_mov_b32 s29, 165888
    buffer_load_dwordx4 v14, s[16:19], s29 offen lds
    s_mov_b32 m0, 38912
    s_add_u32 s29, s50, 17301504
    buffer_load_dwordx4 v13, s[8:11], s29 offen sc1 lds
    s_mov_b32 m0, 53248
    s_mov_b32 s29, 207360
    buffer_load_dwordx4 v14, s[16:19], s29 offen lds
    s_mov_b32 m0, 48128
    s_add_u32 s29, s50, 17432576
    buffer_load_dwordx4 v13, s[8:11], s29 offen sc1 lds
    s_mov_b32 m0, 62464
    s_mov_b32 s29, 248832
    buffer_load_dwordx4 v14, s[16:19], s29 offen lds
    s_mov_b32 m0, 57344
    s_add_u32 s29, s50, 17563648
    buffer_load_dwordx4 v13, s[8:11], s29 offen sc1 lds
    s_mov_b32 m0, 59392
    s_add_u32 s29, s52, 17563648
    buffer_load_dwordx4 v13, s[8:11], s29 offen sc1 lds
    s_mov_b32 m0, 71680
    s_mov_b32 s29, 290304
    buffer_load_dwordx4 v14, s[16:19], s29 offen lds
    s_mov_b32 m0, 66560
    s_add_u32 s29, s50, 17694720
    buffer_load_dwordx4 v13, s[8:11], s29 offen sc1 lds
    s_mov_b32 m0, 80896
    s_mov_b32 s29, 331776
    buffer_load_dwordx4 v14, s[16:19], s29 offen lds
    s_mov_b32 m0, 75776
    s_add_u32 s29, s50, 17825792
    buffer_load_dwordx4 v13, s[8:11], s29 offen sc1 lds
    s_mov_b32 m0, 90112
    s_mov_b32 s29, 373248
    buffer_load_dwordx4 v14, s[16:19], s29 offen lds
    s_mov_b32 m0, 84992
    s_add_u32 s29, s50, 17956864
    buffer_load_dwordx4 v13, s[8:11], s29 offen sc1 lds
    s_mov_b32 m0, 99328
    s_mov_b32 s29, 414720
    buffer_load_dwordx4 v14, s[16:19], s29 offen lds
    s_mov_b32 m0, 94208
    s_add_u32 s29, s50, 18087936
    buffer_load_dwordx4 v13, s[8:11], s29 offen sc1 lds
    s_mov_b32 m0, 96256
    s_add_u32 s29, s52, 18087936
    buffer_load_dwordx4 v13, s[8:11], s29 offen sc1 lds
    s_mov_b32 m0, 108544
    s_mov_b32 s29, 456192
    buffer_load_dwordx4 v14, s[16:19], s29 offen lds
    s_mov_b32 m0, 103424
    s_add_u32 s29, s50, 18219008
    buffer_load_dwordx4 v13, s[8:11], s29 offen sc1 lds
    s_waitcnt vmcnt(14)
    s_barrier
    s_mov_b32 m0, 117760
    s_mov_b32 s29, 497664
    buffer_load_dwordx4 v14, s[16:19], s29 offen lds
    s_mov_b32 m0, 112640
    s_add_u32 s29, s50, 18350080
    buffer_load_dwordx4 v13, s[8:11], s29 offen sc1 lds
    s_mov_b32 m0, 126976
    s_mov_b32 s29, 539136
    buffer_load_dwordx4 v14, s[16:19], s29 offen lds
    s_mov_b32 m0, 121856
    s_add_u32 s29, s50, 18481152
    buffer_load_dwordx4 v13, s[8:11], s29 offen sc1 lds
    s_mov_b32 m0, 136192
    s_mov_b32 s29, 580608
    buffer_load_dwordx4 v14, s[16:19], s29 offen lds
    s_mov_b32 m0, 131072
    s_add_u32 s29, s50, 18612224
    buffer_load_dwordx4 v13, s[8:11], s29 offen sc1 lds
    s_mov_b32 m0, 133120
    s_add_u32 s29, s52, 18612224
    buffer_load_dwordx4 v13, s[8:11], s29 offen sc1 lds
    s_mov_b32 m0, 145408
    s_mov_b32 s29, 622080
    buffer_load_dwordx4 v14, s[16:19], s29 offen lds
    s_mov_b32 m0, 140288
    s_add_u32 s29, s50, 18743296
    buffer_load_dwordx4 v13, s[8:11], s29 offen sc1 lds
    s_waitcnt vmcnt(14)
    s_barrier
    s_mov_b32 m0, 7168
    s_mov_b32 s29, 0
    buffer_load_dwordx4 v15, s[16:19], s29 offen lds
    s_mov_b32 m0, 2048
    s_add_u32 s29, s50, 18874368
    buffer_load_dwordx4 v13, s[8:11], s29 offen sc1 lds
    s_mov_b32 m0, 16384
    s_mov_b32 s29, 331776
    buffer_load_dwordx4 v15, s[16:19], s29 offen lds
    s_mov_b32 m0, 11264
    s_add_u32 s29, s50, 19005440
    buffer_load_dwordx4 v13, s[8:11], s29 offen sc1 lds
    s_mov_b32 m0, 25600
    s_mov_b32 s29, 0
    buffer_load_dwordx4 v14, s[12:15], s29 offen lds
    s_mov_b32 m0, 20480
    s_add_u32 s29, s50, 19136512
    buffer_load_dwordx4 v13, s[8:11], s29 offen sc1 lds
    s_mov_b32 m0, 22528
    s_add_u32 s29, s52, 19136512
    buffer_load_dwordx4 v13, s[8:11], s29 offen sc1 lds
    s_mov_b32 m0, 34816
    s_mov_b32 s29, 41472
    buffer_load_dwordx4 v14, s[12:15], s29 offen lds
    s_mov_b32 m0, 29696
    s_add_u32 s29, s50, 19267584
    buffer_load_dwordx4 v13, s[8:11], s29 offen sc1 lds
    s_waitcnt vmcnt(14)
    s_barrier
    s_mov_b32 m0, 44032
    s_mov_b32 s29, 82944
    buffer_load_dwordx4 v14, s[12:15], s29 offen lds
    s_mov_b32 m0, 38912
    s_add_u32 s29, s50, 19398656
    buffer_load_dwordx4 v13, s[8:11], s29 offen sc1 lds
    s_mov_b32 m0, 53248
    s_mov_b32 s29, 124416
    buffer_load_dwordx4 v14, s[12:15], s29 offen lds
    s_mov_b32 m0, 48128
    s_add_u32 s29, s50, 19529728
    buffer_load_dwordx4 v13, s[8:11], s29 offen sc1 lds
    s_mov_b32 m0, 62464
    s_mov_b32 s29, 165888
    buffer_load_dwordx4 v14, s[12:15], s29 offen lds
    s_mov_b32 m0, 57344
    s_add_u32 s29, s50, 19660800
    buffer_load_dwordx4 v13, s[8:11], s29 offen sc1 lds
    s_mov_b32 m0, 59392
    s_add_u32 s29, s52, 19660800
    buffer_load_dwordx4 v13, s[8:11], s29 offen sc1 lds
    s_mov_b32 m0, 71680
    s_mov_b32 s29, 207360
    buffer_load_dwordx4 v14, s[12:15], s29 offen lds
    s_mov_b32 m0, 66560
    s_add_u32 s29, s50, 19791872
    buffer_load_dwordx4 v13, s[8:11], s29 offen sc1 lds
    s_waitcnt vmcnt(14)
    s_barrier
    s_mov_b32 m0, 80896
    s_mov_b32 s29, 248832
    buffer_load_dwordx4 v14, s[12:15], s29 offen lds
    s_mov_b32 m0, 75776
    s_add_u32 s29, s50, 19922944
    buffer_load_dwordx4 v13, s[8:11], s29 offen sc1 lds
    s_mov_b32 m0, 90112
    s_mov_b32 s29, 290304
    buffer_load_dwordx4 v14, s[12:15], s29 offen lds
    s_mov_b32 m0, 84992
    s_add_u32 s29, s50, 20054016
    buffer_load_dwordx4 v13, s[8:11], s29 offen sc1 lds
    s_mov_b32 m0, 99328
    s_mov_b32 s29, 331776
    buffer_load_dwordx4 v14, s[12:15], s29 offen lds
    s_mov_b32 m0, 94208
    s_add_u32 s29, s50, 20185088
    buffer_load_dwordx4 v13, s[8:11], s29 offen sc1 lds
    s_mov_b32 m0, 96256
    s_add_u32 s29, s52, 20185088
    buffer_load_dwordx4 v13, s[8:11], s29 offen sc1 lds
    s_mov_b32 m0, 108544
    s_mov_b32 s29, 373248
    buffer_load_dwordx4 v14, s[12:15], s29 offen lds
    s_mov_b32 m0, 103424
    s_add_u32 s29, s50, 20316160
    buffer_load_dwordx4 v13, s[8:11], s29 offen sc1 lds
    s_waitcnt vmcnt(14)
    s_barrier
    s_mov_b32 m0, 117760
    s_mov_b32 s29, 414720
    buffer_load_dwordx4 v14, s[12:15], s29 offen lds
    s_mov_b32 m0, 112640
    s_add_u32 s29, s50, 20447232
    buffer_load_dwordx4 v13, s[8:11], s29 offen sc1 lds
    s_mov_b32 m0, 126976
    s_mov_b32 s29, 456192
    buffer_load_dwordx4 v14, s[12:15], s29 offen lds
    s_mov_b32 m0, 121856
    s_add_u32 s29, s50, 20578304
    buffer_load_dwordx4 v13, s[8:11], s29 offen sc1 lds
    s_mov_b32 m0, 136192
    s_mov_b32 s29, 497664
    buffer_load_dwordx4 v14, s[12:15], s29 offen lds
    s_mov_b32 m0, 131072
    s_add_u32 s29, s50, 20709376
    buffer_load_dwordx4 v13, s[8:11], s29 offen sc1 lds
    s_mov_b32 m0, 133120
    s_add_u32 s29, s52, 20709376
    buffer_load_dwordx4 v13, s[8:11], s29 offen sc1 lds
    s_mov_b32 m0, 145408
    s_mov_b32 s29, 539136
    buffer_load_dwordx4 v14, s[12:15], s29 offen lds
    s_mov_b32 m0, 140288
    s_add_u32 s29, s50, 20840448
    buffer_load_dwordx4 v13, s[8:11], s29 offen sc1 lds
    s_waitcnt vmcnt(14)
    s_barrier
    s_mov_b32 m0, 7168
    s_mov_b32 s29, 580608
    buffer_load_dwordx4 v14, s[12:15], s29 offen lds
    s_mov_b32 m0, 2048
    s_add_u32 s29, s50, 20971520
    buffer_load_dwordx4 v13, s[8:11], s29 offen sc1 lds
    s_mov_b32 m0, 16384
    s_mov_b32 s29, 622080
    buffer_load_dwordx4 v14, s[12:15], s29 offen lds
    s_mov_b32 m0, 11264
    s_add_u32 s29, s50, 21102592
    buffer_load_dwordx4 v13, s[8:11], s29 offen sc1 lds
    s_mov_b32 m0, 25600
    s_mov_b32 s29, 0
    buffer_load_dwordx4 v15, s[12:15], s29 offen lds
    s_mov_b32 m0, 20480
    s_add_u32 s29, s50, 21233664
    buffer_load_dwordx4 v13, s[8:11], s29 offen sc1 lds
    s_mov_b32 m0, 22528
    s_add_u32 s29, s52, 21233664
    buffer_load_dwordx4 v13, s[8:11], s29 offen sc1 lds
    s_mov_b32 m0, 34816
    s_mov_b32 s29, 331776
    buffer_load_dwordx4 v15, s[12:15], s29 offen lds
    s_mov_b32 m0, 29696
    s_add_u32 s29, s50, 21364736
    buffer_load_dwordx4 v13, s[8:11], s29 offen sc1 lds
    s_waitcnt vmcnt(14)
    s_barrier
    s_waitcnt vmcnt(5)
    s_barrier
    s_waitcnt vmcnt(0)
    s_barrier
    s_barrier
    s_barrier
    s_branch L_op_store_ld
L_op_ld3_entry:
    s_mov_b32 m0, 8192
    s_mov_b32 s29, 0
    buffer_load_dwordx4 v14, s[16:19], s29 offen lds
    s_mov_b32 m0, 3072
    s_add_u32 s29, s51, 16777216
    buffer_load_dwordx4 v13, s[8:11], s29 offen sc1 lds
    s_mov_b32 m0, 17408
    s_mov_b32 s29, 41472
    buffer_load_dwordx4 v14, s[16:19], s29 offen lds
    s_mov_b32 m0, 12288
    s_add_u32 s29, s51, 16908288
    buffer_load_dwordx4 v13, s[8:11], s29 offen sc1 lds
    s_mov_b32 m0, 26624
    s_mov_b32 s29, 82944
    buffer_load_dwordx4 v14, s[16:19], s29 offen lds
    s_mov_b32 m0, 21504
    s_add_u32 s29, s51, 17039360
    buffer_load_dwordx4 v13, s[8:11], s29 offen sc1 lds
    s_mov_b32 m0, 35840
    s_mov_b32 s29, 124416
    buffer_load_dwordx4 v14, s[16:19], s29 offen lds
    s_mov_b32 m0, 30720
    s_add_u32 s29, s51, 17170432
    buffer_load_dwordx4 v13, s[8:11], s29 offen sc1 lds
    s_mov_b32 m0, 31744
    s_add_u32 s29, s52, 17170432
    buffer_load_dwordx4 v13, s[8:11], s29 offen sc1 lds
    s_mov_b32 m0, 45056
    s_mov_b32 s29, 165888
    buffer_load_dwordx4 v14, s[16:19], s29 offen lds
    s_mov_b32 m0, 39936
    s_add_u32 s29, s51, 17301504
    buffer_load_dwordx4 v13, s[8:11], s29 offen sc1 lds
    s_mov_b32 m0, 54272
    s_mov_b32 s29, 207360
    buffer_load_dwordx4 v14, s[16:19], s29 offen lds
    s_mov_b32 m0, 49152
    s_add_u32 s29, s51, 17432576
    buffer_load_dwordx4 v13, s[8:11], s29 offen sc1 lds
    s_mov_b32 m0, 63488
    s_mov_b32 s29, 248832
    buffer_load_dwordx4 v14, s[16:19], s29 offen lds
    s_mov_b32 m0, 58368
    s_add_u32 s29, s51, 17563648
    buffer_load_dwordx4 v13, s[8:11], s29 offen sc1 lds
    s_mov_b32 m0, 72704
    s_mov_b32 s29, 290304
    buffer_load_dwordx4 v14, s[16:19], s29 offen lds
    s_mov_b32 m0, 67584
    s_add_u32 s29, s51, 17694720
    buffer_load_dwordx4 v13, s[8:11], s29 offen sc1 lds
    s_mov_b32 m0, 68608
    s_add_u32 s29, s52, 17694720
    buffer_load_dwordx4 v13, s[8:11], s29 offen sc1 lds
    s_mov_b32 m0, 81920
    s_mov_b32 s29, 331776
    buffer_load_dwordx4 v14, s[16:19], s29 offen lds
    s_mov_b32 m0, 76800
    s_add_u32 s29, s51, 17825792
    buffer_load_dwordx4 v13, s[8:11], s29 offen sc1 lds
    s_mov_b32 m0, 91136
    s_mov_b32 s29, 373248
    buffer_load_dwordx4 v14, s[16:19], s29 offen lds
    s_mov_b32 m0, 86016
    s_add_u32 s29, s51, 17956864
    buffer_load_dwordx4 v13, s[8:11], s29 offen sc1 lds
    s_mov_b32 m0, 100352
    s_mov_b32 s29, 414720
    buffer_load_dwordx4 v14, s[16:19], s29 offen lds
    s_mov_b32 m0, 95232
    s_add_u32 s29, s51, 18087936
    buffer_load_dwordx4 v13, s[8:11], s29 offen sc1 lds
    s_mov_b32 m0, 109568
    s_mov_b32 s29, 456192
    buffer_load_dwordx4 v14, s[16:19], s29 offen lds
    s_mov_b32 m0, 104448
    s_add_u32 s29, s51, 18219008
    buffer_load_dwordx4 v13, s[8:11], s29 offen sc1 lds
    s_mov_b32 m0, 105472
    s_add_u32 s29, s52, 18219008
    buffer_load_dwordx4 v13, s[8:11], s29 offen sc1 lds
    s_waitcnt vmcnt(14)
    s_barrier
    s_mov_b32 m0, 118784
    s_mov_b32 s29, 497664
    buffer_load_dwordx4 v14, s[16:19], s29 offen lds
    s_mov_b32 m0, 113664
    s_add_u32 s29, s51, 18350080
    buffer_load_dwordx4 v13, s[8:11], s29 offen sc1 lds
    s_mov_b32 m0, 128000
    s_mov_b32 s29, 539136
    buffer_load_dwordx4 v14, s[16:19], s29 offen lds
    s_mov_b32 m0, 122880
    s_add_u32 s29, s51, 18481152
    buffer_load_dwordx4 v13, s[8:11], s29 offen sc1 lds
    s_mov_b32 m0, 137216
    s_mov_b32 s29, 580608
    buffer_load_dwordx4 v14, s[16:19], s29 offen lds
    s_mov_b32 m0, 132096
    s_add_u32 s29, s51, 18612224
    buffer_load_dwordx4 v13, s[8:11], s29 offen sc1 lds
    s_mov_b32 m0, 146432
    s_mov_b32 s29, 622080
    buffer_load_dwordx4 v14, s[16:19], s29 offen lds
    s_mov_b32 m0, 141312
    s_add_u32 s29, s51, 18743296
    buffer_load_dwordx4 v13, s[8:11], s29 offen sc1 lds
    s_mov_b32 m0, 142336
    s_add_u32 s29, s52, 18743296
    buffer_load_dwordx4 v13, s[8:11], s29 offen sc1 lds
    s_waitcnt vmcnt(14)
    s_barrier
    s_mov_b32 m0, 8192
    s_mov_b32 s29, 0
    buffer_load_dwordx4 v15, s[16:19], s29 offen lds
    s_mov_b32 m0, 3072
    s_add_u32 s29, s51, 18874368
    buffer_load_dwordx4 v13, s[8:11], s29 offen sc1 lds
    s_mov_b32 m0, 17408
    s_mov_b32 s29, 331776
    buffer_load_dwordx4 v15, s[16:19], s29 offen lds
    s_mov_b32 m0, 12288
    s_add_u32 s29, s51, 19005440
    buffer_load_dwordx4 v13, s[8:11], s29 offen sc1 lds
    s_mov_b32 m0, 26624
    s_mov_b32 s29, 0
    buffer_load_dwordx4 v14, s[12:15], s29 offen lds
    s_mov_b32 m0, 21504
    s_add_u32 s29, s51, 19136512
    buffer_load_dwordx4 v13, s[8:11], s29 offen sc1 lds
    s_mov_b32 m0, 35840
    s_mov_b32 s29, 41472
    buffer_load_dwordx4 v14, s[12:15], s29 offen lds
    s_mov_b32 m0, 30720
    s_add_u32 s29, s51, 19267584
    buffer_load_dwordx4 v13, s[8:11], s29 offen sc1 lds
    s_mov_b32 m0, 31744
    s_add_u32 s29, s52, 19267584
    buffer_load_dwordx4 v13, s[8:11], s29 offen sc1 lds
    s_waitcnt vmcnt(14)
    s_barrier
    s_mov_b32 m0, 45056
    s_mov_b32 s29, 82944
    buffer_load_dwordx4 v14, s[12:15], s29 offen lds
    s_mov_b32 m0, 39936
    s_add_u32 s29, s51, 19398656
    buffer_load_dwordx4 v13, s[8:11], s29 offen sc1 lds
    s_mov_b32 m0, 54272
    s_mov_b32 s29, 124416
    buffer_load_dwordx4 v14, s[12:15], s29 offen lds
    s_mov_b32 m0, 49152
    s_add_u32 s29, s51, 19529728
    buffer_load_dwordx4 v13, s[8:11], s29 offen sc1 lds
    s_mov_b32 m0, 63488
    s_mov_b32 s29, 165888
    buffer_load_dwordx4 v14, s[12:15], s29 offen lds
    s_mov_b32 m0, 58368
    s_add_u32 s29, s51, 19660800
    buffer_load_dwordx4 v13, s[8:11], s29 offen sc1 lds
    s_mov_b32 m0, 72704
    s_mov_b32 s29, 207360
    buffer_load_dwordx4 v14, s[12:15], s29 offen lds
    s_mov_b32 m0, 67584
    s_add_u32 s29, s51, 19791872
    buffer_load_dwordx4 v13, s[8:11], s29 offen sc1 lds
    s_mov_b32 m0, 68608
    s_add_u32 s29, s52, 19791872
    buffer_load_dwordx4 v13, s[8:11], s29 offen sc1 lds
    s_waitcnt vmcnt(14)
    s_barrier
    s_mov_b32 m0, 81920
    s_mov_b32 s29, 248832
    buffer_load_dwordx4 v14, s[12:15], s29 offen lds
    s_mov_b32 m0, 76800
    s_add_u32 s29, s51, 19922944
    buffer_load_dwordx4 v13, s[8:11], s29 offen sc1 lds
    s_mov_b32 m0, 91136
    s_mov_b32 s29, 290304
    buffer_load_dwordx4 v14, s[12:15], s29 offen lds
    s_mov_b32 m0, 86016
    s_add_u32 s29, s51, 20054016
    buffer_load_dwordx4 v13, s[8:11], s29 offen sc1 lds
    s_mov_b32 m0, 100352
    s_mov_b32 s29, 331776
    buffer_load_dwordx4 v14, s[12:15], s29 offen lds
    s_mov_b32 m0, 95232
    s_add_u32 s29, s51, 20185088
    buffer_load_dwordx4 v13, s[8:11], s29 offen sc1 lds
    s_mov_b32 m0, 109568
    s_mov_b32 s29, 373248
    buffer_load_dwordx4 v14, s[12:15], s29 offen lds
    s_mov_b32 m0, 104448
    s_add_u32 s29, s51, 20316160
    buffer_load_dwordx4 v13, s[8:11], s29 offen sc1 lds
    s_mov_b32 m0, 105472
    s_add_u32 s29, s52, 20316160
    buffer_load_dwordx4 v13, s[8:11], s29 offen sc1 lds
    s_waitcnt vmcnt(14)
    s_barrier
    s_mov_b32 m0, 118784
    s_mov_b32 s29, 414720
    buffer_load_dwordx4 v14, s[12:15], s29 offen lds
    s_mov_b32 m0, 113664
    s_add_u32 s29, s51, 20447232
    buffer_load_dwordx4 v13, s[8:11], s29 offen sc1 lds
    s_mov_b32 m0, 128000
    s_mov_b32 s29, 456192
    buffer_load_dwordx4 v14, s[12:15], s29 offen lds
    s_mov_b32 m0, 122880
    s_add_u32 s29, s51, 20578304
    buffer_load_dwordx4 v13, s[8:11], s29 offen sc1 lds
    s_mov_b32 m0, 137216
    s_mov_b32 s29, 497664
    buffer_load_dwordx4 v14, s[12:15], s29 offen lds
    s_mov_b32 m0, 132096
    s_add_u32 s29, s51, 20709376
    buffer_load_dwordx4 v13, s[8:11], s29 offen sc1 lds
    s_mov_b32 m0, 146432
    s_mov_b32 s29, 539136
    buffer_load_dwordx4 v14, s[12:15], s29 offen lds
    s_mov_b32 m0, 141312
    s_add_u32 s29, s51, 20840448
    buffer_load_dwordx4 v13, s[8:11], s29 offen sc1 lds
    s_mov_b32 m0, 142336
    s_add_u32 s29, s52, 20840448
    buffer_load_dwordx4 v13, s[8:11], s29 offen sc1 lds
    s_waitcnt vmcnt(14)
    s_barrier
    s_mov_b32 m0, 8192
    s_mov_b32 s29, 580608
    buffer_load_dwordx4 v14, s[12:15], s29 offen lds
    s_mov_b32 m0, 3072
    s_add_u32 s29, s51, 20971520
    buffer_load_dwordx4 v13, s[8:11], s29 offen sc1 lds
    s_mov_b32 m0, 17408
    s_mov_b32 s29, 622080
    buffer_load_dwordx4 v14, s[12:15], s29 offen lds
    s_mov_b32 m0, 12288
    s_add_u32 s29, s51, 21102592
    buffer_load_dwordx4 v13, s[8:11], s29 offen sc1 lds
    s_mov_b32 m0, 26624
    s_mov_b32 s29, 0
    buffer_load_dwordx4 v15, s[12:15], s29 offen lds
    s_mov_b32 m0, 21504
    s_add_u32 s29, s51, 21233664
    buffer_load_dwordx4 v13, s[8:11], s29 offen sc1 lds
    s_mov_b32 m0, 35840
    s_mov_b32 s29, 331776
    buffer_load_dwordx4 v15, s[12:15], s29 offen lds
    s_mov_b32 m0, 30720
    s_add_u32 s29, s51, 21364736
    buffer_load_dwordx4 v13, s[8:11], s29 offen sc1 lds
    s_mov_b32 m0, 31744
    s_add_u32 s29, s52, 21364736
    buffer_load_dwordx4 v13, s[8:11], s29 offen sc1 lds
    s_waitcnt vmcnt(14)
    s_barrier
    s_waitcnt vmcnt(5)
    s_barrier
    s_waitcnt vmcnt(0)
    s_barrier
    s_barrier
    s_barrier
    s_branch L_op_store_ld
L_op_store_ld:
    s_add_u32 s24, s24, 8
L_op_store:
    s_add_u32 s33, s24, 0
    s_cmp_ge_u32 s33, 10
    s_cbranch_scc1 L_st_40
    s_lshl_b32 s29, s33, 6
    v_add_u32 v2, s29, v1
    v_lshrrev_b32 v3, 3, v2
    v_and_b32 v4, 7, v2
    v_and_b32 v5, 7, v3
    v_xor_b32 v5, v5, v4
    v_lshlrev_b32 v5, 4, v5
    v_lshlrev_b32 v6, 7, v3
    v_add_u32 v5, v5, v6
    ds_read_b128 v[24:27], v5
    s_lshl_b32 s30, s27, 4
    v_add_u32 v6, s30, v3
    v_mul_u32_u24 v6, 1152, v6
    v_lshlrev_b32 v4, 4, v4
    v_add_u32 v6, v6, v4
    s_lshl_b32 s30, s28, 4
    v_cmp_gt_u32 vcc, s30, v3
    v_mov_b32 v4, 0x80000000
    s_lshl_b32 s30, s26, 7
    v_cndmask_b32 v6, v4, v6, vcc
    s_waitcnt lgkmcnt(0)
    buffer_store_dwordx4 v[24:27], v6, s[20:23], s30 offen
L_st_40:
L_op_stored:
L_op_end:
    s_endpgm
code_end:
.section .rodata,"a"
.p2align 6
.amdhsa_kernel qkv_kernel
  .amdhsa_next_free_vgpr 168
  .amdhsa_next_free_sgpr 100
  .amdhsa_accum_offset 168
  .amdhsa_group_segment_fixed_size 0
  .amdhsa_kernarg_size 80
  .amdhsa_user_sgpr_count 2
  .amdhsa_user_sgpr_kernarg_segment_ptr 1
  .amdhsa_system_sgpr_workgroup_id_x 1
.end_amdhsa_kernel
.p2align 6
.amdhsa_kernel attn_kernel
  .amdhsa_next_free_vgpr 168
  .amdhsa_next_free_sgpr 100
  .amdhsa_accum_offset 168
  .amdhsa_group_segment_fixed_size 0
  .amdhsa_kernarg_size 80
  .amdhsa_user_sgpr_count 2
  .amdhsa_user_sgpr_kernarg_segment_ptr 1
  .amdhsa_system_sgpr_workgroup_id_x 1
.end_amdhsa_kernel
.p2align 6
.amdhsa_kernel oproj_kernel
  .amdhsa_next_free_vgpr 168
  .amdhsa_next_free_sgpr 100
  .amdhsa_accum_offset 168
  .amdhsa_group_segment_fixed_size 0
  .amdhsa_kernarg_size 80
  .amdhsa_user_sgpr_count 2
  .amdhsa_user_sgpr_kernarg_segment_ptr 1
  .amdhsa_system_sgpr_workgroup_id_x 1
.end_amdhsa_kernel
```
